```python
import torch

def _softmax(x, axis=-1):
    return torch.softmax(x, dim=axis)

def _gelu(x):
    return torch.nn.functional.gelu(x, approximate='tanh')

def _silu(x):
    return torch.nn.functional.silu(x)

def _sigmoid(x):
    return torch.sigmoid(x)

def _layernorm(x, axis=-1, eps=1e-05):
    m = x.mean(dim=axis, keepdim=True)
    v = x.var(dim=axis, keepdim=True, unbiased=False)
    return (x - m) / torch.sqrt(v + eps)

def _scatter_add(tgt, idx, src, axis=0):
    return tgt.clone().index_add_(axis, idx, src)

def _segment_sum(src, seg, n):
    out = torch.zeros((n,) + src.shape[1:], dtype=src.dtype)
    return out.index_add_(0, seg, src)

def _pad(x, pw):
    flat = tuple((v for pair in reversed(pw) for v in pair))
    return torch.nn.functional.pad(x, flat)
kernel_name = 'concat_heads__spectral_gfnet__memory_aug_recurrent_mem_tr__prompt'

def setup_inputs():

    _w = lambda a: (lambda t: t.to(torch.bfloat16) if t.is_floating_point() else t)(torch.as_tensor(a))

    def _A_setup():
        B, S, D = (1, 2048, 576)
        Df = D // 2 + 1
        return {'x': _w((lambda *s: torch.randn(*s, dtype=torch.bfloat16) * 0.05)(B, S, D)), 'w_r': _w((lambda *s: torch.randn(*s, dtype=torch.bfloat16) * 3.2)(S, Df) * 0.02), 'w_i': _w((lambda *s: torch.randn(*s, dtype=torch.bfloat16) * 3.2)(S, Df) * 0.02)}
    _A_in = _A_setup()

    def _B_setup():
        B, S, Dm = (1, 2048, 576)
        H, Dh = (32, 128)
        M, seg = (8, 32)
        seg = min(seg, S)
        S = S // seg * seg
        return {'x': _w((lambda *s: torch.randn(*s, dtype=torch.bfloat16) * 0.05)(B, S, Dm)), 'mem0': _w((lambda *s: torch.randn(*s, dtype=torch.bfloat16) * 0.4)(B, M, Dm)), 'Wq': _w((lambda *s: torch.randn(*s, dtype=torch.bfloat16) * 6.4)(Dm, H, Dh) * Dm ** (-0.5)), 'Wk': _w((lambda *s: torch.randn(*s, dtype=torch.bfloat16) * 6.4)(Dm, H, Dh) * Dm ** (-0.5)), 'Wv': _w((lambda *s: torch.randn(*s, dtype=torch.bfloat16) * 0.4)(Dm, H, Dh) * Dm ** (-0.5)), 'Wo': _w((lambda *s: torch.randn(*s, dtype=torch.bfloat16) * 0.4)(H, Dh, Dm) * (H * Dh) ** (-0.5)), 'seg_len': seg}
    _B_in = _B_setup()
    return {'A_x': _A_in['x'], 'A_w_r': _A_in['w_r'], 'A_w_i': _A_in['w_i'], 'B_x': _B_in['x'], 'B_mem0': _B_in['mem0'], 'B_Wq': _B_in['Wq'], 'B_Wk': _B_in['Wk'], 'B_Wv': _B_in['Wv'], 'B_Wo': _B_in['Wo'], 'B_seg_len': _B_in['seg_len']}

def reference(A_x, A_w_r, A_w_i, B_x, B_mem0, B_Wq, B_Wk, B_Wv, B_Wo, B_seg_len):

    def _A_ref(x, w_r, w_i):
        B, S, D = x.shape
        X = (lambda x, axes=(-2, -1): torch.fft.rfft2(x.float(), dim=axes))(x, axes=(-2, -1))
        W = w_r + 1j * w_i
        X = X * W
        y = (lambda x, s, axes=(-2, -1): torch.fft.irfft2(x, s=s, dim=axes).to(torch.bfloat16))(X, (S, D), axes=(-2, -1))
        return y

    def _B_ref(x, mem0, Wq, Wk, Wv, Wo, seg_len):
        B, S, Dm = x.shape
        H, Dh = (Wq.shape[1], Wq.shape[2])
        M = mem0.shape[1]
        scale = Dh ** (-0.5)
        n_seg = S // seg_len
        L = M + seg_len
        idx = torch.arange(L)
        mask = (idx[:, None] < M) | (idx[:, None] >= idx[None, :])
        mem = mem0
        outs = []
        for s in range(n_seg):
            xs = x[:, s * seg_len:(s + 1) * seg_len, :].clone()
            h = torch.concatenate([mem, xs], axis=1)
            q = torch.einsum('btd,dhe->bhte', h, Wq)
            k = torch.einsum('btd,dhe->bhte', h, Wk)
            v = torch.einsum('btd,dhe->bhte', h, Wv)
            scores = torch.einsum('bhqe,bhke->bhqk', q, k) * scale
            scores = torch.where(mask[None, None], scores, -1000000000.0)
            p = _softmax(scores, axis=-1)
            o = torch.einsum('bhqk,bhke->bhqe', p, v)
            o = torch.einsum('bhte,hed->btd', o, Wo)
            mem = o[:, :M, :].clone()
            outs.append(o[:, M:, :])
        return torch.concatenate(outs, axis=1)
    a = _A_ref(A_x, A_w_r, A_w_i)
    b = _B_ref(B_x, B_mem0, B_Wq, B_Wk, B_Wv, B_Wo, B_seg_len)
    return torch.concatenate([a, b], axis=-1)
```

```asm
; @launch grid=(256,1,1) block=(256,1,1) lds=163840
.amdgcn_target "amdgcn-amd-amdhsa--gfx950"
.text
.globl concat_heads__spectral_gfnet__memory_aug_recurrent_mem_tr__prompt_kernel
.p2align 8
.type concat_heads__spectral_gfnet__memory_aug_recurrent_mem_tr__prompt_kernel,@function
concat_heads__spectral_gfnet__memory_aug_recurrent_mem_tr__prompt_kernel:
    s_load_dwordx2 s[12:13], s[0:1], 88
    s_load_dwordx2 s[8:9], s[0:1], 96
    s_getreg_b32 s4, hwreg(HW_REG_XCC_ID)
    s_mov_b32 s10, 268435456
    s_mov_b32 s11, 0x00020000
    s_and_b32 s4, s4, 7
    v_lshrrev_b32 v2, 6, v0
    v_mov_b32 v5, 2031616
    s_waitcnt lgkmcnt(0)
    v_readfirstlane_b32 s6, v2
    s_cmp_ge_u32 s2, 256
    s_cbranch_scc1 L_exit
    v_cmp_eq_u32 vcc, 0, v0
    s_nop 0
    s_and_saveexec_b64 s[14:15], vcc
    s_cbranch_execz L_skip
    s_lshl_b32 s16, s4, 2
    s_cmp_eq_u32 s4, 0
    s_cselect_b32 s16, 192, s16
    v_mov_b32 v1, s16
    v_mov_b32 v2, 1
    global_atomic_add v3, v1, v2, s[12:13] sc0
    s_waitcnt vmcnt(0)
    v_readfirstlane_b32 s17, v3
    s_nop 0
    s_cmp_lt_u32 s17, 32
    s_cbranch_scc1 L_nat
    v_mov_b32 v1, 32
    global_atomic_add v1, v2, s[12:13]
    v_mov_b32 v1, 36
    global_atomic_add v3, v1, v2, s[12:13] sc0
    v_mov_b32 v1, 0
    s_mov_b32 s18, 0
    s_waitcnt vmcnt(0)
    v_readfirstlane_b32 s17, v3
L_orw:
    global_load_dword v3, v1, s[12:13] offset:32 sc1
    global_load_dword v6, v1, s[12:13] offset:192 sc1
    s_waitcnt vmcnt(0)
    v_readfirstlane_b32 s19, v3
    v_readfirstlane_b32 s16, v6
    s_nop 0
    s_min_u32 s16, s16, 32
    s_add_u32 s19, s19, s16
    s_add_u32 s18, s18, 1
    s_cmp_gt_u32 s18, 0x4000
    s_cbranch_scc1 L_oex
    s_cmp_lt_u32 s19, 256
    s_cbranch_scc1 L_orw
    s_cmp_gt_u32 s19, 256
    s_cbranch_scc1 L_oex
    s_mov_b32 s18, 0
L_orx:
    s_lshl_b32 s16, s18, 2
    s_cmp_eq_u32 s18, 0
    s_cselect_b32 s16, 192, s16
    v_mov_b32 v1, s16
    global_load_dword v3, v1, s[12:13] sc1
    s_waitcnt vmcnt(0)
    v_readfirstlane_b32 s19, v3
    s_nop 0
    s_min_u32 s19, s19, 32
    s_sub_u32 s16, 32, s19
    s_cmp_lt_u32 s17, s16
    s_cbranch_scc1 L_orf
    s_sub_u32 s17, s17, s16
    s_add_u32 s18, s18, 1
    s_cmp_lt_u32 s18, 8
    s_cbranch_scc1 L_orx
L_oex:
    s_mov_b32 s17, 0x1000
    s_branch L_orv
L_orf:
    s_add_u32 s17, s17, s19
    s_lshl_b32 s18, s18, 8
    s_add_u32 s17, s17, s18
    s_branch L_orv
L_nat:
    s_lshl_b32 s18, s4, 8
    s_add_u32 s17, s17, s18
    s_add_u32 s17, s17, 64
L_orv:
    v_mov_b32 v3, s17
    v_mov_b32 v1, 0
    ds_write_b32 v1, v3
    s_waitcnt lgkmcnt(0)
L_skip:
    s_mov_b64 exec, s[14:15]
    buffer_load_dword v59, v5, s[8:11], 0 offen sc1
    s_barrier
    v_mov_b32 v1, 0
    ds_read_b32 v3, v1
    s_waitcnt lgkmcnt(0)
    v_readfirstlane_b32 s5, v3
    s_barrier
    s_and_b32 s3, s5, 64
    s_lshr_b32 s4, s5, 8
    s_and_b32 s5, s5, 31
    s_cmp_ge_u32 s4, 8
    s_cbranch_scc1 L_exit
    s_getpc_b64 s[16:17]
L_pc:
    s_lshl_b32 s18, s5, 12
    v_lshlrev_b32 v1, 4, v0
    v_add_u32 v1, s18, v1
    v_cmp_gt_u32 vcc, L_code_end - L_pc - 16, v1
    s_nop 0
    s_and_saveexec_b64 s[14:15], vcc
    s_cbranch_execz L_nopf
    global_load_dwordx4 v[60:63], v1, s[16:17]
L_nopf:
    s_mov_b64 exec, s[14:15]
    s_cmp_eq_u32 s4, 0
    s_cbranch_scc1 R_chain
    s_cmp_ge_u32 s4, 5
    s_cbranch_scc1 R_fft
    s_waitcnt vmcnt(0)
    v_readfirstlane_b32 s7, v59
    s_nop 0
    s_add_u32 s7, s7, 1
    s_cmp_le_u32 s4, 4
    s_cbranch_scc1 R_qkv
    s_branch R_fft
L_exit:
    s_endpgm
R_qkv:
    s_load_dwordx2 s[72:73], s[0:1], 40
    s_mov_b32 s74, 4718592
    s_mov_b32 s75, 0x00020000
    s_load_dwordx2 s[76:77], s[0:1], 48
    s_mov_b32 s78, 4718592
    s_mov_b32 s79, 0x00020000
    s_load_dwordx2 s[80:81], s[0:1], 56
    s_mov_b32 s82, 4718592
    s_mov_b32 s83, 0x00020000
    s_load_dwordx2 s[24:25], s[0:1], 24
    s_mov_b32 s26, 2359296
    s_mov_b32 s27, 0x00020000
    s_load_dwordx2 s[84:85], s[0:1], 88
    s_sub_u32 s14, s4, 1
    s_lshl_b32 s14, s14, 5
    s_add_u32 s14, s14, s5
    s_lshr_b32 s12, s14, 2
    s_and_b32 s13, s14, 3
    v_mov_b32 v4, s7
    v_and_b32 v32, 63, v0
    v_lshrrev_b32 v33, 5, v32
    v_bfe_u32 v34, v32, 4, 1
    v_bfe_u32 v35, v32, 2, 2
    v_and_b32 v36, 3, v32
    v_and_b32 v37, 15, v32
    v_lshlrev_b32 v1, 10, v34
    v_lshl_add_u32 v1, v33, 8, v1
    v_lshl_add_u32 v1, v37, 4, v1
    v_mov_b32 v2, v1
    s_and_b32 s14, s6, 1
    s_lshl_b32 s14, s14, 4
    v_add_u32 v3, s14, v37
    v_mul_u32_u24 v3, 1152, v3
    v_lshrrev_b32 v38, 4, v32
    v_lshl_add_u32 v3, v38, 4, v3
    s_lshr_b32 s14, s6, 1
    s_lshl_b32 s14, s14, 6
    v_add_u32 v3, s14, v3
    s_lshl_b32 s14, s6, 1
    v_add_u32 v38, s14, v34
    v_lshlrev_b32 v39, 1, v35
    v_xor_b32 v38, v38, v39
    v_lshl_add_u32 v39, v33, 3, v35
    v_lshlrev_b32 v39, 8, v39
    v_lshl_add_u32 v39, v38, 5, v39
    v_lshl_add_u32 v16, v36, 3, v39
    v_add_u32 v17, 36864, v16
    v_add_u32 v18, 73728, v16
    v_add_u32 v19, 110592, v16
    s_mul_i32 s94, s6, 36864
    s_lshl_b32 s95, s12, 8
    s_lshl_b32 s14, s6, 17
    s_add_u32 s95, s95, s14
    s_waitcnt lgkmcnt(0)
    v_and_b32 v28, 63, v0
    v_lshrrev_b32 v29, 4, v28
    v_and_b32 v28, 15, v28
    v_lshlrev_b32 v24, 2, v29
    v_xor_b32 v24, v24, v28
    v_lshlrev_b32 v24, 4, v24
    v_lshl_add_u32 v24, v29, 13, v24
    v_add_u32 v24, 0, v24
    v_lshlrev_b32 v25, 2, v29
    v_xor_b32 v25, v25, v28
    v_lshlrev_b32 v25, 4, v25
    v_lshl_add_u32 v25, v29, 13, v25
    v_add_u32 v25, 32768, v25
    v_lshlrev_b32 v26, 2, v29
    v_xor_b32 v26, v26, v28
    v_lshlrev_b32 v26, 4, v26
    v_lshl_add_u32 v26, v29, 13, v26
    v_add_u32 v26, 65536, v26
    v_lshlrev_b32 v27, 2, v29
    v_xor_b32 v27, v27, v28
    v_lshlrev_b32 v27, 4, v27
    v_lshl_add_u32 v27, v29, 13, v27
    v_add_u32 v27, 98304, v27
    s_add_u32 s96, s95, 0
    s_add_u32 m0, s94, 0
    s_nop 0
    buffer_load_dwordx4 v24, s[72:75], s96 offen lds
    s_add_u32 m0, s94, 1024
    s_nop 0
    buffer_load_dwordx4 v25, s[72:75], s96 offen lds
    s_add_u32 m0, s94, 2048
    s_nop 0
    buffer_load_dwordx4 v26, s[72:75], s96 offen lds
    s_add_u32 m0, s94, 3072
    s_nop 0
    buffer_load_dwordx4 v27, s[72:75], s96 offen lds
    s_barrier
    s_add_u32 s96, s95, 524288
    s_add_u32 m0, s94, 4096
    s_nop 0
    buffer_load_dwordx4 v24, s[72:75], s96 offen lds
    s_add_u32 m0, s94, 5120
    s_nop 0
    buffer_load_dwordx4 v25, s[72:75], s96 offen lds
    s_add_u32 m0, s94, 6144
    s_nop 0
    buffer_load_dwordx4 v26, s[72:75], s96 offen lds
    s_add_u32 m0, s94, 7168
    s_nop 0
    buffer_load_dwordx4 v27, s[72:75], s96 offen lds
    s_barrier
    s_add_u32 s96, s95, 1048576
    s_add_u32 m0, s94, 8192
    s_nop 0
    buffer_load_dwordx4 v24, s[72:75], s96 offen lds
    s_add_u32 m0, s94, 9216
    s_nop 0
    buffer_load_dwordx4 v25, s[72:75], s96 offen lds
    s_add_u32 m0, s94, 10240
    s_nop 0
    buffer_load_dwordx4 v26, s[72:75], s96 offen lds
    s_add_u32 m0, s94, 11264
    s_nop 0
    buffer_load_dwordx4 v27, s[72:75], s96 offen lds
    s_barrier
    s_add_u32 s96, s95, 1572864
    s_add_u32 m0, s94, 12288
    s_nop 0
    buffer_load_dwordx4 v24, s[72:75], s96 offen lds
    s_add_u32 m0, s94, 13312
    s_nop 0
    buffer_load_dwordx4 v25, s[72:75], s96 offen lds
    s_add_u32 m0, s94, 14336
    s_nop 0
    buffer_load_dwordx4 v26, s[72:75], s96 offen lds
    s_add_u32 m0, s94, 15360
    s_nop 0
    buffer_load_dwordx4 v27, s[72:75], s96 offen lds
    s_barrier
    s_add_u32 s96, s95, 2097152
    s_add_u32 m0, s94, 16384
    s_nop 0
    buffer_load_dwordx4 v24, s[72:75], s96 offen lds
    s_add_u32 m0, s94, 17408
    s_nop 0
    buffer_load_dwordx4 v25, s[72:75], s96 offen lds
    s_add_u32 m0, s94, 18432
    s_nop 0
    buffer_load_dwordx4 v26, s[72:75], s96 offen lds
    s_add_u32 m0, s94, 19456
    s_nop 0
    buffer_load_dwordx4 v27, s[72:75], s96 offen lds
    s_barrier
    s_add_u32 s96, s95, 2621440
    s_add_u32 m0, s94, 20480
    s_nop 0
    buffer_load_dwordx4 v24, s[72:75], s96 offen lds
    s_add_u32 m0, s94, 21504
    s_nop 0
    buffer_load_dwordx4 v25, s[72:75], s96 offen lds
    s_add_u32 m0, s94, 22528
    s_nop 0
    buffer_load_dwordx4 v26, s[72:75], s96 offen lds
    s_add_u32 m0, s94, 23552
    s_nop 0
    buffer_load_dwordx4 v27, s[72:75], s96 offen lds
    s_barrier
    s_add_u32 s96, s95, 3145728
    s_add_u32 m0, s94, 24576
    s_nop 0
    buffer_load_dwordx4 v24, s[72:75], s96 offen lds
    s_add_u32 m0, s94, 25600
    s_nop 0
    buffer_load_dwordx4 v25, s[72:75], s96 offen lds
    s_add_u32 m0, s94, 26624
    s_nop 0
    buffer_load_dwordx4 v26, s[72:75], s96 offen lds
    s_add_u32 m0, s94, 27648
    s_nop 0
    buffer_load_dwordx4 v27, s[72:75], s96 offen lds
    s_barrier
    s_add_u32 s96, s95, 3670016
    s_add_u32 m0, s94, 28672
    s_nop 0
    buffer_load_dwordx4 v24, s[72:75], s96 offen lds
    s_add_u32 m0, s94, 29696
    s_nop 0
    buffer_load_dwordx4 v25, s[72:75], s96 offen lds
    s_add_u32 m0, s94, 30720
    s_nop 0
    buffer_load_dwordx4 v26, s[72:75], s96 offen lds
    s_add_u32 m0, s94, 31744
    s_nop 0
    buffer_load_dwordx4 v27, s[72:75], s96 offen lds
    s_barrier
    s_add_u32 s96, s95, 4194304
    s_add_u32 m0, s94, 32768
    s_nop 0
    buffer_load_dwordx4 v24, s[72:75], s96 offen lds
    s_add_u32 m0, s94, 33792
    s_nop 0
    buffer_load_dwordx4 v25, s[72:75], s96 offen lds
    s_add_u32 m0, s94, 34816
    s_nop 0
    buffer_load_dwordx4 v26, s[72:75], s96 offen lds
    s_add_u32 m0, s94, 35840
    s_nop 0
    buffer_load_dwordx4 v27, s[72:75], s96 offen lds
    s_waitcnt vmcnt(32) lgkmcnt(0)
    s_barrier
    ds_read_b64_tr_b16 v[80:81], v16 offset:0
    ds_read_b64_tr_b16 v[82:83], v16 offset:1024
    ds_read_b64_tr_b16 v[84:85], v17 offset:0
    ds_read_b64_tr_b16 v[86:87], v17 offset:1024
    ds_read_b64_tr_b16 v[88:89], v18 offset:0
    ds_read_b64_tr_b16 v[90:91], v18 offset:1024
    ds_read_b64_tr_b16 v[92:93], v19 offset:0
    ds_read_b64_tr_b16 v[94:95], v19 offset:1024
    s_waitcnt vmcnt(28) lgkmcnt(0)
    s_barrier
    ds_read_b64_tr_b16 v[96:97], v16 offset:4096
    ds_read_b64_tr_b16 v[98:99], v16 offset:5120
    s_add_u32 s96, s95, 0
    s_add_u32 m0, s94, 0
    s_nop 0
    buffer_load_dwordx4 v24, s[76:79], s96 offen lds
    ds_read_b64_tr_b16 v[100:101], v17 offset:4096
    ds_read_b64_tr_b16 v[102:103], v17 offset:5120
    s_add_u32 m0, s94, 1024
    s_nop 0
    buffer_load_dwordx4 v25, s[76:79], s96 offen lds
    ds_read_b64_tr_b16 v[104:105], v18 offset:4096
    ds_read_b64_tr_b16 v[106:107], v18 offset:5120
    s_add_u32 m0, s94, 2048
    s_nop 0
    buffer_load_dwordx4 v26, s[76:79], s96 offen lds
    ds_read_b64_tr_b16 v[108:109], v19 offset:4096
    ds_read_b64_tr_b16 v[110:111], v19 offset:5120
    s_add_u32 m0, s94, 3072
    s_nop 0
    buffer_load_dwordx4 v27, s[76:79], s96 offen lds
    s_waitcnt vmcnt(28) lgkmcnt(0)
    s_barrier
    ds_read_b64_tr_b16 v[112:113], v16 offset:8192
    ds_read_b64_tr_b16 v[114:115], v16 offset:9216
    s_add_u32 s96, s95, 524288
    s_add_u32 m0, s94, 4096
    s_nop 0
    buffer_load_dwordx4 v24, s[76:79], s96 offen lds
    ds_read_b64_tr_b16 v[116:117], v17 offset:8192
    ds_read_b64_tr_b16 v[118:119], v17 offset:9216
    s_add_u32 m0, s94, 5120
    s_nop 0
    buffer_load_dwordx4 v25, s[76:79], s96 offen lds
    ds_read_b64_tr_b16 v[120:121], v18 offset:8192
    ds_read_b64_tr_b16 v[122:123], v18 offset:9216
    s_add_u32 m0, s94, 6144
    s_nop 0
    buffer_load_dwordx4 v26, s[76:79], s96 offen lds
    ds_read_b64_tr_b16 v[124:125], v19 offset:8192
    ds_read_b64_tr_b16 v[126:127], v19 offset:9216
    s_add_u32 m0, s94, 7168
    s_nop 0
    buffer_load_dwordx4 v27, s[76:79], s96 offen lds
    s_waitcnt vmcnt(28) lgkmcnt(0)
    s_barrier
    ds_read_b64_tr_b16 v[128:129], v16 offset:12288
    ds_read_b64_tr_b16 v[130:131], v16 offset:13312
    s_add_u32 s96, s95, 1048576
    s_add_u32 m0, s94, 8192
    s_nop 0
    buffer_load_dwordx4 v24, s[76:79], s96 offen lds
    ds_read_b64_tr_b16 v[132:133], v17 offset:12288
    ds_read_b64_tr_b16 v[134:135], v17 offset:13312
    s_add_u32 m0, s94, 9216
    s_nop 0
    buffer_load_dwordx4 v25, s[76:79], s96 offen lds
    ds_read_b64_tr_b16 v[136:137], v18 offset:12288
    ds_read_b64_tr_b16 v[138:139], v18 offset:13312
    s_add_u32 m0, s94, 10240
    s_nop 0
    buffer_load_dwordx4 v26, s[76:79], s96 offen lds
    ds_read_b64_tr_b16 v[140:141], v19 offset:12288
    ds_read_b64_tr_b16 v[142:143], v19 offset:13312
    s_add_u32 m0, s94, 11264
    s_nop 0
    buffer_load_dwordx4 v27, s[76:79], s96 offen lds
    s_waitcnt vmcnt(28) lgkmcnt(0)
    s_barrier
    ds_read_b64_tr_b16 v[144:145], v16 offset:16384
    ds_read_b64_tr_b16 v[146:147], v16 offset:17408
    s_add_u32 s96, s95, 1572864
    s_add_u32 m0, s94, 12288
    s_nop 0
    buffer_load_dwordx4 v24, s[76:79], s96 offen lds
    ds_read_b64_tr_b16 v[148:149], v17 offset:16384
    ds_read_b64_tr_b16 v[150:151], v17 offset:17408
    s_add_u32 m0, s94, 13312
    s_nop 0
    buffer_load_dwordx4 v25, s[76:79], s96 offen lds
    ds_read_b64_tr_b16 v[152:153], v18 offset:16384
    ds_read_b64_tr_b16 v[154:155], v18 offset:17408
    s_add_u32 m0, s94, 14336
    s_nop 0
    buffer_load_dwordx4 v26, s[76:79], s96 offen lds
    ds_read_b64_tr_b16 v[156:157], v19 offset:16384
    ds_read_b64_tr_b16 v[158:159], v19 offset:17408
    s_add_u32 m0, s94, 15360
    s_nop 0
    buffer_load_dwordx4 v27, s[76:79], s96 offen lds
    s_waitcnt vmcnt(28) lgkmcnt(0)
    s_barrier
    ds_read_b64_tr_b16 v[160:161], v16 offset:20480
    ds_read_b64_tr_b16 v[162:163], v16 offset:21504
    s_add_u32 s96, s95, 2097152
    s_add_u32 m0, s94, 16384
    s_nop 0
    buffer_load_dwordx4 v24, s[76:79], s96 offen lds
    ds_read_b64_tr_b16 v[164:165], v17 offset:20480
    ds_read_b64_tr_b16 v[166:167], v17 offset:21504
    s_add_u32 m0, s94, 17408
    s_nop 0
    buffer_load_dwordx4 v25, s[76:79], s96 offen lds
    ds_read_b64_tr_b16 v[168:169], v18 offset:20480
    ds_read_b64_tr_b16 v[170:171], v18 offset:21504
    s_add_u32 m0, s94, 18432
    s_nop 0
    buffer_load_dwordx4 v26, s[76:79], s96 offen lds
    ds_read_b64_tr_b16 v[172:173], v19 offset:20480
    ds_read_b64_tr_b16 v[174:175], v19 offset:21504
    s_add_u32 m0, s94, 19456
    s_nop 0
    buffer_load_dwordx4 v27, s[76:79], s96 offen lds
    s_waitcnt vmcnt(28) lgkmcnt(0)
    s_barrier
    ds_read_b64_tr_b16 v[176:177], v16 offset:24576
    ds_read_b64_tr_b16 v[178:179], v16 offset:25600
    s_add_u32 s96, s95, 2621440
    s_add_u32 m0, s94, 20480
    s_nop 0
    buffer_load_dwordx4 v24, s[76:79], s96 offen lds
    ds_read_b64_tr_b16 v[180:181], v17 offset:24576
    ds_read_b64_tr_b16 v[182:183], v17 offset:25600
    s_add_u32 m0, s94, 21504
    s_nop 0
    buffer_load_dwordx4 v25, s[76:79], s96 offen lds
    ds_read_b64_tr_b16 v[184:185], v18 offset:24576
    ds_read_b64_tr_b16 v[186:187], v18 offset:25600
    s_add_u32 m0, s94, 22528
    s_nop 0
    buffer_load_dwordx4 v26, s[76:79], s96 offen lds
    ds_read_b64_tr_b16 v[188:189], v19 offset:24576
    ds_read_b64_tr_b16 v[190:191], v19 offset:25600
    s_add_u32 m0, s94, 23552
    s_nop 0
    buffer_load_dwordx4 v27, s[76:79], s96 offen lds
    s_waitcnt vmcnt(28) lgkmcnt(0)
    s_barrier
    ds_read_b64_tr_b16 v[192:193], v16 offset:28672
    ds_read_b64_tr_b16 v[194:195], v16 offset:29696
    s_add_u32 s96, s95, 3145728
    s_add_u32 m0, s94, 24576
    s_nop 0
    buffer_load_dwordx4 v24, s[76:79], s96 offen lds
    ds_read_b64_tr_b16 v[196:197], v17 offset:28672
    ds_read_b64_tr_b16 v[198:199], v17 offset:29696
    s_add_u32 m0, s94, 25600
    s_nop 0
    buffer_load_dwordx4 v25, s[76:79], s96 offen lds
    ds_read_b64_tr_b16 v[200:201], v18 offset:28672
    ds_read_b64_tr_b16 v[202:203], v18 offset:29696
    s_add_u32 m0, s94, 26624
    s_nop 0
    buffer_load_dwordx4 v26, s[76:79], s96 offen lds
    ds_read_b64_tr_b16 v[204:205], v19 offset:28672
    ds_read_b64_tr_b16 v[206:207], v19 offset:29696
    s_add_u32 m0, s94, 27648
    s_nop 0
    buffer_load_dwordx4 v27, s[76:79], s96 offen lds
    s_waitcnt vmcnt(28) lgkmcnt(0)
    s_barrier
    ds_read_b64_tr_b16 v[208:209], v16 offset:32768
    ds_read_b64_tr_b16 v[210:211], v16 offset:33792
    s_add_u32 s96, s95, 3670016
    s_add_u32 m0, s94, 28672
    s_nop 0
    buffer_load_dwordx4 v24, s[76:79], s96 offen lds
    ds_read_b64_tr_b16 v[212:213], v17 offset:32768
    ds_read_b64_tr_b16 v[214:215], v17 offset:33792
    s_add_u32 m0, s94, 29696
    s_nop 0
    buffer_load_dwordx4 v25, s[76:79], s96 offen lds
    ds_read_b64_tr_b16 v[216:217], v18 offset:32768
    ds_read_b64_tr_b16 v[218:219], v18 offset:33792
    s_add_u32 m0, s94, 30720
    s_nop 0
    buffer_load_dwordx4 v26, s[76:79], s96 offen lds
    ds_read_b64_tr_b16 v[220:221], v19 offset:32768
    ds_read_b64_tr_b16 v[222:223], v19 offset:33792
    s_add_u32 m0, s94, 31744
    s_nop 0
    buffer_load_dwordx4 v27, s[76:79], s96 offen lds
    s_waitcnt vmcnt(28) lgkmcnt(0)
    s_barrier
    ds_read_b64_tr_b16 a[0:1], v16 offset:0
    ds_read_b64_tr_b16 a[2:3], v16 offset:1024
    s_add_u32 s96, s95, 4194304
    s_add_u32 m0, s94, 32768
    s_nop 0
    buffer_load_dwordx4 v24, s[76:79], s96 offen lds
    ds_read_b64_tr_b16 a[4:5], v17 offset:0
    ds_read_b64_tr_b16 a[6:7], v17 offset:1024
    s_add_u32 m0, s94, 33792
    s_nop 0
    buffer_load_dwordx4 v25, s[76:79], s96 offen lds
    ds_read_b64_tr_b16 a[8:9], v18 offset:0
    ds_read_b64_tr_b16 a[10:11], v18 offset:1024
    s_add_u32 m0, s94, 34816
    s_nop 0
    buffer_load_dwordx4 v26, s[76:79], s96 offen lds
    ds_read_b64_tr_b16 a[12:13], v19 offset:0
    ds_read_b64_tr_b16 a[14:15], v19 offset:1024
    s_add_u32 m0, s94, 35840
    s_nop 0
    buffer_load_dwordx4 v27, s[76:79], s96 offen lds
    s_waitcnt vmcnt(28) lgkmcnt(0)
    s_barrier
    ds_read_b64_tr_b16 a[16:17], v16 offset:4096
    ds_read_b64_tr_b16 a[18:19], v16 offset:5120
    s_add_u32 s96, s95, 0
    s_add_u32 m0, s94, 0
    s_nop 0
    buffer_load_dwordx4 v24, s[80:83], s96 offen lds
    ds_read_b64_tr_b16 a[20:21], v17 offset:4096
    ds_read_b64_tr_b16 a[22:23], v17 offset:5120
    s_add_u32 m0, s94, 1024
    s_nop 0
    buffer_load_dwordx4 v25, s[80:83], s96 offen lds
    ds_read_b64_tr_b16 a[24:25], v18 offset:4096
    ds_read_b64_tr_b16 a[26:27], v18 offset:5120
    s_add_u32 m0, s94, 2048
    s_nop 0
    buffer_load_dwordx4 v26, s[80:83], s96 offen lds
    ds_read_b64_tr_b16 a[28:29], v19 offset:4096
    ds_read_b64_tr_b16 a[30:31], v19 offset:5120
    s_add_u32 m0, s94, 3072
    s_nop 0
    buffer_load_dwordx4 v27, s[80:83], s96 offen lds
    s_waitcnt vmcnt(28) lgkmcnt(0)
    s_barrier
    ds_read_b64_tr_b16 a[32:33], v16 offset:8192
    ds_read_b64_tr_b16 a[34:35], v16 offset:9216
    s_add_u32 s96, s95, 524288
    s_add_u32 m0, s94, 4096
    s_nop 0
    buffer_load_dwordx4 v24, s[80:83], s96 offen lds
    ds_read_b64_tr_b16 a[36:37], v17 offset:8192
    ds_read_b64_tr_b16 a[38:39], v17 offset:9216
    s_add_u32 m0, s94, 5120
    s_nop 0
    buffer_load_dwordx4 v25, s[80:83], s96 offen lds
    ds_read_b64_tr_b16 a[40:41], v18 offset:8192
    ds_read_b64_tr_b16 a[42:43], v18 offset:9216
    s_add_u32 m0, s94, 6144
    s_nop 0
    buffer_load_dwordx4 v26, s[80:83], s96 offen lds
    ds_read_b64_tr_b16 a[44:45], v19 offset:8192
    ds_read_b64_tr_b16 a[46:47], v19 offset:9216
    s_add_u32 m0, s94, 7168
    s_nop 0
    buffer_load_dwordx4 v27, s[80:83], s96 offen lds
    s_waitcnt vmcnt(28) lgkmcnt(0)
    s_barrier
    ds_read_b64_tr_b16 a[48:49], v16 offset:12288
    ds_read_b64_tr_b16 a[50:51], v16 offset:13312
    s_add_u32 s96, s95, 1048576
    s_add_u32 m0, s94, 8192
    s_nop 0
    buffer_load_dwordx4 v24, s[80:83], s96 offen lds
    ds_read_b64_tr_b16 a[52:53], v17 offset:12288
    ds_read_b64_tr_b16 a[54:55], v17 offset:13312
    s_add_u32 m0, s94, 9216
    s_nop 0
    buffer_load_dwordx4 v25, s[80:83], s96 offen lds
    ds_read_b64_tr_b16 a[56:57], v18 offset:12288
    ds_read_b64_tr_b16 a[58:59], v18 offset:13312
    s_add_u32 m0, s94, 10240
    s_nop 0
    buffer_load_dwordx4 v26, s[80:83], s96 offen lds
    ds_read_b64_tr_b16 a[60:61], v19 offset:12288
    ds_read_b64_tr_b16 a[62:63], v19 offset:13312
    s_add_u32 m0, s94, 11264
    s_nop 0
    buffer_load_dwordx4 v27, s[80:83], s96 offen lds
    s_waitcnt vmcnt(28) lgkmcnt(0)
    s_barrier
    ds_read_b64_tr_b16 a[64:65], v16 offset:16384
    ds_read_b64_tr_b16 a[66:67], v16 offset:17408
    s_add_u32 s96, s95, 1572864
    s_add_u32 m0, s94, 12288
    s_nop 0
    buffer_load_dwordx4 v24, s[80:83], s96 offen lds
    ds_read_b64_tr_b16 a[68:69], v17 offset:16384
    ds_read_b64_tr_b16 a[70:71], v17 offset:17408
    s_add_u32 m0, s94, 13312
    s_nop 0
    buffer_load_dwordx4 v25, s[80:83], s96 offen lds
    ds_read_b64_tr_b16 a[72:73], v18 offset:16384
    ds_read_b64_tr_b16 a[74:75], v18 offset:17408
    s_add_u32 m0, s94, 14336
    s_nop 0
    buffer_load_dwordx4 v26, s[80:83], s96 offen lds
    ds_read_b64_tr_b16 a[76:77], v19 offset:16384
    ds_read_b64_tr_b16 a[78:79], v19 offset:17408
    s_add_u32 m0, s94, 15360
    s_nop 0
    buffer_load_dwordx4 v27, s[80:83], s96 offen lds
    s_waitcnt vmcnt(28) lgkmcnt(0)
    s_barrier
    ds_read_b64_tr_b16 a[80:81], v16 offset:20480
    ds_read_b64_tr_b16 a[82:83], v16 offset:21504
    s_add_u32 s96, s95, 2097152
    s_add_u32 m0, s94, 16384
    s_nop 0
    buffer_load_dwordx4 v24, s[80:83], s96 offen lds
    ds_read_b64_tr_b16 a[84:85], v17 offset:20480
    ds_read_b64_tr_b16 a[86:87], v17 offset:21504
    s_add_u32 m0, s94, 17408
    s_nop 0
    buffer_load_dwordx4 v25, s[80:83], s96 offen lds
    ds_read_b64_tr_b16 a[88:89], v18 offset:20480
    ds_read_b64_tr_b16 a[90:91], v18 offset:21504
    s_add_u32 m0, s94, 18432
    s_nop 0
    buffer_load_dwordx4 v26, s[80:83], s96 offen lds
    ds_read_b64_tr_b16 a[92:93], v19 offset:20480
    ds_read_b64_tr_b16 a[94:95], v19 offset:21504
    s_add_u32 m0, s94, 19456
    s_nop 0
    buffer_load_dwordx4 v27, s[80:83], s96 offen lds
    s_waitcnt vmcnt(28) lgkmcnt(0)
    s_barrier
    ds_read_b64_tr_b16 a[96:97], v16 offset:24576
    ds_read_b64_tr_b16 a[98:99], v16 offset:25600
    s_add_u32 s96, s95, 2621440
    s_add_u32 m0, s94, 20480
    s_nop 0
    buffer_load_dwordx4 v24, s[80:83], s96 offen lds
    ds_read_b64_tr_b16 a[100:101], v17 offset:24576
    ds_read_b64_tr_b16 a[102:103], v17 offset:25600
    s_add_u32 m0, s94, 21504
    s_nop 0
    buffer_load_dwordx4 v25, s[80:83], s96 offen lds
    ds_read_b64_tr_b16 a[104:105], v18 offset:24576
    ds_read_b64_tr_b16 a[106:107], v18 offset:25600
    s_add_u32 m0, s94, 22528
    s_nop 0
    buffer_load_dwordx4 v26, s[80:83], s96 offen lds
    ds_read_b64_tr_b16 a[108:109], v19 offset:24576
    ds_read_b64_tr_b16 a[110:111], v19 offset:25600
    s_add_u32 m0, s94, 23552
    s_nop 0
    buffer_load_dwordx4 v27, s[80:83], s96 offen lds
    s_waitcnt vmcnt(28) lgkmcnt(0)
    s_barrier
    ds_read_b64_tr_b16 a[112:113], v16 offset:28672
    ds_read_b64_tr_b16 a[114:115], v16 offset:29696
    s_add_u32 s96, s95, 3145728
    s_add_u32 m0, s94, 24576
    s_nop 0
    buffer_load_dwordx4 v24, s[80:83], s96 offen lds
    ds_read_b64_tr_b16 a[116:117], v17 offset:28672
    ds_read_b64_tr_b16 a[118:119], v17 offset:29696
    s_add_u32 m0, s94, 25600
    s_nop 0
    buffer_load_dwordx4 v25, s[80:83], s96 offen lds
    ds_read_b64_tr_b16 a[120:121], v18 offset:28672
    ds_read_b64_tr_b16 a[122:123], v18 offset:29696
    s_add_u32 m0, s94, 26624
    s_nop 0
    buffer_load_dwordx4 v26, s[80:83], s96 offen lds
    ds_read_b64_tr_b16 a[124:125], v19 offset:28672
    ds_read_b64_tr_b16 a[126:127], v19 offset:29696
    s_add_u32 m0, s94, 27648
    s_nop 0
    buffer_load_dwordx4 v27, s[80:83], s96 offen lds
    s_waitcnt vmcnt(28) lgkmcnt(0)
    s_barrier
    ds_read_b64_tr_b16 a[128:129], v16 offset:32768
    ds_read_b64_tr_b16 a[130:131], v16 offset:33792
    s_add_u32 s96, s95, 3670016
    s_add_u32 m0, s94, 28672
    s_nop 0
    buffer_load_dwordx4 v24, s[80:83], s96 offen lds
    ds_read_b64_tr_b16 a[132:133], v17 offset:32768
    ds_read_b64_tr_b16 a[134:135], v17 offset:33792
    s_add_u32 m0, s94, 29696
    s_nop 0
    buffer_load_dwordx4 v25, s[80:83], s96 offen lds
    ds_read_b64_tr_b16 a[136:137], v18 offset:32768
    ds_read_b64_tr_b16 a[138:139], v18 offset:33792
    s_add_u32 m0, s94, 30720
    s_nop 0
    buffer_load_dwordx4 v26, s[80:83], s96 offen lds
    ds_read_b64_tr_b16 a[140:141], v19 offset:32768
    ds_read_b64_tr_b16 a[142:143], v19 offset:33792
    s_add_u32 m0, s94, 31744
    s_nop 0
    buffer_load_dwordx4 v27, s[80:83], s96 offen lds
    s_waitcnt vmcnt(28) lgkmcnt(0)
    s_barrier
    ds_read_b64_tr_b16 a[144:145], v16 offset:0
    ds_read_b64_tr_b16 a[146:147], v16 offset:1024
    s_add_u32 s96, s95, 4194304
    s_add_u32 m0, s94, 32768
    s_nop 0
    buffer_load_dwordx4 v24, s[80:83], s96 offen lds
    ds_read_b64_tr_b16 a[148:149], v17 offset:0
    ds_read_b64_tr_b16 a[150:151], v17 offset:1024
    s_add_u32 m0, s94, 33792
    s_nop 0
    buffer_load_dwordx4 v25, s[80:83], s96 offen lds
    ds_read_b64_tr_b16 a[152:153], v18 offset:0
    ds_read_b64_tr_b16 a[154:155], v18 offset:1024
    s_add_u32 m0, s94, 34816
    s_nop 0
    buffer_load_dwordx4 v26, s[80:83], s96 offen lds
    ds_read_b64_tr_b16 a[156:157], v19 offset:0
    ds_read_b64_tr_b16 a[158:159], v19 offset:1024
    s_add_u32 m0, s94, 35840
    s_nop 0
    buffer_load_dwordx4 v27, s[80:83], s96 offen lds
    s_waitcnt vmcnt(28) lgkmcnt(0)
    s_barrier
    ds_read_b64_tr_b16 a[160:161], v16 offset:4096
    ds_read_b64_tr_b16 a[162:163], v16 offset:5120
    ds_read_b64_tr_b16 a[164:165], v17 offset:4096
    ds_read_b64_tr_b16 a[166:167], v17 offset:5120
    ds_read_b64_tr_b16 a[168:169], v18 offset:4096
    ds_read_b64_tr_b16 a[170:171], v18 offset:5120
    ds_read_b64_tr_b16 a[172:173], v19 offset:4096
    ds_read_b64_tr_b16 a[174:175], v19 offset:5120
    s_waitcnt vmcnt(24) lgkmcnt(0)
    s_barrier
    ds_read_b64_tr_b16 a[176:177], v16 offset:8192
    ds_read_b64_tr_b16 a[178:179], v16 offset:9216
    ds_read_b64_tr_b16 a[180:181], v17 offset:8192
    ds_read_b64_tr_b16 a[182:183], v17 offset:9216
    ds_read_b64_tr_b16 a[184:185], v18 offset:8192
    ds_read_b64_tr_b16 a[186:187], v18 offset:9216
    ds_read_b64_tr_b16 a[188:189], v19 offset:8192
    ds_read_b64_tr_b16 a[190:191], v19 offset:9216
    s_waitcnt vmcnt(20) lgkmcnt(0)
    s_barrier
    ds_read_b64_tr_b16 a[192:193], v16 offset:12288
    ds_read_b64_tr_b16 a[194:195], v16 offset:13312
    ds_read_b64_tr_b16 a[196:197], v17 offset:12288
    ds_read_b64_tr_b16 a[198:199], v17 offset:13312
    ds_read_b64_tr_b16 a[200:201], v18 offset:12288
    ds_read_b64_tr_b16 a[202:203], v18 offset:13312
    ds_read_b64_tr_b16 a[204:205], v19 offset:12288
    ds_read_b64_tr_b16 a[206:207], v19 offset:13312
    s_waitcnt vmcnt(16) lgkmcnt(0)
    s_barrier
    ds_read_b64_tr_b16 a[208:209], v16 offset:16384
    ds_read_b64_tr_b16 a[210:211], v16 offset:17408
    ds_read_b64_tr_b16 a[212:213], v17 offset:16384
    ds_read_b64_tr_b16 a[214:215], v17 offset:17408
    ds_read_b64_tr_b16 a[216:217], v18 offset:16384
    ds_read_b64_tr_b16 a[218:219], v18 offset:17408
    ds_read_b64_tr_b16 a[220:221], v19 offset:16384
    ds_read_b64_tr_b16 a[222:223], v19 offset:17408
    s_waitcnt vmcnt(12) lgkmcnt(0)
    s_barrier
    ds_read_b64_tr_b16 a[224:225], v16 offset:20480
    ds_read_b64_tr_b16 a[226:227], v16 offset:21504
    ds_read_b64_tr_b16 a[228:229], v17 offset:20480
    ds_read_b64_tr_b16 a[230:231], v17 offset:21504
    ds_read_b64_tr_b16 a[232:233], v18 offset:20480
    ds_read_b64_tr_b16 a[234:235], v18 offset:21504
    ds_read_b64_tr_b16 a[236:237], v19 offset:20480
    ds_read_b64_tr_b16 a[238:239], v19 offset:21504
    s_waitcnt vmcnt(8) lgkmcnt(0)
    s_barrier
    ds_read_b64_tr_b16 a[240:241], v16 offset:24576
    ds_read_b64_tr_b16 a[242:243], v16 offset:25600
    ds_read_b64_tr_b16 a[244:245], v17 offset:24576
    ds_read_b64_tr_b16 a[246:247], v17 offset:25600
    ds_read_b64_tr_b16 a[248:249], v18 offset:24576
    ds_read_b64_tr_b16 a[250:251], v18 offset:25600
    ds_read_b64_tr_b16 a[252:253], v19 offset:24576
    ds_read_b64_tr_b16 a[254:255], v19 offset:25600
    s_waitcnt vmcnt(4) lgkmcnt(0)
    s_barrier
    ds_read_b64_tr_b16 v[224:225], v16 offset:28672
    ds_read_b64_tr_b16 v[226:227], v16 offset:29696
    ds_read_b64_tr_b16 v[228:229], v17 offset:28672
    ds_read_b64_tr_b16 v[230:231], v17 offset:29696
    ds_read_b64_tr_b16 v[232:233], v18 offset:28672
    ds_read_b64_tr_b16 v[234:235], v18 offset:29696
    ds_read_b64_tr_b16 v[236:237], v19 offset:28672
    ds_read_b64_tr_b16 v[238:239], v19 offset:29696
    s_waitcnt vmcnt(0) lgkmcnt(0)
    s_barrier
    ds_read_b64_tr_b16 v[240:241], v16 offset:32768
    ds_read_b64_tr_b16 v[242:243], v16 offset:33792
    ds_read_b64_tr_b16 v[244:245], v17 offset:32768
    ds_read_b64_tr_b16 v[246:247], v17 offset:33792
    ds_read_b64_tr_b16 v[248:249], v18 offset:32768
    ds_read_b64_tr_b16 v[250:251], v18 offset:33792
    ds_read_b64_tr_b16 v[252:253], v19 offset:32768
    ds_read_b64_tr_b16 v[254:255], v19 offset:33792
    s_waitcnt lgkmcnt(0)
    s_barrier
    s_lshl_b32 s14, s12, 2
    s_add_u32 s14, s14, s6
    s_lshl_b32 s17, s14, 12
    s_mul_i32 s15, s13, 524288
    s_add_u32 s17, s17, s15
    s_add_u32 s17, s17, 16777216
    s_lshl_b32 s18, s14, 11
    s_mul_i32 s15, s13, 262144
    s_add_u32 s18, s18, s15
    s_add_u32 s18, s18, 52428800
    s_lshl_b32 s19, s14, 8
    s_lshl_b32 s15, s13, 2
    s_add_u32 s19, s19, s15
    s_add_u32 s19, s19, 1572864
    s_mov_b32 s23, 2130706432
    s_mul_i32 s20, s13, 36864
    s_lshl_b32 s21, s6, 10
    s_mov_b32 s22, 0
    v_mov_b32 v5, 0
    s_cmp_eq_u32 s3, 0
    s_cbranch_scc1 Q_la
    s_cmp_lg_u32 s6, 0
    s_cbranch_scc1 Q_la
    s_mov_b64 exec, 1
    v_mov_b32 v6, 32
    v_mov_b32 v7, 1
    global_atomic_add v6, v7, s[84:85]
    s_mov_b64 exec, -1
Q_la:
    s_add_u32 m0, s21, 0
    s_nop 0
    buffer_load_dwordx4 v3, s[24:27], s20 offen offset:0 lds
    s_add_u32 m0, s21, 3968
    s_nop 0
    buffer_load_dwordx4 v3, s[24:27], s20 offen offset:128 lds
    s_add_u32 m0, s21, 7936
    s_nop 0
    buffer_load_dwordx4 v3, s[24:27], s20 offen offset:256 lds
    s_add_u32 m0, s21, 11904
    s_nop 0
    buffer_load_dwordx4 v3, s[24:27], s20 offen offset:384 lds
    s_add_u32 m0, s21, 15872
    s_nop 0
    buffer_load_dwordx4 v3, s[24:27], s20 offen offset:512 lds
    s_add_u32 m0, s21, 19840
    s_nop 0
    buffer_load_dwordx4 v3, s[24:27], s20 offen offset:640 lds
    s_add_u32 m0, s21, 23808
    s_nop 0
    buffer_load_dwordx4 v3, s[24:27], s20 offen offset:768 lds
    s_add_u32 m0, s21, 27776
    s_nop 0
    buffer_load_dwordx4 v3, s[24:27], s20 offen offset:896 lds
    s_add_u32 m0, s21, 31744
    s_nop 0
    buffer_load_dwordx4 v3, s[24:27], s20 offen offset:1024 lds
    s_waitcnt vmcnt(0)
Q_loop:
    s_barrier
    s_xor_b32 s21, s21, 0x10000
    s_add_u32 s20, s20, 147456
    ds_read_b128 v[64:67], v2 offset:0
    ds_read_b128 v[68:71], v2 offset:512
    ds_read_b128 v[72:75], v2 offset:2048
    ds_read_b128 v[76:79], v2 offset:2560
    s_waitcnt lgkmcnt(3)
    v_mfma_f32_32x32x16_bf16 v[16:31], v[80:83], v[64:67], 0
    v_mfma_f32_32x32x16_bf16 v[32:47], a[0:3], v[64:67], 0
    v_mfma_f32_32x32x16_bf16 v[48:63], v[64:67], a[144:147], 0
    s_add_u32 m0, s21, 0
    s_nop 0
    buffer_load_dwordx4 v3, s[24:27], s20 offen offset:0 lds
    ds_read_b128 v[64:67], v2 offset:4096
    s_waitcnt lgkmcnt(3)
    v_mfma_f32_32x32x16_bf16 v[16:31], v[84:87], v[68:71], v[16:31]
    v_mfma_f32_32x32x16_bf16 v[32:47], a[4:7], v[68:71], v[32:47]
    v_mfma_f32_32x32x16_bf16 v[48:63], v[68:71], a[148:151], v[48:63]
    s_add_u32 m0, s21, 3968
    s_nop 0
    buffer_load_dwordx4 v3, s[24:27], s20 offen offset:128 lds
    ds_read_b128 v[68:71], v2 offset:4608
    s_waitcnt lgkmcnt(3)
    v_mfma_f32_32x32x16_bf16 v[16:31], v[88:91], v[72:75], v[16:31]
    v_mfma_f32_32x32x16_bf16 v[32:47], a[8:11], v[72:75], v[32:47]
    v_mfma_f32_32x32x16_bf16 v[48:63], v[72:75], a[152:155], v[48:63]
    s_add_u32 m0, s21, 7936
    s_nop 0
    buffer_load_dwordx4 v3, s[24:27], s20 offen offset:256 lds
    ds_read_b128 v[72:75], v2 offset:6144
    s_waitcnt lgkmcnt(3)
    v_mfma_f32_32x32x16_bf16 v[16:31], v[92:95], v[76:79], v[16:31]
    v_mfma_f32_32x32x16_bf16 v[32:47], a[12:15], v[76:79], v[32:47]
    v_mfma_f32_32x32x16_bf16 v[48:63], v[76:79], a[156:159], v[48:63]
    s_add_u32 m0, s21, 11904
    s_nop 0
    buffer_load_dwordx4 v3, s[24:27], s20 offen offset:384 lds
    ds_read_b128 v[76:79], v2 offset:6656
    s_waitcnt lgkmcnt(3)
    v_mfma_f32_32x32x16_bf16 v[16:31], v[96:99], v[64:67], v[16:31]
    v_mfma_f32_32x32x16_bf16 v[32:47], a[16:19], v[64:67], v[32:47]
    v_mfma_f32_32x32x16_bf16 v[48:63], v[64:67], a[160:163], v[48:63]
    s_add_u32 m0, s21, 15872
    s_nop 0
    buffer_load_dwordx4 v3, s[24:27], s20 offen offset:512 lds
    ds_read_b128 v[64:67], v2 offset:8192
    s_waitcnt lgkmcnt(3)
    v_mfma_f32_32x32x16_bf16 v[16:31], v[100:103], v[68:71], v[16:31]
    v_mfma_f32_32x32x16_bf16 v[32:47], a[20:23], v[68:71], v[32:47]
    v_mfma_f32_32x32x16_bf16 v[48:63], v[68:71], a[164:167], v[48:63]
    s_add_u32 m0, s21, 19840
    s_nop 0
    buffer_load_dwordx4 v3, s[24:27], s20 offen offset:640 lds
    ds_read_b128 v[68:71], v2 offset:8704
    s_waitcnt lgkmcnt(3)
    v_mfma_f32_32x32x16_bf16 v[16:31], v[104:107], v[72:75], v[16:31]
    v_mfma_f32_32x32x16_bf16 v[32:47], a[24:27], v[72:75], v[32:47]
    v_mfma_f32_32x32x16_bf16 v[48:63], v[72:75], a[168:171], v[48:63]
    s_add_u32 m0, s21, 23808
    s_nop 0
    buffer_load_dwordx4 v3, s[24:27], s20 offen offset:768 lds
    ds_read_b128 v[72:75], v2 offset:10240
    s_waitcnt lgkmcnt(3)
    v_mfma_f32_32x32x16_bf16 v[16:31], v[108:111], v[76:79], v[16:31]
    v_mfma_f32_32x32x16_bf16 v[32:47], a[28:31], v[76:79], v[32:47]
    v_mfma_f32_32x32x16_bf16 v[48:63], v[76:79], a[172:175], v[48:63]
    s_add_u32 m0, s21, 27776
    s_nop 0
    buffer_load_dwordx4 v3, s[24:27], s20 offen offset:896 lds
    ds_read_b128 v[76:79], v2 offset:10752
    s_waitcnt lgkmcnt(3)
    v_mfma_f32_32x32x16_bf16 v[16:31], v[112:115], v[64:67], v[16:31]
    v_mfma_f32_32x32x16_bf16 v[32:47], a[32:35], v[64:67], v[32:47]
    v_mfma_f32_32x32x16_bf16 v[48:63], v[64:67], a[176:179], v[48:63]
    s_add_u32 m0, s21, 31744
    s_nop 0
    buffer_load_dwordx4 v3, s[24:27], s20 offen offset:1024 lds
    ds_read_b128 v[64:67], v2 offset:12288
    s_waitcnt lgkmcnt(3)
    v_mfma_f32_32x32x16_bf16 v[16:31], v[116:119], v[68:71], v[16:31]
    v_mfma_f32_32x32x16_bf16 v[32:47], a[36:39], v[68:71], v[32:47]
    v_mfma_f32_32x32x16_bf16 v[48:63], v[68:71], a[180:183], v[48:63]
    ds_read_b128 v[68:71], v2 offset:12800
    s_waitcnt lgkmcnt(3)
    v_mfma_f32_32x32x16_bf16 v[16:31], v[120:123], v[72:75], v[16:31]
    v_mfma_f32_32x32x16_bf16 v[32:47], a[40:43], v[72:75], v[32:47]
    v_mfma_f32_32x32x16_bf16 v[48:63], v[72:75], a[184:187], v[48:63]
    ds_read_b128 v[72:75], v2 offset:14336
    s_waitcnt lgkmcnt(3)
    v_mfma_f32_32x32x16_bf16 v[16:31], v[124:127], v[76:79], v[16:31]
    v_mfma_f32_32x32x16_bf16 v[32:47], a[44:47], v[76:79], v[32:47]
    v_mfma_f32_32x32x16_bf16 v[48:63], v[76:79], a[188:191], v[48:63]
    ds_read_b128 v[76:79], v2 offset:14848
    s_waitcnt lgkmcnt(3)
    v_mfma_f32_32x32x16_bf16 v[16:31], v[128:131], v[64:67], v[16:31]
    v_mfma_f32_32x32x16_bf16 v[32:47], a[48:51], v[64:67], v[32:47]
    v_mfma_f32_32x32x16_bf16 v[48:63], v[64:67], a[192:195], v[48:63]
    ds_read_b128 v[64:67], v2 offset:16384
    s_waitcnt lgkmcnt(3)
    v_mfma_f32_32x32x16_bf16 v[16:31], v[132:135], v[68:71], v[16:31]
    v_mfma_f32_32x32x16_bf16 v[32:47], a[52:55], v[68:71], v[32:47]
    v_mfma_f32_32x32x16_bf16 v[48:63], v[68:71], a[196:199], v[48:63]
    ds_read_b128 v[68:71], v2 offset:16896
    s_waitcnt lgkmcnt(3)
    v_mfma_f32_32x32x16_bf16 v[16:31], v[136:139], v[72:75], v[16:31]
    v_mfma_f32_32x32x16_bf16 v[32:47], a[56:59], v[72:75], v[32:47]
    v_mfma_f32_32x32x16_bf16 v[48:63], v[72:75], a[200:203], v[48:63]
    ds_read_b128 v[72:75], v2 offset:18432
    s_waitcnt lgkmcnt(3)
    v_mfma_f32_32x32x16_bf16 v[16:31], v[140:143], v[76:79], v[16:31]
    v_mfma_f32_32x32x16_bf16 v[32:47], a[60:63], v[76:79], v[32:47]
    v_mfma_f32_32x32x16_bf16 v[48:63], v[76:79], a[204:207], v[48:63]
    ds_read_b128 v[76:79], v2 offset:18944
    s_waitcnt lgkmcnt(3)
    v_mfma_f32_32x32x16_bf16 v[16:31], v[144:147], v[64:67], v[16:31]
    v_mfma_f32_32x32x16_bf16 v[32:47], a[64:67], v[64:67], v[32:47]
    v_mfma_f32_32x32x16_bf16 v[48:63], v[64:67], a[208:211], v[48:63]
    ds_read_b128 v[64:67], v2 offset:20480
    s_waitcnt lgkmcnt(3)
    v_mfma_f32_32x32x16_bf16 v[16:31], v[148:151], v[68:71], v[16:31]
    v_mfma_f32_32x32x16_bf16 v[32:47], a[68:71], v[68:71], v[32:47]
    v_mfma_f32_32x32x16_bf16 v[48:63], v[68:71], a[212:215], v[48:63]
    ds_read_b128 v[68:71], v2 offset:20992
    s_waitcnt lgkmcnt(3)
    v_mfma_f32_32x32x16_bf16 v[16:31], v[152:155], v[72:75], v[16:31]
    v_mfma_f32_32x32x16_bf16 v[32:47], a[72:75], v[72:75], v[32:47]
    v_mfma_f32_32x32x16_bf16 v[48:63], v[72:75], a[216:219], v[48:63]
    s_waitcnt vmcnt(9)
    s_mov_b64 exec, 1
    buffer_store_dword v4, v5, s[8:11], s23 offen sc1
    s_mov_b64 exec, -1
    ds_read_b128 v[72:75], v2 offset:22528
    s_waitcnt lgkmcnt(3)
    v_mfma_f32_32x32x16_bf16 v[16:31], v[156:159], v[76:79], v[16:31]
    v_mfma_f32_32x32x16_bf16 v[32:47], a[76:79], v[76:79], v[32:47]
    v_mfma_f32_32x32x16_bf16 v[48:63], v[76:79], a[220:223], v[48:63]
    ds_read_b128 v[76:79], v2 offset:23040
    s_waitcnt lgkmcnt(3)
    v_mfma_f32_32x32x16_bf16 v[16:31], v[160:163], v[64:67], v[16:31]
    v_mfma_f32_32x32x16_bf16 v[32:47], a[80:83], v[64:67], v[32:47]
    v_mfma_f32_32x32x16_bf16 v[48:63], v[64:67], a[224:227], v[48:63]
    ds_read_b128 v[64:67], v2 offset:24576
    s_waitcnt lgkmcnt(3)
    v_mfma_f32_32x32x16_bf16 v[16:31], v[164:167], v[68:71], v[16:31]
    v_mfma_f32_32x32x16_bf16 v[32:47], a[84:87], v[68:71], v[32:47]
    v_mfma_f32_32x32x16_bf16 v[48:63], v[68:71], a[228:231], v[48:63]
    ds_read_b128 v[68:71], v2 offset:25088
    s_waitcnt lgkmcnt(3)
    v_mfma_f32_32x32x16_bf16 v[16:31], v[168:171], v[72:75], v[16:31]
    v_mfma_f32_32x32x16_bf16 v[32:47], a[88:91], v[72:75], v[32:47]
    v_mfma_f32_32x32x16_bf16 v[48:63], v[72:75], a[232:235], v[48:63]
    ds_read_b128 v[72:75], v2 offset:26624
    s_waitcnt lgkmcnt(3)
    v_mfma_f32_32x32x16_bf16 v[16:31], v[172:175], v[76:79], v[16:31]
    v_mfma_f32_32x32x16_bf16 v[32:47], a[92:95], v[76:79], v[32:47]
    v_mfma_f32_32x32x16_bf16 v[48:63], v[76:79], a[236:239], v[48:63]
    ds_read_b128 v[76:79], v2 offset:27136
    s_waitcnt lgkmcnt(3)
    v_mfma_f32_32x32x16_bf16 v[16:31], v[176:179], v[64:67], v[16:31]
    v_mfma_f32_32x32x16_bf16 v[32:47], a[96:99], v[64:67], v[32:47]
    v_mfma_f32_32x32x16_bf16 v[48:63], v[64:67], a[240:243], v[48:63]
    ds_read_b128 v[64:67], v2 offset:28672
    s_waitcnt lgkmcnt(3)
    v_mfma_f32_32x32x16_bf16 v[16:31], v[180:183], v[68:71], v[16:31]
    v_mfma_f32_32x32x16_bf16 v[32:47], a[100:103], v[68:71], v[32:47]
    v_mfma_f32_32x32x16_bf16 v[48:63], v[68:71], a[244:247], v[48:63]
    ds_read_b128 v[68:71], v2 offset:29184
    s_waitcnt lgkmcnt(3)
    v_mfma_f32_32x32x16_bf16 v[16:31], v[184:187], v[72:75], v[16:31]
    v_mfma_f32_32x32x16_bf16 v[32:47], a[104:107], v[72:75], v[32:47]
    v_mfma_f32_32x32x16_bf16 v[48:63], v[72:75], a[248:251], v[48:63]
    ds_read_b128 v[72:75], v2 offset:30720
    s_waitcnt lgkmcnt(3)
    v_mfma_f32_32x32x16_bf16 v[16:31], v[188:191], v[76:79], v[16:31]
    v_mfma_f32_32x32x16_bf16 v[32:47], a[108:111], v[76:79], v[32:47]
    v_mfma_f32_32x32x16_bf16 v[48:63], v[76:79], a[252:255], v[48:63]
    ds_read_b128 v[76:79], v2 offset:31232
    s_waitcnt lgkmcnt(3)
    v_mfma_f32_32x32x16_bf16 v[16:31], v[192:195], v[64:67], v[16:31]
    v_mfma_f32_32x32x16_bf16 v[32:47], a[112:115], v[64:67], v[32:47]
    v_mfma_f32_32x32x16_bf16 v[48:63], v[64:67], v[224:227], v[48:63]
    ds_read_b128 v[64:67], v2 offset:32768
    s_waitcnt lgkmcnt(3)
    v_mfma_f32_32x32x16_bf16 v[16:31], v[196:199], v[68:71], v[16:31]
    v_mfma_f32_32x32x16_bf16 v[32:47], a[116:119], v[68:71], v[32:47]
    v_mfma_f32_32x32x16_bf16 v[48:63], v[68:71], v[228:231], v[48:63]
    ds_read_b128 v[68:71], v2 offset:33280
    s_waitcnt lgkmcnt(3)
    v_mfma_f32_32x32x16_bf16 v[16:31], v[200:203], v[72:75], v[16:31]
    v_mfma_f32_32x32x16_bf16 v[32:47], a[120:123], v[72:75], v[32:47]
    v_mfma_f32_32x32x16_bf16 v[48:63], v[72:75], v[232:235], v[48:63]
    ds_read_b128 v[72:75], v2 offset:34816
    s_waitcnt lgkmcnt(3)
    v_mfma_f32_32x32x16_bf16 v[16:31], v[204:207], v[76:79], v[16:31]
    v_mfma_f32_32x32x16_bf16 v[32:47], a[124:127], v[76:79], v[32:47]
    v_mfma_f32_32x32x16_bf16 v[48:63], v[76:79], v[236:239], v[48:63]
    ds_read_b128 v[76:79], v2 offset:35328
    s_waitcnt lgkmcnt(3)
    v_mfma_f32_32x32x16_bf16 v[16:31], v[208:211], v[64:67], v[16:31]
    v_mfma_f32_32x32x16_bf16 v[32:47], a[128:131], v[64:67], v[32:47]
    v_mfma_f32_32x32x16_bf16 v[48:63], v[64:67], v[240:243], v[48:63]
    s_waitcnt lgkmcnt(2)
    v_mfma_f32_32x32x16_bf16 v[16:31], v[212:215], v[68:71], v[16:31]
    v_mfma_f32_32x32x16_bf16 v[32:47], a[132:135], v[68:71], v[32:47]
    v_mfma_f32_32x32x16_bf16 v[48:63], v[68:71], v[244:247], v[48:63]
    s_waitcnt lgkmcnt(1)
    v_mfma_f32_32x32x16_bf16 v[16:31], v[216:219], v[72:75], v[16:31]
    v_mfma_f32_32x32x16_bf16 v[32:47], a[136:139], v[72:75], v[32:47]
    v_mfma_f32_32x32x16_bf16 v[48:63], v[72:75], v[248:251], v[48:63]
    s_waitcnt lgkmcnt(0)
    v_mfma_f32_32x32x16_bf16 v[16:31], v[220:223], v[76:79], v[16:31]
    v_mfma_f32_32x32x16_bf16 v[32:47], a[140:143], v[76:79], v[32:47]
    v_mfma_f32_32x32x16_bf16 v[48:63], v[76:79], v[252:255], v[48:63]
    v_xor_b32 v2, 0x10000, v2
    v_cvt_pk_bf16_f32 v16, v16, v17
    v_cvt_pk_bf16_f32 v17, v18, v19
    v_cvt_pk_bf16_f32 v18, v24, v25
    v_cvt_pk_bf16_f32 v19, v26, v27
    v_cvt_pk_bf16_f32 v20, v20, v21
    v_cvt_pk_bf16_f32 v21, v22, v23
    v_cvt_pk_bf16_f32 v22, v28, v29
    v_cvt_pk_bf16_f32 v23, v30, v31
    buffer_store_dwordx4 v[16:19], v1, s[8:11], s18 offen offset:0 sc1
    buffer_store_dwordx4 v[20:23], v1, s[8:11], s18 offen offset:512 sc1
    v_cvt_pk_bf16_f32 v32, v32, v33
    v_cvt_pk_bf16_f32 v33, v34, v35
    v_cvt_pk_bf16_f32 v34, v40, v41
    v_cvt_pk_bf16_f32 v35, v42, v43
    v_cvt_pk_bf16_f32 v36, v36, v37
    v_cvt_pk_bf16_f32 v37, v38, v39
    v_cvt_pk_bf16_f32 v38, v44, v45
    v_cvt_pk_bf16_f32 v39, v46, v47
    buffer_store_dwordx4 v[32:35], v1, s[8:11], s17 offen offset:0 sc1
    buffer_store_dwordx4 v[36:39], v1, s[8:11], s17 offen offset:512 sc1
    v_cvt_pk_bf16_f32 v48, v48, v49
    v_cvt_pk_bf16_f32 v49, v50, v51
    v_cvt_pk_bf16_f32 v50, v56, v57
    v_cvt_pk_bf16_f32 v51, v58, v59
    v_cvt_pk_bf16_f32 v52, v52, v53
    v_cvt_pk_bf16_f32 v53, v54, v55
    v_cvt_pk_bf16_f32 v54, v60, v61
    v_cvt_pk_bf16_f32 v55, v62, v63
    buffer_store_dwordx4 v[48:51], v1, s[8:11], s17 offen offset:2048 sc1
    buffer_store_dwordx4 v[52:55], v1, s[8:11], s17 offen offset:2560 sc1
    s_mov_b32 s23, s19
    s_add_u32 s19, s19, 16
    s_add_u32 s17, s17, 2097152
    s_add_u32 s18, s18, 1048576
    s_add_u32 s22, s22, 1
    s_cmp_lt_u32 s22, 16
    s_waitcnt vmcnt(6)
    s_cbranch_scc1 Q_loop
    s_waitcnt vmcnt(0)
    s_mov_b64 exec, 1
    buffer_store_dword v4, v5, s[8:11], s23 offen sc1
    s_mov_b64 exec, -1
    s_waitcnt vmcnt(0)
    s_barrier
    v_and_b32 v12, 63, v0
    v_lshlrev_b32 v6, 4, v12
    v_lshrrev_b32 v13, 4, v12
    v_lshlrev_b32 v7, 7, v13
    v_and_b32 v13, 7, v12
    v_lshl_add_u32 v7, v13, 4, v7
    v_bfe_u32 v14, v12, 3, 1
    v_lshl_add_u32 v7, v14, 3, v7
    s_mul_i32 s14, s6, 2304
    v_add_u32 v7, s14, v7
    v_lshrrev_b32 v14, 5, v12
    v_lshlrev_b32 v8, 7, v14
    v_lshl_add_u32 v8, v13, 4, v8
    s_lshl_b32 s14, s6, 9
    v_add_u32 v9, s14, v8
    v_bfe_u32 v13, v12, 4, 1
    v_lshlrev_b32 v10, 17, v13
    v_lshl_add_u32 v10, v14, 8, v10
    v_and_b32 v13, 15, v12
    v_lshl_add_u32 v10, v13, 4, v10
    v_and_b32 v13, 31, v12
    v_lshlrev_b32 v14, 2, v14
    v_sub_u32 v13, v13, v14
    s_mov_b32 s64, 0x3e0293ee
    s_mov_b32 s65, 0x3e0293ee
    s_mov_b32 s63, 0
    v_cmp_le_i32 s[28:29], 0, v13
    v_cmp_le_i32 s[30:31], 1, v13
    v_cmp_le_i32 s[32:33], 2, v13
    v_cmp_le_i32 s[34:35], 3, v13
    v_cmp_le_i32 s[36:37], 8, v13
    v_cmp_le_i32 s[38:39], 9, v13
    v_cmp_le_i32 s[40:41], 10, v13
    v_cmp_le_i32 s[42:43], 11, v13
    v_cmp_le_i32 s[44:45], 16, v13
    v_cmp_le_i32 s[46:47], 17, v13
    v_cmp_le_i32 s[48:49], 18, v13
    v_cmp_le_i32 s[50:51], 19, v13
    v_cmp_le_i32 s[52:53], 24, v13
    v_cmp_le_i32 s[54:55], 25, v13
    v_cmp_le_i32 s[56:57], 26, v13
    v_cmp_le_i32 s[58:59], 27, v13
    s_mul_i32 s66, s13, 524288
    s_lshl_b32 s14, s12, 14
    s_add_u32 s66, s66, s14
    s_add_u32 s66, s66, 16777216
    s_mul_i32 s70, s13, 262144
    s_lshl_b32 s14, s12, 13
    s_add_u32 s70, s70, s14
    s_add_u32 s70, s70, 52428800
    s_mul_i32 s60, s13, 32768
    s_mul_i32 s14, s6, 4608
    s_add_u32 s60, s60, s14
    s_add_u32 s60, s60, 4194304
    s_lshl_b32 s14, s12, 2
    s_add_u32 s14, s14, s6
    s_lshl_b32 s61, s14, 10
    s_lshl_b32 s15, s13, 18
    s_add_u32 s61, s61, s15
    s_add_u32 s61, s61, 85983232
    s_lshl_b32 s62, s14, 6
    s_lshl_b32 s15, s13, 13
    s_add_u32 s62, s62, s15
    s_add_u32 s62, s62, 7340032
    s_mov_b32 s22, 0
A_loop:
    s_add_u32 s67, s66, 4096
    s_add_u32 s68, s66, 8192
    s_add_u32 s69, s66, 12288
    s_add_u32 s71, s70, 4096
    s_lshl_b32 s14, s6, 12
    s_add_u32 s14, s14, s66
    buffer_load_dwordx4 v[80:83], v1, s[8:11], s70 offen offset:0 sc1
    buffer_load_dwordx4 v[112:115], v1, s[8:11], s66 offen offset:0 sc1
    buffer_load_dwordx4 v[84:87], v1, s[8:11], s70 offen offset:512 sc1
    buffer_load_dwordx4 v[116:119], v1, s[8:11], s66 offen offset:512 sc1
    buffer_load_dwordx4 v[88:91], v1, s[8:11], s70 offen offset:2048 sc1
    buffer_load_dwordx4 v[120:123], v1, s[8:11], s67 offen offset:0 sc1
    buffer_load_dwordx4 v[92:95], v1, s[8:11], s70 offen offset:2560 sc1
    buffer_load_dwordx4 v[124:127], v1, s[8:11], s67 offen offset:512 sc1
    buffer_load_dwordx4 v[96:99], v1, s[8:11], s71 offen offset:0 sc1
    buffer_load_dwordx4 v[128:131], v1, s[8:11], s68 offen offset:0 sc1
    buffer_load_dwordx4 v[100:103], v1, s[8:11], s71 offen offset:512 sc1
    buffer_load_dwordx4 v[132:135], v1, s[8:11], s68 offen offset:512 sc1
    buffer_load_dwordx4 v[104:107], v1, s[8:11], s71 offen offset:2048 sc1
    buffer_load_dwordx4 v[136:139], v1, s[8:11], s69 offen offset:0 sc1
    buffer_load_dwordx4 v[108:111], v1, s[8:11], s71 offen offset:2560 sc1
    buffer_load_dwordx4 v[140:143], v1, s[8:11], s69 offen offset:512 sc1
    buffer_load_dwordx4 v[144:147], v1, s[8:11], s14 offen offset:2048 sc1
    buffer_load_dwordx4 v[148:151], v1, s[8:11], s14 offen offset:2560 sc1
    s_waitcnt vmcnt(16)
    v_mfma_f32_32x32x16_bf16 v[152:167], v[112:115], v[80:83], 0
    s_waitcnt vmcnt(14)
    v_mfma_f32_32x32x16_bf16 v[152:167], v[116:119], v[84:87], v[152:167]
    s_waitcnt vmcnt(12)
    v_mfma_f32_32x32x16_bf16 v[152:167], v[120:123], v[88:91], v[152:167]
    s_waitcnt vmcnt(10)
    v_mfma_f32_32x32x16_bf16 v[152:167], v[124:127], v[92:95], v[152:167]
    s_waitcnt vmcnt(8)
    v_mfma_f32_32x32x16_bf16 v[152:167], v[128:131], v[96:99], v[152:167]
    s_waitcnt vmcnt(6)
    v_mfma_f32_32x32x16_bf16 v[152:167], v[132:135], v[100:103], v[152:167]
    s_waitcnt vmcnt(4)
    v_mfma_f32_32x32x16_bf16 v[152:167], v[136:139], v[104:107], v[152:167]
    s_waitcnt vmcnt(2)
    v_mfma_f32_32x32x16_bf16 v[152:167], v[140:143], v[108:111], v[152:167]
    s_sub_u32 s15, s60, 32768
    s_cmp_lt_u32 s15, 4194304
    s_cselect_b32 s15, s60, s15
A_lp:
    s_mov_b64 exec, 1
    buffer_load_dword v170, v6, s[8:11], s15 offen offset:3576 sc1
    s_waitcnt vmcnt(0)
    v_cmp_ne_u32 vcc, v4, v170
    s_mov_b64 exec, -1
    s_add_u32 s63, s63, 1
    s_cmp_gt_u32 s63, 0x80000
    s_cbranch_scc1 A_fp
    s_cbranch_vccz A_fp
    s_sleep 4
    s_branch A_lp
A_fp:
    buffer_load_dwordx4 v[168:171], v6, s[8:11], s60 offen offset:0 sc1
    buffer_load_dwordx4 v[172:175], v6, s[8:11], s60 offen offset:1024 sc1
    buffer_load_dwordx4 v[176:179], v6, s[8:11], s60 offen offset:2048 sc1
    buffer_load_dwordx4 v[180:183], v6, s[8:11], s60 offen offset:3072 sc1
    v_mov_b32 v186, v4
    s_add_u32 s14, s60, 4096
    s_mov_b32 exec_hi, 0
    buffer_load_dwordx4 v[184:187], v6, s[8:11], s14 offen sc1
    s_mov_b64 exec, -1
    s_waitcnt vmcnt(0)
    v_xor_b32 v12, v4, v170
    v_xor_b32 v13, v4, v174
    v_xor_b32 v14, v4, v178
    v_or3_b32 v12, v12, v13, v14
    v_xor_b32 v13, v4, v182
    v_xor_b32 v14, v4, v186
    v_or3_b32 v12, v12, v13, v14
    v_cmp_ne_u32 vcc, 0, v12
    s_add_u32 s63, s63, 1
    s_cmp_gt_u32 s63, 0x80000
    s_cbranch_scc1 A_fd
    s_cbranch_vccnz A_fp
A_fd:
    ds_write_b64 v7, v[168:169] offset:0
    ds_write_b64 v7, v[172:173] offset:512
    ds_write_b64 v7, v[176:177] offset:1024
    ds_write_b64 v7, v[180:181] offset:1536
    s_mov_b32 exec_hi, 0
    ds_write_b64 v7, v[184:185] offset:2048
    s_mov_b64 exec, -1
    v_mov_b32 v14, 0xff800000
    v_cndmask_b32 v152, v14, v152, s[28:29]
    v_cndmask_b32 v153, v14, v153, s[30:31]
    v_cndmask_b32 v154, v14, v154, s[32:33]
    v_cndmask_b32 v155, v14, v155, s[34:35]
    v_cndmask_b32 v156, v14, v156, s[36:37]
    v_cndmask_b32 v157, v14, v157, s[38:39]
    v_cndmask_b32 v158, v14, v158, s[40:41]
    v_cndmask_b32 v159, v14, v159, s[42:43]
    v_cndmask_b32 v160, v14, v160, s[44:45]
    v_cndmask_b32 v161, v14, v161, s[46:47]
    v_cndmask_b32 v162, v14, v162, s[48:49]
    v_cndmask_b32 v163, v14, v163, s[50:51]
    v_cndmask_b32 v164, v14, v164, s[52:53]
    v_cndmask_b32 v165, v14, v165, s[54:55]
    v_cndmask_b32 v166, v14, v166, s[56:57]
    v_cndmask_b32 v167, v14, v167, s[58:59]
    s_waitcnt lgkmcnt(0)
    s_barrier
    ds_read_b128 v[64:67], v8 offset:0
    ds_read_b128 v[68:71], v8 offset:256
    ds_read_b128 v[72:75], v8 offset:512
    ds_read_b128 v[76:79], v8 offset:768
    s_waitcnt lgkmcnt(3)
    v_mfma_f32_32x32x16_bf16 v[32:47], a[0:3], v[64:67], 0
    v_mfma_f32_32x32x16_bf16 v[48:63], v[64:67], a[144:147], 0
    ds_read_b128 v[64:67], v8 offset:1024
    s_waitcnt lgkmcnt(3)
    v_mfma_f32_32x32x16_bf16 v[32:47], a[4:7], v[68:71], v[32:47]
    v_mfma_f32_32x32x16_bf16 v[48:63], v[68:71], a[148:151], v[48:63]
    ds_read_b128 v[68:71], v8 offset:1280
    s_waitcnt lgkmcnt(3)
    v_mfma_f32_32x32x16_bf16 v[32:47], a[8:11], v[72:75], v[32:47]
    v_mfma_f32_32x32x16_bf16 v[48:63], v[72:75], a[152:155], v[48:63]
    ds_read_b128 v[72:75], v8 offset:1536
    s_waitcnt lgkmcnt(3)
    v_mfma_f32_32x32x16_bf16 v[32:47], a[12:15], v[76:79], v[32:47]
    v_mfma_f32_32x32x16_bf16 v[48:63], v[76:79], a[156:159], v[48:63]
    ds_read_b128 v[76:79], v8 offset:1792
    s_waitcnt lgkmcnt(3)
    v_mfma_f32_32x32x16_bf16 v[32:47], a[16:19], v[64:67], v[32:47]
    v_mfma_f32_32x32x16_bf16 v[48:63], v[64:67], a[160:163], v[48:63]
    ds_read_b128 v[64:67], v8 offset:2048
    s_waitcnt lgkmcnt(3)
    v_mfma_f32_32x32x16_bf16 v[32:47], a[20:23], v[68:71], v[32:47]
    v_mfma_f32_32x32x16_bf16 v[48:63], v[68:71], a[164:167], v[48:63]
    ds_read_b128 v[68:71], v8 offset:2304
    s_waitcnt lgkmcnt(3)
    v_mfma_f32_32x32x16_bf16 v[32:47], a[24:27], v[72:75], v[32:47]
    v_mfma_f32_32x32x16_bf16 v[48:63], v[72:75], a[168:171], v[48:63]
    ds_read_b128 v[72:75], v8 offset:2560
    s_waitcnt lgkmcnt(3)
    v_mfma_f32_32x32x16_bf16 v[32:47], a[28:31], v[76:79], v[32:47]
    v_mfma_f32_32x32x16_bf16 v[48:63], v[76:79], a[172:175], v[48:63]
    ds_read_b128 v[76:79], v8 offset:2816
    s_waitcnt lgkmcnt(3)
    v_mfma_f32_32x32x16_bf16 v[32:47], a[32:35], v[64:67], v[32:47]
    v_mfma_f32_32x32x16_bf16 v[48:63], v[64:67], a[176:179], v[48:63]
    ds_read_b128 v[64:67], v8 offset:3072
    s_waitcnt lgkmcnt(3)
    v_mfma_f32_32x32x16_bf16 v[32:47], a[36:39], v[68:71], v[32:47]
    v_mfma_f32_32x32x16_bf16 v[48:63], v[68:71], a[180:183], v[48:63]
    ds_read_b128 v[68:71], v8 offset:3328
    s_waitcnt lgkmcnt(3)
    v_mfma_f32_32x32x16_bf16 v[32:47], a[40:43], v[72:75], v[32:47]
    v_mfma_f32_32x32x16_bf16 v[48:63], v[72:75], a[184:187], v[48:63]
    ds_read_b128 v[72:75], v8 offset:3584
    s_waitcnt lgkmcnt(3)
    v_mfma_f32_32x32x16_bf16 v[32:47], a[44:47], v[76:79], v[32:47]
    v_mfma_f32_32x32x16_bf16 v[48:63], v[76:79], a[188:191], v[48:63]
    ds_read_b128 v[76:79], v8 offset:3840
    s_waitcnt lgkmcnt(3)
    v_mfma_f32_32x32x16_bf16 v[32:47], a[48:51], v[64:67], v[32:47]
    v_mfma_f32_32x32x16_bf16 v[48:63], v[64:67], a[192:195], v[48:63]
    ds_read_b128 v[64:67], v8 offset:4096
    s_waitcnt lgkmcnt(3)
    v_mfma_f32_32x32x16_bf16 v[32:47], a[52:55], v[68:71], v[32:47]
    v_mfma_f32_32x32x16_bf16 v[48:63], v[68:71], a[196:199], v[48:63]
    ds_read_b128 v[68:71], v8 offset:4352
    s_waitcnt lgkmcnt(3)
    v_mfma_f32_32x32x16_bf16 v[32:47], a[56:59], v[72:75], v[32:47]
    v_mfma_f32_32x32x16_bf16 v[48:63], v[72:75], a[200:203], v[48:63]
    ds_read_b128 v[72:75], v8 offset:4608
    s_waitcnt lgkmcnt(3)
    v_mfma_f32_32x32x16_bf16 v[32:47], a[60:63], v[76:79], v[32:47]
    v_mfma_f32_32x32x16_bf16 v[48:63], v[76:79], a[204:207], v[48:63]
    ds_read_b128 v[76:79], v8 offset:4864
    s_waitcnt lgkmcnt(3)
    v_mfma_f32_32x32x16_bf16 v[32:47], a[64:67], v[64:67], v[32:47]
    v_mfma_f32_32x32x16_bf16 v[48:63], v[64:67], a[208:211], v[48:63]
    ds_read_b128 v[64:67], v8 offset:5120
    s_waitcnt lgkmcnt(3)
    v_mfma_f32_32x32x16_bf16 v[32:47], a[68:71], v[68:71], v[32:47]
    v_mfma_f32_32x32x16_bf16 v[48:63], v[68:71], a[212:215], v[48:63]
    ds_read_b128 v[68:71], v8 offset:5376
    s_waitcnt lgkmcnt(3)
    v_mfma_f32_32x32x16_bf16 v[32:47], a[72:75], v[72:75], v[32:47]
    v_mfma_f32_32x32x16_bf16 v[48:63], v[72:75], a[216:219], v[48:63]
    ds_read_b128 v[72:75], v8 offset:5632
    s_waitcnt lgkmcnt(3)
    v_mfma_f32_32x32x16_bf16 v[32:47], a[76:79], v[76:79], v[32:47]
    v_mfma_f32_32x32x16_bf16 v[48:63], v[76:79], a[220:223], v[48:63]
    ds_read_b128 v[76:79], v8 offset:5888
    s_waitcnt lgkmcnt(3)
    v_mfma_f32_32x32x16_bf16 v[32:47], a[80:83], v[64:67], v[32:47]
    v_mfma_f32_32x32x16_bf16 v[48:63], v[64:67], a[224:227], v[48:63]
    ds_read_b128 v[64:67], v8 offset:6144
    s_waitcnt lgkmcnt(3)
    v_mfma_f32_32x32x16_bf16 v[32:47], a[84:87], v[68:71], v[32:47]
    v_mfma_f32_32x32x16_bf16 v[48:63], v[68:71], a[228:231], v[48:63]
    ds_read_b128 v[68:71], v8 offset:6400
    s_waitcnt lgkmcnt(3)
    v_mfma_f32_32x32x16_bf16 v[32:47], a[88:91], v[72:75], v[32:47]
    v_mfma_f32_32x32x16_bf16 v[48:63], v[72:75], a[232:235], v[48:63]
    ds_read_b128 v[72:75], v8 offset:6656
    s_waitcnt lgkmcnt(3)
    v_mfma_f32_32x32x16_bf16 v[32:47], a[92:95], v[76:79], v[32:47]
    v_mfma_f32_32x32x16_bf16 v[48:63], v[76:79], a[236:239], v[48:63]
    ds_read_b128 v[76:79], v8 offset:6912
    s_waitcnt lgkmcnt(3)
    v_mfma_f32_32x32x16_bf16 v[32:47], a[96:99], v[64:67], v[32:47]
    v_mfma_f32_32x32x16_bf16 v[48:63], v[64:67], a[240:243], v[48:63]
    ds_read_b128 v[64:67], v8 offset:7168
    s_waitcnt lgkmcnt(3)
    v_mfma_f32_32x32x16_bf16 v[32:47], a[100:103], v[68:71], v[32:47]
    v_mfma_f32_32x32x16_bf16 v[48:63], v[68:71], a[244:247], v[48:63]
    ds_read_b128 v[68:71], v8 offset:7424
    s_waitcnt lgkmcnt(3)
    v_mfma_f32_32x32x16_bf16 v[32:47], a[104:107], v[72:75], v[32:47]
    v_mfma_f32_32x32x16_bf16 v[48:63], v[72:75], a[248:251], v[48:63]
    ds_read_b128 v[72:75], v8 offset:7680
    s_waitcnt lgkmcnt(3)
    v_mfma_f32_32x32x16_bf16 v[32:47], a[108:111], v[76:79], v[32:47]
    v_mfma_f32_32x32x16_bf16 v[48:63], v[76:79], a[252:255], v[48:63]
    ds_read_b128 v[76:79], v8 offset:7936
    s_waitcnt lgkmcnt(3)
    v_mfma_f32_32x32x16_bf16 v[32:47], a[112:115], v[64:67], v[32:47]
    v_mfma_f32_32x32x16_bf16 v[48:63], v[64:67], v[224:227], v[48:63]
    ds_read_b128 v[64:67], v8 offset:8192
    s_waitcnt lgkmcnt(3)
    v_mfma_f32_32x32x16_bf16 v[32:47], a[116:119], v[68:71], v[32:47]
    v_mfma_f32_32x32x16_bf16 v[48:63], v[68:71], v[228:231], v[48:63]
    ds_read_b128 v[68:71], v8 offset:8448
    s_waitcnt lgkmcnt(3)
    v_mfma_f32_32x32x16_bf16 v[32:47], a[120:123], v[72:75], v[32:47]
    v_mfma_f32_32x32x16_bf16 v[48:63], v[72:75], v[232:235], v[48:63]
    ds_read_b128 v[72:75], v8 offset:8704
    s_waitcnt lgkmcnt(3)
    v_mfma_f32_32x32x16_bf16 v[32:47], a[124:127], v[76:79], v[32:47]
    v_mfma_f32_32x32x16_bf16 v[48:63], v[76:79], v[236:239], v[48:63]
    ds_read_b128 v[76:79], v8 offset:8960
    s_waitcnt lgkmcnt(3)
    v_mfma_f32_32x32x16_bf16 v[32:47], a[128:131], v[64:67], v[32:47]
    v_mfma_f32_32x32x16_bf16 v[48:63], v[64:67], v[240:243], v[48:63]
    s_waitcnt lgkmcnt(2)
    v_mfma_f32_32x32x16_bf16 v[32:47], a[132:135], v[68:71], v[32:47]
    v_mfma_f32_32x32x16_bf16 v[48:63], v[68:71], v[244:247], v[48:63]
    s_waitcnt lgkmcnt(1)
    v_mfma_f32_32x32x16_bf16 v[32:47], a[136:139], v[72:75], v[32:47]
    v_mfma_f32_32x32x16_bf16 v[48:63], v[72:75], v[248:251], v[48:63]
    s_waitcnt lgkmcnt(0)
    v_mfma_f32_32x32x16_bf16 v[32:47], a[140:143], v[76:79], v[32:47]
    v_mfma_f32_32x32x16_bf16 v[48:63], v[76:79], v[252:255], v[48:63]
    v_max3_f32 v12, v152, v153, v154
    v_max3_f32 v12, v12, v155, v156
    v_max3_f32 v12, v12, v157, v158
    v_max3_f32 v12, v12, v159, v160
    v_max3_f32 v12, v12, v161, v162
    v_max3_f32 v12, v12, v163, v164
    v_max3_f32 v12, v12, v165, v166
    v_max_f32 v12, v12, v167
    v_cvt_pk_bf16_f32 v32, v32, v33
    v_cvt_pk_bf16_f32 v33, v34, v35
    v_cvt_pk_bf16_f32 v34, v40, v41
    v_cvt_pk_bf16_f32 v35, v42, v43
    v_cvt_pk_bf16_f32 v36, v36, v37
    v_cvt_pk_bf16_f32 v37, v38, v39
    v_cvt_pk_bf16_f32 v38, v44, v45
    v_cvt_pk_bf16_f32 v39, v46, v47
    s_mov_b32 exec_lo, 0xff
    s_mov_b32 exec_hi, 0xff
    ds_write_b128 v9, v[32:35] offset:16384
    ds_write_b128 v9, v[36:39] offset:16640
    s_mov_b64 exec, -1
    v_cvt_pk_bf16_f32 v48, v48, v49
    v_cvt_pk_bf16_f32 v49, v50, v51
    s_waitcnt lgkmcnt(0)
    s_barrier
    ds_read_b128 v[112:115], v8 offset:16384
    ds_read_b128 v[116:119], v8 offset:16640
    ds_read_b128 v[120:123], v8 offset:16896
    ds_read_b128 v[124:127], v8 offset:17152
    ds_read_b128 v[128:131], v8 offset:17408
    ds_read_b128 v[132:135], v8 offset:17664
    ds_read_b128 v[136:139], v8 offset:17920
    ds_read_b128 v[140:143], v8 offset:18176
    s_waitcnt lgkmcnt(7)
    v_mfma_f32_32x32x16_bf16 v[188:203], v[112:115], v[80:83], 0
    s_waitcnt lgkmcnt(6)
    v_mfma_f32_32x32x16_bf16 v[188:203], v[116:119], v[84:87], v[188:203]
    s_waitcnt lgkmcnt(5)
    v_mfma_f32_32x32x16_bf16 v[188:203], v[120:123], v[88:91], v[188:203]
    s_waitcnt lgkmcnt(4)
    v_mfma_f32_32x32x16_bf16 v[188:203], v[124:127], v[92:95], v[188:203]
    s_waitcnt lgkmcnt(3)
    v_mfma_f32_32x32x16_bf16 v[188:203], v[128:131], v[96:99], v[188:203]
    s_waitcnt lgkmcnt(2)
    v_mfma_f32_32x32x16_bf16 v[188:203], v[132:135], v[100:103], v[188:203]
    s_waitcnt lgkmcnt(1)
    v_mfma_f32_32x32x16_bf16 v[188:203], v[136:139], v[104:107], v[188:203]
    s_waitcnt lgkmcnt(0)
    v_mfma_f32_32x32x16_bf16 v[188:203], v[140:143], v[108:111], v[188:203]
    s_nop 11
    v_max3_f32 v12, v12, v188, v189
    v_max3_f32 v12, v12, v190, v191
    v_mov_b32 v13, v12
    s_nop 1
    v_permlane32_swap_b32 v12, v13
    v_max_f32 v12, v12, v13
    v_mul_f32 v12, s64, v12
    v_pk_fma_f32 v[152:153], v[152:153], s[64:65], v[12:13] op_sel_hi:[1,1,0] neg_lo:[0,0,1] neg_hi:[0,0,1]
    v_pk_fma_f32 v[154:155], v[154:155], s[64:65], v[12:13] op_sel_hi:[1,1,0] neg_lo:[0,0,1] neg_hi:[0,0,1]
    v_pk_fma_f32 v[156:157], v[156:157], s[64:65], v[12:13] op_sel_hi:[1,1,0] neg_lo:[0,0,1] neg_hi:[0,0,1]
    v_pk_fma_f32 v[158:159], v[158:159], s[64:65], v[12:13] op_sel_hi:[1,1,0] neg_lo:[0,0,1] neg_hi:[0,0,1]
    v_pk_fma_f32 v[160:161], v[160:161], s[64:65], v[12:13] op_sel_hi:[1,1,0] neg_lo:[0,0,1] neg_hi:[0,0,1]
    v_pk_fma_f32 v[162:163], v[162:163], s[64:65], v[12:13] op_sel_hi:[1,1,0] neg_lo:[0,0,1] neg_hi:[0,0,1]
    v_pk_fma_f32 v[164:165], v[164:165], s[64:65], v[12:13] op_sel_hi:[1,1,0] neg_lo:[0,0,1] neg_hi:[0,0,1]
    v_pk_fma_f32 v[166:167], v[166:167], s[64:65], v[12:13] op_sel_hi:[1,1,0] neg_lo:[0,0,1] neg_hi:[0,0,1]
    v_pk_fma_f32 v[188:189], v[188:189], s[64:65], v[12:13] op_sel_hi:[1,1,0] neg_lo:[0,0,1] neg_hi:[0,0,1]
    v_pk_fma_f32 v[190:191], v[190:191], s[64:65], v[12:13] op_sel_hi:[1,1,0] neg_lo:[0,0,1] neg_hi:[0,0,1]
    v_exp_f32 v152, v152
    v_exp_f32 v153, v153
    v_exp_f32 v154, v154
    v_exp_f32 v155, v155
    v_exp_f32 v156, v156
    v_exp_f32 v157, v157
    v_exp_f32 v158, v158
    v_exp_f32 v159, v159
    v_exp_f32 v160, v160
    v_exp_f32 v161, v161
    v_exp_f32 v162, v162
    v_exp_f32 v163, v163
    v_exp_f32 v164, v164
    v_exp_f32 v165, v165
    v_exp_f32 v166, v166
    v_exp_f32 v167, v167
    v_exp_f32 v188, v188
    v_exp_f32 v189, v189
    v_exp_f32 v190, v190
    v_exp_f32 v191, v191
    v_pk_add_f32 v[192:193], v[152:153], v[154:155]
    v_pk_add_f32 v[192:193], v[192:193], v[156:157]
    v_pk_add_f32 v[192:193], v[192:193], v[158:159]
    v_pk_add_f32 v[192:193], v[192:193], v[160:161]
    v_pk_add_f32 v[192:193], v[192:193], v[162:163]
    v_pk_add_f32 v[192:193], v[192:193], v[164:165]
    v_pk_add_f32 v[192:193], v[192:193], v[166:167]
    v_pk_add_f32 v[192:193], v[192:193], v[188:189]
    v_pk_add_f32 v[192:193], v[192:193], v[190:191]
    v_add_f32 v12, v192, v193
    v_mov_b32 v13, v12
    s_nop 1
    v_permlane32_swap_b32 v12, v13
    v_add_f32 v12, v12, v13
    v_rcp_f32 v12, v12
    s_nop 0
    v_pk_mul_f32 v[152:153], v[152:153], v[12:13] op_sel_hi:[1,0]
    v_pk_mul_f32 v[154:155], v[154:155], v[12:13] op_sel_hi:[1,0]
    v_pk_mul_f32 v[156:157], v[156:157], v[12:13] op_sel_hi:[1,0]
    v_pk_mul_f32 v[158:159], v[158:159], v[12:13] op_sel_hi:[1,0]
    v_pk_mul_f32 v[160:161], v[160:161], v[12:13] op_sel_hi:[1,0]
    v_pk_mul_f32 v[162:163], v[162:163], v[12:13] op_sel_hi:[1,0]
    v_pk_mul_f32 v[164:165], v[164:165], v[12:13] op_sel_hi:[1,0]
    v_pk_mul_f32 v[166:167], v[166:167], v[12:13] op_sel_hi:[1,0]
    v_pk_mul_f32 v[188:189], v[188:189], v[12:13] op_sel_hi:[1,0]
    v_pk_mul_f32 v[190:191], v[190:191], v[12:13] op_sel_hi:[1,0]
    v_cvt_pk_bf16_f32 v204, v152, v153
    v_cvt_pk_bf16_f32 v205, v154, v155
    v_cvt_pk_bf16_f32 v206, v160, v161
    v_cvt_pk_bf16_f32 v207, v162, v163
    v_cvt_pk_bf16_f32 v208, v156, v157
    v_cvt_pk_bf16_f32 v209, v158, v159
    v_cvt_pk_bf16_f32 v210, v164, v165
    v_cvt_pk_bf16_f32 v211, v166, v167
    v_cvt_pk_bf16_f32 v212, v188, v189
    v_cvt_pk_bf16_f32 v213, v190, v191
    v_mfma_f32_32x32x16_bf16 v[16:31], v[144:147], v[204:207], 0
    v_mfma_f32_32x32x16_bf16 v[16:31], v[148:151], v[208:211], v[16:31]
    v_mfma_f32_32x32x8_bf16 v[16:31], v[48:49], v[212:213], v[16:31]
    s_nop 11
    v_cvt_pk_bf16_f32 v16, v16, v17
    v_cvt_pk_bf16_f32 v17, v18, v19
    v_cvt_pk_bf16_f32 v18, v20, v21
    v_cvt_pk_bf16_f32 v19, v22, v23
    v_cvt_pk_bf16_f32 v20, v24, v25
    v_cvt_pk_bf16_f32 v21, v26, v27
    v_cvt_pk_bf16_f32 v22, v28, v29
    v_cvt_pk_bf16_f32 v23, v30, v31
    buffer_store_dwordx4 v[16:19], v10, s[8:11], s61 offen sc1
    buffer_store_dwordx4 v[20:23], v10, s[8:11], s61 offen offset:512 sc1
    s_add_u32 s66, s66, 2097152
    s_add_u32 s70, s70, 1048576
    s_add_u32 s60, s60, 131072
    s_add_u32 s61, s61, 1048576
    s_add_u32 s22, s22, 1
    s_waitcnt vmcnt(0)
    s_mov_b64 exec, 1
    buffer_store_dword v4, v5, s[8:11], s62 offen sc1
    s_mov_b64 exec, -1
    s_add_u32 s62, s62, 32768
    s_cmp_lt_u32 s22, 16
    s_cbranch_scc1 A_loop
    s_branch L_exit
R_chain:
    s_load_dwordx2 s[72:73], s[0:1], 40
    s_mov_b32 s74, 4718592
    s_mov_b32 s75, 0x00020000
    s_load_dwordx2 s[76:77], s[0:1], 48
    s_mov_b32 s78, 4718592
    s_mov_b32 s79, 0x00020000
    s_load_dwordx2 s[80:81], s[0:1], 56
    s_mov_b32 s82, 4718592
    s_mov_b32 s83, 0x00020000
    s_load_dwordx2 s[84:85], s[0:1], 64
    s_mov_b32 s86, 4718592
    s_mov_b32 s87, 0x00020000
    s_load_dwordx2 s[88:89], s[0:1], 32
    s_mov_b32 s90, 9216
    s_mov_b32 s91, 0x00020000
    s_load_dwordx2 s[92:93], s[0:1], 88
    s_mov_b32 s12, s6
    s_mov_b32 s13, s5
    s_mul_i32 s16, s12, 36864
    s_add_u32 s94, s16, 16384
    s_lshl_b32 s95, s13, 8
    s_lshl_b32 s15, s12, 17
    s_add_u32 s95, s95, s15
    s_mul_i32 s97, s13, 147456
    s_lshl_b32 s15, s12, 5
    s_add_u32 s97, s97, s15
    v_and_b32 v28, 63, v0
    s_mov_b32 s15, s13
    s_cmp_eq_u32 s12, 1
    s_cselect_b32 s16, 40, 0
    s_add_u32 s15, s15, s16
    s_cmp_eq_u32 s12, 3
    s_cselect_b32 s16, 32, 0
    s_add_u32 s15, s15, s16
    s_lshl_b32 s15, s15, 4
    v_and_b32 v70, 7, v28
    v_mul_u32_u24 v70, 1152, v70
    v_bfe_u32 v71, v28, 4, 1
    v_lshl_add_u32 v70, v71, 3, v70
    s_waitcnt lgkmcnt(0)
    buffer_load_dwordx2 v[16:17], v70, s[88:91], s15 offen
    v_and_b32 v24, 63, v0
    v_lshrrev_b32 v25, 4, v24
    v_and_b32 v24, 15, v24
    v_and_b32 v20, 1, v25
    v_lshlrev_b32 v20, 1, v20
    v_xor_b32 v20, 0, v20
    v_xor_b32 v20, v20, v24
    v_lshlrev_b32 v20, 4, v20
    v_lshl_add_u32 v20, v25, 13, v20
    v_add_u32 v20, 0, v20
    v_and_b32 v21, 1, v25
    v_lshlrev_b32 v21, 1, v21
    v_xor_b32 v21, 4, v21
    v_xor_b32 v21, v21, v24
    v_lshlrev_b32 v21, 4, v21
    v_lshl_add_u32 v21, v25, 13, v21
    v_add_u32 v21, 32768, v21
    v_and_b32 v22, 1, v25
    v_lshlrev_b32 v22, 1, v22
    v_xor_b32 v22, 8, v22
    v_xor_b32 v22, v22, v24
    v_lshlrev_b32 v22, 4, v22
    v_lshl_add_u32 v22, v25, 13, v22
    v_add_u32 v22, 65536, v22
    v_and_b32 v23, 1, v25
    v_lshlrev_b32 v23, 1, v23
    v_xor_b32 v23, 12, v23
    v_xor_b32 v23, v23, v24
    v_lshlrev_b32 v23, 4, v23
    v_lshl_add_u32 v23, v25, 13, v23
    v_add_u32 v23, 98304, v23
    s_add_u32 s96, s95, 0
    s_add_u32 m0, s94, 0
    s_nop 0
    buffer_load_dwordx4 v20, s[72:75], s96 offen lds
    s_add_u32 m0, s94, 1024
    s_nop 0
    buffer_load_dwordx4 v21, s[72:75], s96 offen lds
    s_add_u32 m0, s94, 2048
    s_nop 0
    buffer_load_dwordx4 v22, s[72:75], s96 offen lds
    s_add_u32 m0, s94, 3072
    s_nop 0
    buffer_load_dwordx4 v23, s[72:75], s96 offen lds
    s_barrier
    s_add_u32 s96, s95, 524288
    s_add_u32 m0, s94, 4096
    s_nop 0
    buffer_load_dwordx4 v20, s[72:75], s96 offen lds
    s_add_u32 m0, s94, 5120
    s_nop 0
    buffer_load_dwordx4 v21, s[72:75], s96 offen lds
    s_add_u32 m0, s94, 6144
    s_nop 0
    buffer_load_dwordx4 v22, s[72:75], s96 offen lds
    s_add_u32 m0, s94, 7168
    s_nop 0
    buffer_load_dwordx4 v23, s[72:75], s96 offen lds
    s_barrier
    s_add_u32 s96, s95, 1048576
    s_add_u32 m0, s94, 8192
    s_nop 0
    buffer_load_dwordx4 v20, s[72:75], s96 offen lds
    s_add_u32 m0, s94, 9216
    s_nop 0
    buffer_load_dwordx4 v21, s[72:75], s96 offen lds
    s_add_u32 m0, s94, 10240
    s_nop 0
    buffer_load_dwordx4 v22, s[72:75], s96 offen lds
    s_add_u32 m0, s94, 11264
    s_nop 0
    buffer_load_dwordx4 v23, s[72:75], s96 offen lds
    s_barrier
    s_add_u32 s96, s95, 1572864
    s_add_u32 m0, s94, 12288
    s_nop 0
    buffer_load_dwordx4 v20, s[72:75], s96 offen lds
    s_add_u32 m0, s94, 13312
    s_nop 0
    buffer_load_dwordx4 v21, s[72:75], s96 offen lds
    s_add_u32 m0, s94, 14336
    s_nop 0
    buffer_load_dwordx4 v22, s[72:75], s96 offen lds
    s_add_u32 m0, s94, 15360
    s_nop 0
    buffer_load_dwordx4 v23, s[72:75], s96 offen lds
    s_barrier
    s_add_u32 s96, s95, 2097152
    s_add_u32 m0, s94, 16384
    s_nop 0
    buffer_load_dwordx4 v20, s[72:75], s96 offen lds
    s_add_u32 m0, s94, 17408
    s_nop 0
    buffer_load_dwordx4 v21, s[72:75], s96 offen lds
    s_add_u32 m0, s94, 18432
    s_nop 0
    buffer_load_dwordx4 v22, s[72:75], s96 offen lds
    s_add_u32 m0, s94, 19456
    s_nop 0
    buffer_load_dwordx4 v23, s[72:75], s96 offen lds
    s_barrier
    s_add_u32 s96, s95, 2621440
    s_add_u32 m0, s94, 20480
    s_nop 0
    buffer_load_dwordx4 v20, s[72:75], s96 offen lds
    s_add_u32 m0, s94, 21504
    s_nop 0
    buffer_load_dwordx4 v21, s[72:75], s96 offen lds
    s_add_u32 m0, s94, 22528
    s_nop 0
    buffer_load_dwordx4 v22, s[72:75], s96 offen lds
    s_add_u32 m0, s94, 23552
    s_nop 0
    buffer_load_dwordx4 v23, s[72:75], s96 offen lds
    s_barrier
    s_add_u32 s96, s95, 3145728
    s_add_u32 m0, s94, 24576
    s_nop 0
    buffer_load_dwordx4 v20, s[72:75], s96 offen lds
    s_add_u32 m0, s94, 25600
    s_nop 0
    buffer_load_dwordx4 v21, s[72:75], s96 offen lds
    s_add_u32 m0, s94, 26624
    s_nop 0
    buffer_load_dwordx4 v22, s[72:75], s96 offen lds
    s_add_u32 m0, s94, 27648
    s_nop 0
    buffer_load_dwordx4 v23, s[72:75], s96 offen lds
    s_barrier
    s_add_u32 s96, s95, 3670016
    s_add_u32 m0, s94, 28672
    s_nop 0
    buffer_load_dwordx4 v20, s[72:75], s96 offen lds
    s_add_u32 m0, s94, 29696
    s_nop 0
    buffer_load_dwordx4 v21, s[72:75], s96 offen lds
    s_add_u32 m0, s94, 30720
    s_nop 0
    buffer_load_dwordx4 v22, s[72:75], s96 offen lds
    s_add_u32 m0, s94, 31744
    s_nop 0
    buffer_load_dwordx4 v23, s[72:75], s96 offen lds
    s_barrier
    s_add_u32 s96, s95, 4194304
    s_add_u32 m0, s94, 32768
    s_nop 0
    buffer_load_dwordx4 v20, s[72:75], s96 offen lds
    s_add_u32 m0, s94, 33792
    s_nop 0
    buffer_load_dwordx4 v21, s[72:75], s96 offen lds
    s_add_u32 m0, s94, 34816
    s_nop 0
    buffer_load_dwordx4 v22, s[72:75], s96 offen lds
    s_add_u32 m0, s94, 35840
    s_nop 0
    buffer_load_dwordx4 v23, s[72:75], s96 offen lds
    s_waitcnt vmcnt(36)
    v_add_u32 v18, 1, v59
    v_lshrrev_b32 v29, 4, v28
    v_bfe_u32 v30, v28, 2, 2
    v_and_b32 v31, 3, v28
    v_and_b32 v32, 1, v30
    v_lshrrev_b32 v33, 1, v30
    v_and_b32 v34, 1, v29
    v_lshl_add_u32 v35, v33, 3, v32
    v_lshl_add_u32 v35, v34, 2, v35
    v_lshl_add_u32 v36, v34, 1, v32
    v_lshl_add_u32 v36, v33, 2, v36
    s_lshl_b32 s15, s12, 1
    v_xor_b32 v36, s15, v36
    v_lshlrev_b32 v35, 8, v35
    v_lshl_add_u32 v35, v36, 5, v35
    v_lshl_add_u32 v35, v31, 3, v35
    v_lshrrev_b32 v37, 1, v29
    v_mul_u32_u24 v37, 36864, v37
    v_add_u32 v35, v35, v37
    v_add_u32 v44, 16384, v35
    v_xor_b32 v45, 32, v44
    v_add_u32 v46, 73728, v44
    v_add_u32 v47, 73728, v45
    v_lshrrev_b32 v26, 1, v28
    v_mul_u32_u24 v26, 1152, v26
    v_and_b32 v38, 1, v28
    v_lshl_add_u32 v26, v38, 4, v26
    v_lshrrev_b32 v39, 2, v28
    v_lshlrev_b32 v39, 5, v39
    v_lshl_add_u32 v39, v31, 3, v39
    v_add_u32 v39, s94, v39
    v_and_b32 v63, 63, v0
    v_lshlrev_b32 v0, 4, v63
    v_and_b32 v60, 15, v63
    v_lshrrev_b32 v61, 4, v63
    v_and_b32 v62, 1, v61
    v_lshrrev_b32 v1, 1, v61
    v_lshlrev_b32 v1, 12, v1
    v_lshl_add_u32 v1, v62, 3, v1
    v_lshl_add_u32 v1, v60, 4, v1
    v_mov_b32 v64, 2146435072
    v_cmp_gt_u32 vcc, 8, v60
    s_nop 1
    v_cndmask_b32 v1, v64, v1, vcc
    v_and_b32 v65, 7, v60
    v_lshlrev_b32 v65, 4, v65
    v_lshrrev_b32 v10, 3, v60
    v_lshl_add_u32 v5, v10, 3, v65
    v_lshl_add_u32 v9, v61, 7, v65
    v_add_u32 v9, 5120, v9
    v_lshl_add_u32 v6, v61, 7, v5
    s_lshl_b32 s15, s12, 9
    s_add_u32 s15, s15, 5120
    v_add_u32 v6, s15, v6
    v_lshl_add_u32 v5, v62, 7, v5
    v_add_u32 v5, 1024, v5
    s_mul_i32 s15, s12, 1280
    s_mov_b32 s64, s15
    v_lshlrev_b32 v4, 7, v62
    v_lshl_add_u32 v4, v60, 4, v4
    v_add_u32 v4, s15, v4
    v_add_u32 v4, 1024, v4
    s_mul_i32 s15, s12, 36864
    s_add_u32 s15, s15, 16384
    v_add_u32 v7, s15, v0
    s_mov_b32 s30, -1
    s_mov_b32 s31, 0
    s_mov_b32 s66, 0
    s_mov_b32 s67, 0x00ff00ff
    s_mov_b32 s34, 0x3e0293ee
    s_mov_b32 s35, 0x3e0293ee
    v_and_b32 v12, 7, v60
    v_lshlrev_b32 v13, 2, v62
    v_sub_u32 v12, v12, v13
    v_lshrrev_b32 v13, 3, v60
    v_lshlrev_b32 v13, 2, v13
    v_cmp_gt_u32 vcc, 4, v12
    v_add_u32 v12, v12, v13
    s_nop 0
    v_cndmask_b32 v11, 15, v12, vcc
    v_mov_b32 v12, 0
    v_mov_b32 v64, 0x3f80
    v_cmp_eq_u32 vcc, 0, v11
    s_nop 1
    v_cndmask_b32 v12, v12, v64, vcc
    v_mov_b32 v64, 0x3f800000
    v_cmp_eq_u32 vcc, 1, v11
    s_nop 1
    v_cndmask_b32 v12, v12, v64, vcc
    v_mov_b32 v13, 0
    v_mov_b32 v64, 0x3f80
    v_cmp_eq_u32 vcc, 2, v11
    s_nop 1
    v_cndmask_b32 v13, v13, v64, vcc
    v_mov_b32 v64, 0x3f800000
    v_cmp_eq_u32 vcc, 3, v11
    s_nop 1
    v_cndmask_b32 v13, v13, v64, vcc
    v_mov_b32 v14, 0
    v_mov_b32 v64, 0x3f80
    v_cmp_eq_u32 vcc, 4, v11
    s_nop 1
    v_cndmask_b32 v14, v14, v64, vcc
    v_mov_b32 v64, 0x3f800000
    v_cmp_eq_u32 vcc, 5, v11
    s_nop 1
    v_cndmask_b32 v14, v14, v64, vcc
    v_mov_b32 v15, 0
    v_mov_b32 v64, 0x3f80
    v_cmp_eq_u32 vcc, 6, v11
    s_nop 1
    v_cndmask_b32 v15, v15, v64, vcc
    v_mov_b32 v64, 0x3f800000
    v_cmp_eq_u32 vcc, 7, v11
    s_nop 1
    v_cndmask_b32 v15, v15, v64, vcc
    v_and_b32 v11, 3, v60
    v_mov_b32 v2, 0
    v_mov_b32 v64, 0x3f80
    v_cmp_eq_u32 vcc, 0, v11
    s_nop 1
    v_cndmask_b32 v2, v2, v64, vcc
    v_mov_b32 v64, 0x3f800000
    v_cmp_eq_u32 vcc, 1, v11
    s_nop 1
    v_cndmask_b32 v2, v2, v64, vcc
    v_mov_b32 v3, 0
    v_mov_b32 v64, 0x3f80
    v_cmp_eq_u32 vcc, 2, v11
    s_nop 1
    v_cndmask_b32 v3, v3, v64, vcc
    v_mov_b32 v64, 0x3f800000
    v_cmp_eq_u32 vcc, 3, v11
    s_nop 1
    v_cndmask_b32 v3, v3, v64, vcc
    v_mov_b32 v8, 0x4444
    v_mov_b32 v64, 0xeeee
    v_cmp_gt_u32 vcc, 8, v60
    s_nop 1
    v_cndmask_b32 v8, v64, v8, vcc
    s_mov_b32 s14, 0
    s_mov_b32 s37, 0
    s_mov_b32 s68, 0x7f000000
    s_lshl_b32 s18, s12, 10
    s_add_u32 s38, s18, 7168
    s_add_u32 s18, s18, 1049600
    s_mov_b32 s39, 1053696
    s_mul_i32 s21, s12, 768
    s_add_u32 s43, s21, 13312
    s_add_u32 s21, s21, 1055744
    s_lshl_b32 s15, s13, 7
    s_lshl_b32 s16, s12, 13
    s_add_u32 s52, s15, s16
    s_add_u32 s52, s52, 8388608
    s_add_u32 s53, s52, 32768
    s_add_u32 s54, s52, 65536
    s_add_u32 s55, s52, 98304
    s_add_u32 s56, s52, 131072
    s_add_u32 s57, s52, 163840
    s_add_u32 s58, s52, 196608
    s_add_u32 s59, s52, 229376
    s_add_u32 s60, s52, 262144
    s_lshl_b32 s15, s13, 2
    s_add_u32 s15, s15, s12
    s_lshl_b32 s23, s15, 12
    s_add_u32 s23, s23, 16777216
    s_lshl_b32 s69, s15, 8
    s_add_u32 s69, s69, 1572864
    s_add_u32 s15, s12, 5
    s_lshl_b32 s19, s15, 12
    s_add_u32 s19, s19, 16384
    s_add_u32 s20, s19, 12288
    s_lshl_b32 s61, s15, 15
    s_lshl_b32 s16, s13, 7
    s_add_u32 s61, s61, s16
    s_add_u32 s61, s61, 8388608
    s_add_u32 s62, s61, 98304
    s_mov_b32 s27, 0
    s_mov_b32 s15, 72
    s_cmp_eq_u32 s12, 0
    s_cselect_b32 s27, 2, s27
    s_cselect_b32 s15, s13, s15
    s_add_u32 s16, s13, 40
    s_cmp_eq_u32 s12, 1
    s_cselect_b32 s27, 2, s27
    s_cselect_b32 s15, s16, s15
    s_add_u32 s16, s13, 32
    s_cmp_eq_u32 s12, 3
    s_cselect_b32 s17, s16, 99
    s_cmp_lt_u32 s17, 40
    s_cselect_b32 s27, 1, s27
    s_cselect_b32 s15, s17, s15
    s_lshl_b32 s22, s15, 12
    s_add_u32 s22, s22, 8388608
    s_lshl_b32 s26, s15, 7
    s_add_u32 s26, s26, 1024
    s_cmp_eq_u32 s27, 0
    s_cselect_b32 s26, 0x7f000000, s26
    s_lshl_b32 s25, s15, 8
    s_cmp_eq_u32 s27, 0
    s_cselect_b32 s25, 0x7f000000, s25
    s_add_u32 s25, s25, 4189184
    s_add_u32 s65, s26, 1081344
    s_add_u32 s24, s26, 1048576
    s_xor_b32 s36, s22, 524288
    s_cmp_eq_u32 s27, 0
    s_cselect_b32 s36, 0x7f000000, s36
    s_waitcnt vmcnt(32) lgkmcnt(0)
    s_barrier
    ds_read_b64_tr_b16 a[0:1], v44 offset:0
    ds_read_b64_tr_b16 a[2:3], v44 offset:512
    ds_read_b64_tr_b16 a[4:5], v46 offset:0
    ds_read_b64_tr_b16 a[6:7], v46 offset:512
    ds_read_b64_tr_b16 a[144:145], v45 offset:0
    ds_read_b64_tr_b16 a[146:147], v45 offset:512
    ds_read_b64_tr_b16 a[148:149], v47 offset:0
    ds_read_b64_tr_b16 a[150:151], v47 offset:512
    s_waitcnt vmcnt(28) lgkmcnt(0)
    s_barrier
    ds_read_b64_tr_b16 a[8:9], v44 offset:4096
    ds_read_b64_tr_b16 a[10:11], v44 offset:4608
    s_add_u32 s96, s95, 0
    s_add_u32 m0, s94, 0
    s_nop 0
    buffer_load_dwordx4 v20, s[76:79], s96 offen lds
    ds_read_b64_tr_b16 a[12:13], v46 offset:4096
    ds_read_b64_tr_b16 a[14:15], v46 offset:4608
    s_add_u32 m0, s94, 1024
    s_nop 0
    buffer_load_dwordx4 v21, s[76:79], s96 offen lds
    ds_read_b64_tr_b16 a[152:153], v45 offset:4096
    ds_read_b64_tr_b16 a[154:155], v45 offset:4608
    s_add_u32 m0, s94, 2048
    s_nop 0
    buffer_load_dwordx4 v22, s[76:79], s96 offen lds
    ds_read_b64_tr_b16 a[156:157], v47 offset:4096
    ds_read_b64_tr_b16 a[158:159], v47 offset:4608
    s_add_u32 m0, s94, 3072
    s_nop 0
    buffer_load_dwordx4 v23, s[76:79], s96 offen lds
    s_waitcnt vmcnt(28) lgkmcnt(0)
    s_barrier
    ds_read_b64_tr_b16 a[16:17], v44 offset:8192
    ds_read_b64_tr_b16 a[18:19], v44 offset:8704
    s_add_u32 s96, s95, 524288
    s_add_u32 m0, s94, 4096
    s_nop 0
    buffer_load_dwordx4 v20, s[76:79], s96 offen lds
    ds_read_b64_tr_b16 a[20:21], v46 offset:8192
    ds_read_b64_tr_b16 a[22:23], v46 offset:8704
    s_add_u32 m0, s94, 5120
    s_nop 0
    buffer_load_dwordx4 v21, s[76:79], s96 offen lds
    ds_read_b64_tr_b16 a[160:161], v45 offset:8192
    ds_read_b64_tr_b16 a[162:163], v45 offset:8704
    s_add_u32 m0, s94, 6144
    s_nop 0
    buffer_load_dwordx4 v22, s[76:79], s96 offen lds
    ds_read_b64_tr_b16 a[164:165], v47 offset:8192
    ds_read_b64_tr_b16 a[166:167], v47 offset:8704
    s_add_u32 m0, s94, 7168
    s_nop 0
    buffer_load_dwordx4 v23, s[76:79], s96 offen lds
    s_waitcnt vmcnt(28) lgkmcnt(0)
    s_barrier
    ds_read_b64_tr_b16 a[24:25], v44 offset:12288
    ds_read_b64_tr_b16 a[26:27], v44 offset:12800
    s_add_u32 s96, s95, 1048576
    s_add_u32 m0, s94, 8192
    s_nop 0
    buffer_load_dwordx4 v20, s[76:79], s96 offen lds
    ds_read_b64_tr_b16 a[28:29], v46 offset:12288
    ds_read_b64_tr_b16 a[30:31], v46 offset:12800
    s_add_u32 m0, s94, 9216
    s_nop 0
    buffer_load_dwordx4 v21, s[76:79], s96 offen lds
    ds_read_b64_tr_b16 a[168:169], v45 offset:12288
    ds_read_b64_tr_b16 a[170:171], v45 offset:12800
    s_add_u32 m0, s94, 10240
    s_nop 0
    buffer_load_dwordx4 v22, s[76:79], s96 offen lds
    ds_read_b64_tr_b16 a[172:173], v47 offset:12288
    ds_read_b64_tr_b16 a[174:175], v47 offset:12800
    s_add_u32 m0, s94, 11264
    s_nop 0
    buffer_load_dwordx4 v23, s[76:79], s96 offen lds
    s_waitcnt vmcnt(28) lgkmcnt(0)
    s_barrier
    ds_read_b64_tr_b16 a[32:33], v44 offset:16384
    ds_read_b64_tr_b16 a[34:35], v44 offset:16896
    s_add_u32 s96, s95, 1572864
    s_add_u32 m0, s94, 12288
    s_nop 0
    buffer_load_dwordx4 v20, s[76:79], s96 offen lds
    ds_read_b64_tr_b16 a[36:37], v46 offset:16384
    ds_read_b64_tr_b16 a[38:39], v46 offset:16896
    s_add_u32 m0, s94, 13312
    s_nop 0
    buffer_load_dwordx4 v21, s[76:79], s96 offen lds
    ds_read_b64_tr_b16 a[176:177], v45 offset:16384
    ds_read_b64_tr_b16 a[178:179], v45 offset:16896
    s_add_u32 m0, s94, 14336
    s_nop 0
    buffer_load_dwordx4 v22, s[76:79], s96 offen lds
    ds_read_b64_tr_b16 a[180:181], v47 offset:16384
    ds_read_b64_tr_b16 a[182:183], v47 offset:16896
    s_add_u32 m0, s94, 15360
    s_nop 0
    buffer_load_dwordx4 v23, s[76:79], s96 offen lds
    s_waitcnt vmcnt(28) lgkmcnt(0)
    s_barrier
    ds_read_b64_tr_b16 a[40:41], v44 offset:20480
    ds_read_b64_tr_b16 a[42:43], v44 offset:20992
    s_add_u32 s96, s95, 2097152
    s_add_u32 m0, s94, 16384
    s_nop 0
    buffer_load_dwordx4 v20, s[76:79], s96 offen lds
    ds_read_b64_tr_b16 a[44:45], v46 offset:20480
    ds_read_b64_tr_b16 a[46:47], v46 offset:20992
    s_add_u32 m0, s94, 17408
    s_nop 0
    buffer_load_dwordx4 v21, s[76:79], s96 offen lds
    ds_read_b64_tr_b16 a[184:185], v45 offset:20480
    ds_read_b64_tr_b16 a[186:187], v45 offset:20992
    s_add_u32 m0, s94, 18432
    s_nop 0
    buffer_load_dwordx4 v22, s[76:79], s96 offen lds
    ds_read_b64_tr_b16 a[188:189], v47 offset:20480
    ds_read_b64_tr_b16 a[190:191], v47 offset:20992
    s_add_u32 m0, s94, 19456
    s_nop 0
    buffer_load_dwordx4 v23, s[76:79], s96 offen lds
    s_waitcnt vmcnt(28) lgkmcnt(0)
    s_barrier
    ds_read_b64_tr_b16 a[48:49], v44 offset:24576
    ds_read_b64_tr_b16 a[50:51], v44 offset:25088
    s_add_u32 s96, s95, 2621440
    s_add_u32 m0, s94, 20480
    s_nop 0
    buffer_load_dwordx4 v20, s[76:79], s96 offen lds
    ds_read_b64_tr_b16 a[52:53], v46 offset:24576
    ds_read_b64_tr_b16 a[54:55], v46 offset:25088
    s_add_u32 m0, s94, 21504
    s_nop 0
    buffer_load_dwordx4 v21, s[76:79], s96 offen lds
    ds_read_b64_tr_b16 a[192:193], v45 offset:24576
    ds_read_b64_tr_b16 a[194:195], v45 offset:25088
    s_add_u32 m0, s94, 22528
    s_nop 0
    buffer_load_dwordx4 v22, s[76:79], s96 offen lds
    ds_read_b64_tr_b16 a[196:197], v47 offset:24576
    ds_read_b64_tr_b16 a[198:199], v47 offset:25088
    s_add_u32 m0, s94, 23552
    s_nop 0
    buffer_load_dwordx4 v23, s[76:79], s96 offen lds
    s_waitcnt vmcnt(28) lgkmcnt(0)
    s_barrier
    ds_read_b64_tr_b16 a[56:57], v44 offset:28672
    ds_read_b64_tr_b16 a[58:59], v44 offset:29184
    s_add_u32 s96, s95, 3145728
    s_add_u32 m0, s94, 24576
    s_nop 0
    buffer_load_dwordx4 v20, s[76:79], s96 offen lds
    ds_read_b64_tr_b16 a[60:61], v46 offset:28672
    ds_read_b64_tr_b16 a[62:63], v46 offset:29184
    s_add_u32 m0, s94, 25600
    s_nop 0
    buffer_load_dwordx4 v21, s[76:79], s96 offen lds
    ds_read_b64_tr_b16 a[200:201], v45 offset:28672
    ds_read_b64_tr_b16 a[202:203], v45 offset:29184
    s_add_u32 m0, s94, 26624
    s_nop 0
    buffer_load_dwordx4 v22, s[76:79], s96 offen lds
    ds_read_b64_tr_b16 a[204:205], v47 offset:28672
    ds_read_b64_tr_b16 a[206:207], v47 offset:29184
    s_add_u32 m0, s94, 27648
    s_nop 0
    buffer_load_dwordx4 v23, s[76:79], s96 offen lds
    s_waitcnt vmcnt(28) lgkmcnt(0)
    s_barrier
    ds_read_b64_tr_b16 a[64:65], v44 offset:32768
    ds_read_b64_tr_b16 a[66:67], v44 offset:33280
    s_add_u32 s96, s95, 3670016
    s_add_u32 m0, s94, 28672
    s_nop 0
    buffer_load_dwordx4 v20, s[76:79], s96 offen lds
    ds_read_b64_tr_b16 a[68:69], v46 offset:32768
    ds_read_b64_tr_b16 a[70:71], v46 offset:33280
    s_add_u32 m0, s94, 29696
    s_nop 0
    buffer_load_dwordx4 v21, s[76:79], s96 offen lds
    ds_read_b64_tr_b16 a[208:209], v45 offset:32768
    ds_read_b64_tr_b16 a[210:211], v45 offset:33280
    s_add_u32 m0, s94, 30720
    s_nop 0
    buffer_load_dwordx4 v22, s[76:79], s96 offen lds
    ds_read_b64_tr_b16 a[212:213], v47 offset:32768
    ds_read_b64_tr_b16 a[214:215], v47 offset:33280
    s_add_u32 m0, s94, 31744
    s_nop 0
    buffer_load_dwordx4 v23, s[76:79], s96 offen lds
    s_waitcnt vmcnt(28) lgkmcnt(0)
    s_barrier
    ds_read_b64_tr_b16 a[72:73], v44 offset:0
    ds_read_b64_tr_b16 a[74:75], v44 offset:512
    s_add_u32 s96, s95, 4194304
    s_add_u32 m0, s94, 32768
    s_nop 0
    buffer_load_dwordx4 v20, s[76:79], s96 offen lds
    ds_read_b64_tr_b16 a[76:77], v46 offset:0
    ds_read_b64_tr_b16 a[78:79], v46 offset:512
    s_add_u32 m0, s94, 33792
    s_nop 0
    buffer_load_dwordx4 v21, s[76:79], s96 offen lds
    ds_read_b64_tr_b16 a[216:217], v45 offset:0
    ds_read_b64_tr_b16 a[218:219], v45 offset:512
    s_add_u32 m0, s94, 34816
    s_nop 0
    buffer_load_dwordx4 v22, s[76:79], s96 offen lds
    ds_read_b64_tr_b16 a[220:221], v47 offset:0
    ds_read_b64_tr_b16 a[222:223], v47 offset:512
    s_add_u32 m0, s94, 35840
    s_nop 0
    buffer_load_dwordx4 v23, s[76:79], s96 offen lds
    s_waitcnt vmcnt(28) lgkmcnt(0)
    s_barrier
    ds_read_b64_tr_b16 a[80:81], v44 offset:4096
    ds_read_b64_tr_b16 a[82:83], v44 offset:4608
    s_add_u32 s96, s95, 0
    s_add_u32 m0, s94, 0
    s_nop 0
    buffer_load_dwordx4 v20, s[80:83], s96 offen lds
    ds_read_b64_tr_b16 a[84:85], v46 offset:4096
    ds_read_b64_tr_b16 a[86:87], v46 offset:4608
    s_add_u32 m0, s94, 1024
    s_nop 0
    buffer_load_dwordx4 v21, s[80:83], s96 offen lds
    ds_read_b64_tr_b16 a[224:225], v45 offset:4096
    ds_read_b64_tr_b16 a[226:227], v45 offset:4608
    s_add_u32 m0, s94, 2048
    s_nop 0
    buffer_load_dwordx4 v22, s[80:83], s96 offen lds
    ds_read_b64_tr_b16 a[228:229], v47 offset:4096
    ds_read_b64_tr_b16 a[230:231], v47 offset:4608
    s_add_u32 m0, s94, 3072
    s_nop 0
    buffer_load_dwordx4 v23, s[80:83], s96 offen lds
    s_waitcnt vmcnt(28) lgkmcnt(0)
    s_barrier
    ds_read_b64_tr_b16 a[88:89], v44 offset:8192
    ds_read_b64_tr_b16 a[90:91], v44 offset:8704
    s_add_u32 s96, s95, 524288
    s_add_u32 m0, s94, 4096
    s_nop 0
    buffer_load_dwordx4 v20, s[80:83], s96 offen lds
    ds_read_b64_tr_b16 a[92:93], v46 offset:8192
    ds_read_b64_tr_b16 a[94:95], v46 offset:8704
    s_add_u32 m0, s94, 5120
    s_nop 0
    buffer_load_dwordx4 v21, s[80:83], s96 offen lds
    ds_read_b64_tr_b16 a[232:233], v45 offset:8192
    ds_read_b64_tr_b16 a[234:235], v45 offset:8704
    s_add_u32 m0, s94, 6144
    s_nop 0
    buffer_load_dwordx4 v22, s[80:83], s96 offen lds
    ds_read_b64_tr_b16 a[236:237], v47 offset:8192
    ds_read_b64_tr_b16 a[238:239], v47 offset:8704
    s_add_u32 m0, s94, 7168
    s_nop 0
    buffer_load_dwordx4 v23, s[80:83], s96 offen lds
    s_waitcnt vmcnt(28) lgkmcnt(0)
    s_barrier
    ds_read_b64_tr_b16 a[96:97], v44 offset:12288
    ds_read_b64_tr_b16 a[98:99], v44 offset:12800
    s_add_u32 s96, s95, 1048576
    s_add_u32 m0, s94, 8192
    s_nop 0
    buffer_load_dwordx4 v20, s[80:83], s96 offen lds
    ds_read_b64_tr_b16 a[100:101], v46 offset:12288
    ds_read_b64_tr_b16 a[102:103], v46 offset:12800
    s_add_u32 m0, s94, 9216
    s_nop 0
    buffer_load_dwordx4 v21, s[80:83], s96 offen lds
    ds_read_b64_tr_b16 a[240:241], v45 offset:12288
    ds_read_b64_tr_b16 a[242:243], v45 offset:12800
    s_add_u32 m0, s94, 10240
    s_nop 0
    buffer_load_dwordx4 v22, s[80:83], s96 offen lds
    ds_read_b64_tr_b16 a[244:245], v47 offset:12288
    ds_read_b64_tr_b16 a[246:247], v47 offset:12800
    s_add_u32 m0, s94, 11264
    s_nop 0
    buffer_load_dwordx4 v23, s[80:83], s96 offen lds
    s_waitcnt vmcnt(28) lgkmcnt(0)
    s_barrier
    ds_read_b64_tr_b16 a[104:105], v44 offset:16384
    ds_read_b64_tr_b16 a[106:107], v44 offset:16896
    s_add_u32 s96, s95, 1572864
    s_add_u32 m0, s94, 12288
    s_nop 0
    buffer_load_dwordx4 v20, s[80:83], s96 offen lds
    ds_read_b64_tr_b16 a[108:109], v46 offset:16384
    ds_read_b64_tr_b16 a[110:111], v46 offset:16896
    s_add_u32 m0, s94, 13312
    s_nop 0
    buffer_load_dwordx4 v21, s[80:83], s96 offen lds
    ds_read_b64_tr_b16 a[248:249], v45 offset:16384
    ds_read_b64_tr_b16 a[250:251], v45 offset:16896
    s_add_u32 m0, s94, 14336
    s_nop 0
    buffer_load_dwordx4 v22, s[80:83], s96 offen lds
    ds_read_b64_tr_b16 a[252:253], v47 offset:16384
    ds_read_b64_tr_b16 a[254:255], v47 offset:16896
    s_add_u32 m0, s94, 15360
    s_nop 0
    buffer_load_dwordx4 v23, s[80:83], s96 offen lds
    s_waitcnt vmcnt(28) lgkmcnt(0)
    s_barrier
    ds_read_b64_tr_b16 a[112:113], v44 offset:20480
    ds_read_b64_tr_b16 a[114:115], v44 offset:20992
    s_add_u32 s96, s95, 2097152
    s_add_u32 m0, s94, 16384
    s_nop 0
    buffer_load_dwordx4 v20, s[80:83], s96 offen lds
    ds_read_b64_tr_b16 a[116:117], v46 offset:20480
    ds_read_b64_tr_b16 a[118:119], v46 offset:20992
    s_add_u32 m0, s94, 17408
    s_nop 0
    buffer_load_dwordx4 v21, s[80:83], s96 offen lds
    ds_read_b64_tr_b16 v[80:81], v45 offset:20480
    ds_read_b64_tr_b16 v[82:83], v45 offset:20992
    s_add_u32 m0, s94, 18432
    s_nop 0
    buffer_load_dwordx4 v22, s[80:83], s96 offen lds
    ds_read_b64_tr_b16 v[84:85], v47 offset:20480
    ds_read_b64_tr_b16 v[86:87], v47 offset:20992
    s_add_u32 m0, s94, 19456
    s_nop 0
    buffer_load_dwordx4 v23, s[80:83], s96 offen lds
    s_waitcnt vmcnt(28) lgkmcnt(0)
    s_barrier
    ds_read_b64_tr_b16 a[120:121], v44 offset:24576
    ds_read_b64_tr_b16 a[122:123], v44 offset:25088
    s_add_u32 s96, s95, 2621440
    s_add_u32 m0, s94, 20480
    s_nop 0
    buffer_load_dwordx4 v20, s[80:83], s96 offen lds
    ds_read_b64_tr_b16 a[124:125], v46 offset:24576
    ds_read_b64_tr_b16 a[126:127], v46 offset:25088
    s_add_u32 m0, s94, 21504
    s_nop 0
    buffer_load_dwordx4 v21, s[80:83], s96 offen lds
    ds_read_b64_tr_b16 v[88:89], v45 offset:24576
    ds_read_b64_tr_b16 v[90:91], v45 offset:25088
    s_add_u32 m0, s94, 22528
    s_nop 0
    buffer_load_dwordx4 v22, s[80:83], s96 offen lds
    ds_read_b64_tr_b16 v[92:93], v47 offset:24576
    ds_read_b64_tr_b16 v[94:95], v47 offset:25088
    s_add_u32 m0, s94, 23552
    s_nop 0
    buffer_load_dwordx4 v23, s[80:83], s96 offen lds
    s_waitcnt vmcnt(28) lgkmcnt(0)
    s_barrier
    ds_read_b64_tr_b16 a[128:129], v44 offset:28672
    ds_read_b64_tr_b16 a[130:131], v44 offset:29184
    s_add_u32 s96, s95, 3145728
    s_add_u32 m0, s94, 24576
    s_nop 0
    buffer_load_dwordx4 v20, s[80:83], s96 offen lds
    ds_read_b64_tr_b16 a[132:133], v46 offset:28672
    ds_read_b64_tr_b16 a[134:135], v46 offset:29184
    s_add_u32 m0, s94, 25600
    s_nop 0
    buffer_load_dwordx4 v21, s[80:83], s96 offen lds
    ds_read_b64_tr_b16 v[96:97], v45 offset:28672
    ds_read_b64_tr_b16 v[98:99], v45 offset:29184
    s_add_u32 m0, s94, 26624
    s_nop 0
    buffer_load_dwordx4 v22, s[80:83], s96 offen lds
    ds_read_b64_tr_b16 v[100:101], v47 offset:28672
    ds_read_b64_tr_b16 v[102:103], v47 offset:29184
    s_add_u32 m0, s94, 27648
    s_nop 0
    buffer_load_dwordx4 v23, s[80:83], s96 offen lds
    s_waitcnt vmcnt(28) lgkmcnt(0)
    s_barrier
    ds_read_b64_tr_b16 a[136:137], v44 offset:32768
    ds_read_b64_tr_b16 a[138:139], v44 offset:33280
    s_add_u32 s96, s95, 3670016
    s_add_u32 m0, s94, 28672
    s_nop 0
    buffer_load_dwordx4 v20, s[80:83], s96 offen lds
    ds_read_b64_tr_b16 a[140:141], v46 offset:32768
    ds_read_b64_tr_b16 a[142:143], v46 offset:33280
    s_add_u32 m0, s94, 29696
    s_nop 0
    buffer_load_dwordx4 v21, s[80:83], s96 offen lds
    ds_read_b64_tr_b16 v[104:105], v45 offset:32768
    ds_read_b64_tr_b16 v[106:107], v45 offset:33280
    s_add_u32 m0, s94, 30720
    s_nop 0
    buffer_load_dwordx4 v22, s[80:83], s96 offen lds
    ds_read_b64_tr_b16 v[108:109], v47 offset:32768
    ds_read_b64_tr_b16 v[110:111], v47 offset:33280
    s_add_u32 m0, s94, 31744
    s_nop 0
    buffer_load_dwordx4 v23, s[80:83], s96 offen lds
    s_waitcnt vmcnt(28) lgkmcnt(0)
    s_barrier
    ds_read_b64_tr_b16 v[112:113], v44 offset:0
    ds_read_b64_tr_b16 v[114:115], v44 offset:512
    s_add_u32 s96, s95, 4194304
    s_add_u32 m0, s94, 32768
    s_nop 0
    buffer_load_dwordx4 v20, s[80:83], s96 offen lds
    ds_read_b64_tr_b16 v[116:117], v46 offset:0
    ds_read_b64_tr_b16 v[118:119], v46 offset:512
    s_add_u32 m0, s94, 33792
    s_nop 0
    buffer_load_dwordx4 v21, s[80:83], s96 offen lds
    ds_read_b64_tr_b16 v[184:185], v45 offset:0
    ds_read_b64_tr_b16 v[186:187], v45 offset:512
    s_add_u32 m0, s94, 34816
    s_nop 0
    buffer_load_dwordx4 v22, s[80:83], s96 offen lds
    ds_read_b64_tr_b16 v[188:189], v47 offset:0
    ds_read_b64_tr_b16 v[190:191], v47 offset:512
    s_add_u32 m0, s94, 35840
    s_nop 0
    buffer_load_dwordx4 v23, s[80:83], s96 offen lds
    s_waitcnt vmcnt(28) lgkmcnt(0)
    s_barrier
    ds_read_b64_tr_b16 v[120:121], v44 offset:4096
    ds_read_b64_tr_b16 v[122:123], v44 offset:4608
    s_add_u32 s96, s97, 0
    s_add_u32 m0, s94, 0
    s_nop 0
    buffer_load_dwordx4 v26, s[84:87], s96 offen lds
    ds_read_b64_tr_b16 v[124:125], v46 offset:4096
    ds_read_b64_tr_b16 v[126:127], v46 offset:4608
    s_add_u32 s96, s97, 36864
    s_add_u32 m0, s94, 1024
    s_nop 0
    buffer_load_dwordx4 v26, s[84:87], s96 offen lds
    ds_read_b64_tr_b16 v[192:193], v45 offset:4096
    ds_read_b64_tr_b16 v[194:195], v45 offset:4608
    s_add_u32 s96, s97, 73728
    s_add_u32 m0, s94, 2048
    s_nop 0
    buffer_load_dwordx4 v26, s[84:87], s96 offen lds
    ds_read_b64_tr_b16 v[196:197], v47 offset:4096
    ds_read_b64_tr_b16 v[198:199], v47 offset:4608
    s_add_u32 s96, s97, 110592
    s_add_u32 m0, s94, 3072
    s_nop 0
    buffer_load_dwordx4 v26, s[84:87], s96 offen lds
    s_waitcnt vmcnt(28) lgkmcnt(0)
    s_barrier
    ds_read_b64_tr_b16 v[128:129], v44 offset:8192
    ds_read_b64_tr_b16 v[130:131], v44 offset:8704
    s_add_u32 s96, s97, 128
    s_add_u32 m0, s94, 4096
    s_nop 0
    buffer_load_dwordx4 v26, s[84:87], s96 offen lds
    ds_read_b64_tr_b16 v[132:133], v46 offset:8192
    ds_read_b64_tr_b16 v[134:135], v46 offset:8704
    s_add_u32 s96, s97, 36992
    s_add_u32 m0, s94, 5120
    s_nop 0
    buffer_load_dwordx4 v26, s[84:87], s96 offen lds
    ds_read_b64_tr_b16 v[200:201], v45 offset:8192
    ds_read_b64_tr_b16 v[202:203], v45 offset:8704
    s_add_u32 s96, s97, 73856
    s_add_u32 m0, s94, 6144
    s_nop 0
    buffer_load_dwordx4 v26, s[84:87], s96 offen lds
    ds_read_b64_tr_b16 v[204:205], v47 offset:8192
    ds_read_b64_tr_b16 v[206:207], v47 offset:8704
    s_add_u32 s96, s97, 110720
    s_add_u32 m0, s94, 7168
    s_nop 0
    buffer_load_dwordx4 v26, s[84:87], s96 offen lds
    s_waitcnt vmcnt(28) lgkmcnt(0)
    s_barrier
    ds_read_b64_tr_b16 v[136:137], v44 offset:12288
    ds_read_b64_tr_b16 v[138:139], v44 offset:12800
    s_add_u32 s96, s97, 256
    s_add_u32 m0, s94, 8192
    s_nop 0
    buffer_load_dwordx4 v26, s[84:87], s96 offen lds
    ds_read_b64_tr_b16 v[140:141], v46 offset:12288
    ds_read_b64_tr_b16 v[142:143], v46 offset:12800
    s_add_u32 s96, s97, 37120
    s_add_u32 m0, s94, 9216
    s_nop 0
    buffer_load_dwordx4 v26, s[84:87], s96 offen lds
    ds_read_b64_tr_b16 v[208:209], v45 offset:12288
    ds_read_b64_tr_b16 v[210:211], v45 offset:12800
    s_add_u32 s96, s97, 73984
    s_add_u32 m0, s94, 10240
    s_nop 0
    buffer_load_dwordx4 v26, s[84:87], s96 offen lds
    ds_read_b64_tr_b16 v[212:213], v47 offset:12288
    ds_read_b64_tr_b16 v[214:215], v47 offset:12800
    s_add_u32 s96, s97, 110848
    s_add_u32 m0, s94, 11264
    s_nop 0
    buffer_load_dwordx4 v26, s[84:87], s96 offen lds
    s_waitcnt vmcnt(28) lgkmcnt(0)
    s_barrier
    ds_read_b64_tr_b16 v[144:145], v44 offset:16384
    ds_read_b64_tr_b16 v[146:147], v44 offset:16896
    s_add_u32 s96, s97, 384
    s_add_u32 m0, s94, 12288
    s_nop 0
    buffer_load_dwordx4 v26, s[84:87], s96 offen lds
    ds_read_b64_tr_b16 v[148:149], v46 offset:16384
    ds_read_b64_tr_b16 v[150:151], v46 offset:16896
    s_add_u32 s96, s97, 37248
    s_add_u32 m0, s94, 13312
    s_nop 0
    buffer_load_dwordx4 v26, s[84:87], s96 offen lds
    ds_read_b64_tr_b16 v[216:217], v45 offset:16384
    ds_read_b64_tr_b16 v[218:219], v45 offset:16896
    s_add_u32 s96, s97, 74112
    s_add_u32 m0, s94, 14336
    s_nop 0
    buffer_load_dwordx4 v26, s[84:87], s96 offen lds
    ds_read_b64_tr_b16 v[220:221], v47 offset:16384
    ds_read_b64_tr_b16 v[222:223], v47 offset:16896
    s_add_u32 s96, s97, 110976
    s_add_u32 m0, s94, 15360
    s_nop 0
    buffer_load_dwordx4 v26, s[84:87], s96 offen lds
    s_waitcnt vmcnt(28) lgkmcnt(0)
    s_barrier
    ds_read_b64_tr_b16 v[152:153], v44 offset:20480
    ds_read_b64_tr_b16 v[154:155], v44 offset:20992
    s_add_u32 s96, s97, 512
    s_add_u32 m0, s94, 16384
    s_nop 0
    buffer_load_dwordx4 v26, s[84:87], s96 offen lds
    ds_read_b64_tr_b16 v[156:157], v46 offset:20480
    ds_read_b64_tr_b16 v[158:159], v46 offset:20992
    s_add_u32 s96, s97, 37376
    s_add_u32 m0, s94, 17408
    s_nop 0
    buffer_load_dwordx4 v26, s[84:87], s96 offen lds
    ds_read_b64_tr_b16 v[224:225], v45 offset:20480
    ds_read_b64_tr_b16 v[226:227], v45 offset:20992
    s_add_u32 s96, s97, 74240
    s_add_u32 m0, s94, 18432
    s_nop 0
    buffer_load_dwordx4 v26, s[84:87], s96 offen lds
    ds_read_b64_tr_b16 v[228:229], v47 offset:20480
    ds_read_b64_tr_b16 v[230:231], v47 offset:20992
    s_add_u32 s96, s97, 111104
    s_add_u32 m0, s94, 19456
    s_nop 0
    buffer_load_dwordx4 v26, s[84:87], s96 offen lds
    s_waitcnt vmcnt(28) lgkmcnt(0)
    s_barrier
    ds_read_b64_tr_b16 v[160:161], v44 offset:24576
    ds_read_b64_tr_b16 v[162:163], v44 offset:25088
    s_add_u32 s96, s97, 640
    s_add_u32 m0, s94, 20480
    s_nop 0
    buffer_load_dwordx4 v26, s[84:87], s96 offen lds
    ds_read_b64_tr_b16 v[164:165], v46 offset:24576
    ds_read_b64_tr_b16 v[166:167], v46 offset:25088
    s_add_u32 s96, s97, 37504
    s_add_u32 m0, s94, 21504
    s_nop 0
    buffer_load_dwordx4 v26, s[84:87], s96 offen lds
    ds_read_b64_tr_b16 v[232:233], v45 offset:24576
    ds_read_b64_tr_b16 v[234:235], v45 offset:25088
    s_add_u32 s96, s97, 74368
    s_add_u32 m0, s94, 22528
    s_nop 0
    buffer_load_dwordx4 v26, s[84:87], s96 offen lds
    ds_read_b64_tr_b16 v[236:237], v47 offset:24576
    ds_read_b64_tr_b16 v[238:239], v47 offset:25088
    s_add_u32 s96, s97, 111232
    s_add_u32 m0, s94, 23552
    s_nop 0
    buffer_load_dwordx4 v26, s[84:87], s96 offen lds
    s_waitcnt vmcnt(28) lgkmcnt(0)
    s_barrier
    ds_read_b64_tr_b16 v[168:169], v44 offset:28672
    ds_read_b64_tr_b16 v[170:171], v44 offset:29184
    s_add_u32 s96, s97, 768
    s_add_u32 m0, s94, 24576
    s_nop 0
    buffer_load_dwordx4 v26, s[84:87], s96 offen lds
    ds_read_b64_tr_b16 v[172:173], v46 offset:28672
    ds_read_b64_tr_b16 v[174:175], v46 offset:29184
    s_add_u32 s96, s97, 37632
    s_add_u32 m0, s94, 25600
    s_nop 0
    buffer_load_dwordx4 v26, s[84:87], s96 offen lds
    ds_read_b64_tr_b16 v[240:241], v45 offset:28672
    ds_read_b64_tr_b16 v[242:243], v45 offset:29184
    s_add_u32 s96, s97, 74496
    s_add_u32 m0, s94, 26624
    s_nop 0
    buffer_load_dwordx4 v26, s[84:87], s96 offen lds
    ds_read_b64_tr_b16 v[244:245], v47 offset:28672
    ds_read_b64_tr_b16 v[246:247], v47 offset:29184
    s_add_u32 s96, s97, 111360
    s_add_u32 m0, s94, 27648
    s_nop 0
    buffer_load_dwordx4 v26, s[84:87], s96 offen lds
    s_waitcnt vmcnt(28) lgkmcnt(0)
    s_barrier
    ds_read_b64_tr_b16 v[176:177], v44 offset:32768
    ds_read_b64_tr_b16 v[178:179], v44 offset:33280
    s_add_u32 s96, s97, 896
    s_add_u32 m0, s94, 28672
    s_nop 0
    buffer_load_dwordx4 v26, s[84:87], s96 offen lds
    ds_read_b64_tr_b16 v[180:181], v46 offset:32768
    ds_read_b64_tr_b16 v[182:183], v46 offset:33280
    s_add_u32 s96, s97, 37760
    s_add_u32 m0, s94, 29696
    s_nop 0
    buffer_load_dwordx4 v26, s[84:87], s96 offen lds
    ds_read_b64_tr_b16 v[248:249], v45 offset:32768
    ds_read_b64_tr_b16 v[250:251], v45 offset:33280
    s_add_u32 s96, s97, 74624
    s_add_u32 m0, s94, 30720
    s_nop 0
    buffer_load_dwordx4 v26, s[84:87], s96 offen lds
    ds_read_b64_tr_b16 v[252:253], v47 offset:32768
    ds_read_b64_tr_b16 v[254:255], v47 offset:33280
    s_add_u32 s96, s97, 111488
    s_add_u32 m0, s94, 31744
    s_nop 0
    buffer_load_dwordx4 v26, s[84:87], s96 offen lds
    s_waitcnt lgkmcnt(0)
    s_barrier
    s_add_u32 s96, s97, 1024
    s_add_u32 m0, s94, 32768
    s_nop 0
    buffer_load_dwordx4 v26, s[84:87], s96 offen lds
    s_add_u32 s96, s97, 37888
    s_add_u32 m0, s94, 33792
    s_nop 0
    buffer_load_dwordx4 v26, s[84:87], s96 offen lds
    s_add_u32 s96, s97, 74752
    s_add_u32 m0, s94, 34816
    s_nop 0
    buffer_load_dwordx4 v26, s[84:87], s96 offen lds
    s_add_u32 s96, s97, 111616
    s_add_u32 m0, s94, 35840
    s_nop 0
    buffer_load_dwordx4 v26, s[84:87], s96 offen lds
    v_mov_b32 v10, 64
    v_lshrrev_b32 v11, 2, v0
    global_load_dword v76, v10, s[92:93] sc1
    global_load_dword v78, v10, s[92:93] offset:128 sc1
    v_mov_b32 v79, 0
    buffer_load_dword v19, v11, s[8:11], s69 offen sc1
    v_lshlrev_b32 v77, 2, v0
    buffer_load_dword v72, v77, s[8:11], s36 offen sc1
    s_xor_b32 s15, s36, 524288
    buffer_load_dword v72, v77, s[8:11], s15 offen sc1
    s_mov_b32 exec_hi, 0
    s_add_u32 s15, s26, 1064960
    buffer_load_dwordx2 v[72:73], v1, s[8:11], s15 offen sc1
    s_add_u32 s15, s26, 1081344
    buffer_load_dwordx2 v[72:73], v1, s[8:11], s15 offen sc1
    s_add_u32 s15, s26, 1097728
    buffer_load_dwordx2 v[72:73], v1, s[8:11], s15 offen sc1
    s_mov_b32 exec_hi, -1
    s_waitcnt vmcnt(40)
    ds_read_b64_tr_b16 v[40:41], v39 offset:0
    ds_read_b64_tr_b16 v[42:43], v39 offset:512
    ds_read_b64_tr_b16 v[44:45], v39 offset:1024
    ds_read_b64_tr_b16 v[46:47], v39 offset:1536
    ds_read_b64_tr_b16 v[48:49], v39 offset:2048
    ds_read_b64_tr_b16 v[50:51], v39 offset:2560
    ds_read_b64_tr_b16 v[52:53], v39 offset:3072
    ds_read_b64_tr_b16 v[54:55], v39 offset:3584
    s_waitcnt lgkmcnt(0)
    ds_write_b128 v7, v[40:43] offset:0
    ds_write_b128 v7, v[44:47] offset:1024
    ds_write_b128 v7, v[48:51] offset:2048
    ds_write_b128 v7, v[52:55] offset:3072
    s_waitcnt vmcnt(36)
    ds_read_b64_tr_b16 v[56:57], v39 offset:4096
    ds_read_b64_tr_b16 v[58:59], v39 offset:4608
    ds_read_b64_tr_b16 v[60:61], v39 offset:5120
    ds_read_b64_tr_b16 v[62:63], v39 offset:5632
    ds_read_b64_tr_b16 v[64:65], v39 offset:6144
    ds_read_b64_tr_b16 v[66:67], v39 offset:6656
    ds_read_b64_tr_b16 v[68:69], v39 offset:7168
    ds_read_b64_tr_b16 v[70:71], v39 offset:7680
    s_waitcnt lgkmcnt(0)
    ds_write_b128 v7, v[56:59] offset:4096
    ds_write_b128 v7, v[60:63] offset:5120
    ds_write_b128 v7, v[64:67] offset:6144
    ds_write_b128 v7, v[68:71] offset:7168
    s_waitcnt vmcnt(32)
    ds_read_b64_tr_b16 v[40:41], v39 offset:8192
    ds_read_b64_tr_b16 v[42:43], v39 offset:8704
    ds_read_b64_tr_b16 v[44:45], v39 offset:9216
    ds_read_b64_tr_b16 v[46:47], v39 offset:9728
    ds_read_b64_tr_b16 v[48:49], v39 offset:10240
    ds_read_b64_tr_b16 v[50:51], v39 offset:10752
    ds_read_b64_tr_b16 v[52:53], v39 offset:11264
    ds_read_b64_tr_b16 v[54:55], v39 offset:11776
    s_waitcnt lgkmcnt(0)
    ds_write_b128 v7, v[40:43] offset:8192
    ds_write_b128 v7, v[44:47] offset:9216
    ds_write_b128 v7, v[48:51] offset:10240
    ds_write_b128 v7, v[52:55] offset:11264
    s_waitcnt vmcnt(28)
    ds_read_b64_tr_b16 v[56:57], v39 offset:12288
    ds_read_b64_tr_b16 v[58:59], v39 offset:12800
    ds_read_b64_tr_b16 v[60:61], v39 offset:13312
    ds_read_b64_tr_b16 v[62:63], v39 offset:13824
    ds_read_b64_tr_b16 v[64:65], v39 offset:14336
    ds_read_b64_tr_b16 v[66:67], v39 offset:14848
    ds_read_b64_tr_b16 v[68:69], v39 offset:15360
    ds_read_b64_tr_b16 v[70:71], v39 offset:15872
    s_waitcnt lgkmcnt(0)
    ds_write_b128 v7, v[56:59] offset:12288
    ds_write_b128 v7, v[60:63] offset:13312
    ds_write_b128 v7, v[64:67] offset:14336
    ds_write_b128 v7, v[68:71] offset:15360
    s_waitcnt vmcnt(24)
    ds_read_b64_tr_b16 v[40:41], v39 offset:16384
    ds_read_b64_tr_b16 v[42:43], v39 offset:16896
    ds_read_b64_tr_b16 v[44:45], v39 offset:17408
    ds_read_b64_tr_b16 v[46:47], v39 offset:17920
    ds_read_b64_tr_b16 v[48:49], v39 offset:18432
    ds_read_b64_tr_b16 v[50:51], v39 offset:18944
    ds_read_b64_tr_b16 v[52:53], v39 offset:19456
    ds_read_b64_tr_b16 v[54:55], v39 offset:19968
    s_waitcnt lgkmcnt(0)
    ds_write_b128 v7, v[40:43] offset:16384
    ds_write_b128 v7, v[44:47] offset:17408
    ds_write_b128 v7, v[48:51] offset:18432
    ds_write_b128 v7, v[52:55] offset:19456
    s_waitcnt vmcnt(20)
    ds_read_b64_tr_b16 v[56:57], v39 offset:20480
    ds_read_b64_tr_b16 v[58:59], v39 offset:20992
    ds_read_b64_tr_b16 v[60:61], v39 offset:21504
    ds_read_b64_tr_b16 v[62:63], v39 offset:22016
    ds_read_b64_tr_b16 v[64:65], v39 offset:22528
    ds_read_b64_tr_b16 v[66:67], v39 offset:23040
    ds_read_b64_tr_b16 v[68:69], v39 offset:23552
    ds_read_b64_tr_b16 v[70:71], v39 offset:24064
    s_waitcnt lgkmcnt(0)
    ds_write_b128 v7, v[56:59] offset:20480
    ds_write_b128 v7, v[60:63] offset:21504
    ds_write_b128 v7, v[64:67] offset:22528
    ds_write_b128 v7, v[68:71] offset:23552
    s_waitcnt vmcnt(16)
    ds_read_b64_tr_b16 v[40:41], v39 offset:24576
    ds_read_b64_tr_b16 v[42:43], v39 offset:25088
    ds_read_b64_tr_b16 v[44:45], v39 offset:25600
    ds_read_b64_tr_b16 v[46:47], v39 offset:26112
    ds_read_b64_tr_b16 v[48:49], v39 offset:26624
    ds_read_b64_tr_b16 v[50:51], v39 offset:27136
    ds_read_b64_tr_b16 v[52:53], v39 offset:27648
    ds_read_b64_tr_b16 v[54:55], v39 offset:28160
    s_waitcnt lgkmcnt(0)
    ds_write_b128 v7, v[40:43] offset:24576
    ds_write_b128 v7, v[44:47] offset:25600
    ds_write_b128 v7, v[48:51] offset:26624
    ds_write_b128 v7, v[52:55] offset:27648
    s_waitcnt vmcnt(12)
    ds_read_b64_tr_b16 v[56:57], v39 offset:28672
    ds_read_b64_tr_b16 v[58:59], v39 offset:29184
    ds_read_b64_tr_b16 v[60:61], v39 offset:29696
    ds_read_b64_tr_b16 v[62:63], v39 offset:30208
    ds_read_b64_tr_b16 v[64:65], v39 offset:30720
    ds_read_b64_tr_b16 v[66:67], v39 offset:31232
    ds_read_b64_tr_b16 v[68:69], v39 offset:31744
    ds_read_b64_tr_b16 v[70:71], v39 offset:32256
    s_waitcnt lgkmcnt(0)
    ds_write_b128 v7, v[56:59] offset:28672
    ds_write_b128 v7, v[60:63] offset:29696
    ds_write_b128 v7, v[64:67] offset:30720
    ds_write_b128 v7, v[68:71] offset:31744
    s_waitcnt vmcnt(8)
    ds_read_b64_tr_b16 v[40:41], v39 offset:32768
    ds_read_b64_tr_b16 v[42:43], v39 offset:33280
    ds_read_b64_tr_b16 v[44:45], v39 offset:33792
    ds_read_b64_tr_b16 v[46:47], v39 offset:34304
    ds_read_b64_tr_b16 v[48:49], v39 offset:34816
    ds_read_b64_tr_b16 v[50:51], v39 offset:35328
    ds_read_b64_tr_b16 v[52:53], v39 offset:35840
    ds_read_b64_tr_b16 v[54:55], v39 offset:36352
    s_waitcnt lgkmcnt(0)
    ds_write_b128 v7, v[40:43] offset:32768
    ds_write_b128 v7, v[44:47] offset:33792
    ds_write_b128 v7, v[48:51] offset:34816
    ds_write_b128 v7, v[52:55] offset:35840
    s_waitcnt vmcnt(0)
    s_branch C_wi2
C_wi:
    global_load_dword v76, v10, s[92:93] sc1
    global_load_dword v79, v10, s[92:93] offset:-32 sc1
    s_waitcnt vmcnt(0)
    global_load_dword v78, v10, s[92:93] offset:128 sc1
    buffer_load_dword v19, v11, s[8:11], s69 offen sc1
    s_waitcnt vmcnt(0)
C_wi2:
    v_readfirstlane_b32 s15, v76
    v_readfirstlane_b32 s96, v78
    v_readfirstlane_b32 s97, v79
    v_cmp_eq_u32 s[2:3], v18, v19
    s_add_u32 s37, s37, 1
    s_cmp_gt_u32 s37, 0x100000
    s_cbranch_scc1 C_wfd
    s_cmp_lt_u32 s15, 45
    s_cbranch_scc1 C_wi
    s_bitcmp1_b64 s[2:3], 0
    s_cbranch_scc0 C_wi
    s_cmp_ge_u32 s96, 32
    s_cbranch_scc1 C_wfd
    s_add_u32 s97, s97, s96
    s_cmp_lt_u32 s97, 256
    s_cbranch_scc1 C_wi
C_wfd:
    s_waitcnt lgkmcnt(0)
    buffer_load_dwordx4 v[44:47], v0, s[8:11], s23 offen sc1
    buffer_load_dwordx4 v[48:51], v0, s[8:11], s23 offen offset:1024 sc1
    v_mov_b64 v[20:21], 0
    v_mov_b64 v[22:23], 0
    v_mov_b64 v[24:25], 0
    v_mov_b64 v[26:27], 0
    v_mov_b64 v[28:29], 0
    v_mov_b64 v[30:31], 0
    v_mov_b64 v[32:33], 0
    v_mov_b64 v[34:35], 0
    v_mov_b64 v[36:37], 0
    v_mov_b64 v[38:39], 0
    v_mov_b64 v[40:41], 0
    v_mov_b64 v[42:43], 0
    s_cmp_lt_u32 s96, 32
    s_cbranch_scc1 S_start
    s_bitcmp1_b32 s12, 0
    s_cbranch_scc1 F_ok0
    s_xor_b32 s54, s54, 524288
    s_xor_b32 s55, s55, 524288
    s_xor_b32 s56, s56, 524288
    s_xor_b32 s57, s57, 524288
    s_xor_b32 s58, s58, 524288
    s_xor_b32 s59, s59, 524288
    s_xor_b32 s60, s60, 524288
    s_xor_b32 s61, s61, 524288
    s_branch F_loop
.p2align 6
    s_nop 0
    s_nop 0
    s_nop 0
    s_nop 0
    s_nop 0
    s_nop 0
    s_nop 0
    s_nop 0
F_loop:
    buffer_load_dwordx4 v[52:55], v0, s[8:11], s18 offen offset:0 sc1
    buffer_load_dwordx4 v[56:59], v0, s[8:11], s18 offen offset:1024 sc1
    v_add_u32 v11, s38, v0
    v_mov_b64 v[20:21], 0
    v_mov_b64 v[22:23], 0
    v_mov_b64 v[24:25], 0
    v_mov_b64 v[26:27], 0
    v_mov_b64 v[28:29], 0
    v_mov_b64 v[30:31], 0
    v_mov_b64 v[32:33], 0
    v_mov_b64 v[34:35], 0
    v_mov_b64 v[36:37], 0
    v_mov_b64 v[38:39], 0
    v_mov_b64 v[40:41], 0
    v_mov_b64_e64 v[42:43], 0
    s_xor_b32 s54, s54, 524288
    s_xor_b32 s55, s55, 524288
    s_xor_b32 s56, s56, 524288
    s_xor_b32 s57, s57, 524288
    s_xor_b32 s58, s58, 524288
    s_xor_b32 s59, s59, 524288
    s_xor_b32 s60, s60, 524288
    s_xor_b32 s61, s61, 524288
F_la:
    buffer_load_dwordx4 v[52:55], v0, s[8:11], s18 offen offset:0 sc1
    buffer_load_dwordx4 v[56:59], v0, s[8:11], s18 offen offset:1024 sc1
    s_waitcnt vmcnt(3)
    v_cmp_u_f32 s[40:41], v52, v54
    ds_write_b128 v11, v[52:55] offset:0
    s_waitcnt vmcnt(2)
    v_cmp_u_f32_e64 vcc, v56, v58
    ds_write_b128 v11, v[56:59] offset:1024
    s_or_b64 vcc, vcc, s[40:41]
    s_cbranch_vccnz F_rt0
F_ok0:
    v_cmp_eq_u32 s[2:3], v18, v19
    s_add_u32 s15, s23, 524288
    s_add_u32 s14, s14, 1
    v_add_u32 v11, s43, v0
    s_waitcnt lgkmcnt(0)
    s_barrier
    ds_read_b128 v[60:63], v0 offset:7168
    ds_read_b128 v[64:67], v0 offset:8192
    ds_read_b128 v[68:71], v0 offset:9216
    ds_read_b128 v[72:75], v0 offset:10240
    s_waitcnt lgkmcnt(3)
    v_smfmac_f32_16x16x64_bf16 v[20:23], v[60:63], a[0:7], v8
    v_smfmac_f32_16x16x64_bf16 v[24:27], v[60:63], a[72:79], v8
    v_smfmac_f32_16x16x64_bf16 v[28:31], v[60:63], a[144:151], v8
    v_smfmac_f32_16x16x64_bf16 v[32:35], v[60:63], a[216:223], v8
    buffer_load_dwordx4 v[76:79], v0, s[8:11], s39 offen offset:0 sc1
    v_smfmac_f32_16x16x64_bf16 v[36:39], v[60:63], v[112:119], v8
    s_mov_b32 exec_hi, 0xffff
    buffer_load_dwordx4 v[52:55], v0, s[8:11], s21 offen sc1
    s_mov_b32 exec_hi, -1
    v_smfmac_f32_16x16x64_bf16 v[40:43], v[60:63], v[184:191], v8
    s_waitcnt lgkmcnt(2)
    v_smfmac_f32_16x16x64_bf16 v[20:23], v[64:67], a[8:15], v8
    buffer_load_dwordx4 v[60:63], v0, s[8:11], s39 offen offset:1024 sc1
    v_smfmac_f32_16x16x64_bf16 v[24:27], v[64:67], a[80:87], v8
    v_smfmac_f32_16x16x64_bf16 v[28:31], v[64:67], a[152:159], v8
    v_smfmac_f32_16x16x64_bf16 v[32:35], v[64:67], a[224:231], v8
    v_smfmac_f32_16x16x64_bf16 v[36:39], v[64:67], v[120:127], v8
    v_smfmac_f32_16x16x64_bf16 v[40:43], v[64:67], v[192:199], v8
    s_waitcnt lgkmcnt(1)
    v_smfmac_f32_16x16x64_bf16 v[20:23], v[68:71], a[16:23], v8
    v_smfmac_f32_16x16x64_bf16 v[24:27], v[68:71], a[88:95], v8
    v_smfmac_f32_16x16x64_bf16 v[28:31], v[68:71], a[160:167], v8
    v_smfmac_f32_16x16x64_bf16 v[32:35], v[68:71], a[232:239], v8
    v_smfmac_f32_16x16x64_bf16 v[36:39], v[68:71], v[128:135], v8
    v_smfmac_f32_16x16x64_bf16 v[40:43], v[68:71], v[200:207], v8
    s_waitcnt lgkmcnt(0)
    v_smfmac_f32_16x16x64_bf16 v[20:23], v[72:75], a[24:31], v8
    v_smfmac_f32_16x16x64_bf16 v[24:27], v[72:75], a[96:103], v8
    v_smfmac_f32_16x16x64_bf16 v[28:31], v[72:75], a[168:175], v8
    v_smfmac_f32_16x16x64_bf16 v[32:35], v[72:75], a[240:247], v8
    s_waitcnt vmcnt(2)
    v_cmp_u_f32_e64 vcc, v76, v78
    v_smfmac_f32_16x16x64_bf16 v[36:39], v[72:75], v[136:143], v8
    v_smfmac_f32_16x16x64_bf16 v[40:43], v[72:75], v[208:215], v8
    s_cbranch_vccnz F_rt2
F_ok2:
    v_smfmac_f32_16x16x64_bf16 v[20:23], v[76:79], a[32:39], v8
    s_waitcnt vmcnt(1)
    s_mov_b32 exec_hi, 0xffff
    v_cmp_u_f32_e64 vcc, v52, v54
    ds_write_b128 v11, v[52:55]
    s_mov_b32 exec_hi, -1
    v_smfmac_f32_16x16x64_bf16 v[24:27], v[76:79], a[104:111], v8
    s_waitcnt vmcnt(0)
    v_cmp_u_f32 s[40:41], v60, v62
    v_smfmac_f32_16x16x64_bf16 v[28:31], v[76:79], a[176:183], v8
    v_smfmac_f32_16x16x64_bf16 v[32:35], v[76:79], a[248:255], v8
    s_or_b64 vcc, vcc, s[40:41]
    s_cbranch_vccnz F_rt1
F_ok1:
    s_bitcmp1_b64 s[2:3], s14
    s_waitcnt lgkmcnt(0)
    s_barrier
    ds_read_b128 v[64:67], v0 offset:13312
    ds_read_b128 v[68:71], v0 offset:14336
    ds_read_b128 v[72:75], v0 offset:15360
    s_cbranch_scc0 F_fl
F_flok:
    s_cmp_eq_u64 s[2:3], -1
    v_smfmac_f32_16x16x64_bf16 v[20:23], v[60:63], a[40:47], v8
    s_cbranch_scc0 F_fa
F_fad:
    v_smfmac_f32_16x16x64_bf16 v[24:27], v[60:63], a[112:119], v8
    buffer_load_dwordx4 v[52:55], v0, s[8:11], s23 offen offset:2048 sc1
    v_smfmac_f32_16x16x64_bf16 v[28:31], v[60:63], a[184:191], v8
    v_smfmac_f32_16x16x64_bf16 v[32:35], v[60:63], v[80:87], v8
    buffer_load_dwordx4 v[56:59], v0, s[8:11], s23 offen offset:3072 sc1
    s_waitcnt lgkmcnt(2)
    v_smfmac_f32_16x16x64_bf16 v[20:23], v[64:67], a[48:55], v8
    v_mov_b64 v[10:11], -1
    s_mov_b32 exec_hi, 0
    buffer_store_dwordx4 v[16:19], v9, s[8:11], s25 offen sc1
    v_smfmac_f32_16x16x64_bf16 v[24:27], v[64:67], a[120:127], v8
    buffer_store_dwordx2 v[10:11], v1, s[8:11], s65 offen
    s_mov_b32 exec_hi, -1
    v_lshlrev_b32_e64 v11, 2, v0
    v_smfmac_f32_16x16x64_bf16 v[28:31], v[64:67], a[192:199], v8
    buffer_store_dword v10, v11, s[8:11], s36 offen
    v_smfmac_f32_16x16x64_bf16 v[32:35], v[64:67], v[88:95], v8
    buffer_store_dword v10, v11, s[8:11], s36 offen offset:8
    s_waitcnt lgkmcnt(1)
    v_smfmac_f32_16x16x64_bf16 v[20:23], v[68:71], a[56:63], v8
    v_smfmac_f32_16x16x64_bf16 v[24:27], v[68:71], a[128:135], v8
    v_smfmac_f32_16x16x64_bf16 v[28:31], v[68:71], a[200:207], v8
    v_smfmac_f32_16x16x64_bf16 v[32:35], v[68:71], v[96:103], v8
    s_waitcnt lgkmcnt(0)
    v_smfmac_f32_16x16x64_bf16 v[20:23], v[72:75], a[64:71], v8
    v_smfmac_f32_16x16x64_bf16 v[24:27], v[72:75], a[136:143], v8
    v_smfmac_f32_16x16x64_bf16 v[28:31], v[72:75], a[208:215], v8
    v_cvt_pk_bf16_f32 v20, v20, v21
    v_smfmac_f32_16x16x64_bf16 v[32:35], v[72:75], v[104:111], v8
    v_cvt_pk_bf16_f32 v21, v22, v23
    v_cvt_pk_bf16_f32 v22, v24, v25
    v_cvt_pk_bf16_f32 v23, v26, v27
    s_nop 0
    v_cvt_pk_bf16_f32 v28, v28, v29
    v_cvt_pk_bf16_f32 v29, v30, v31
    v_mfma_f32_16x16x32_bf16 v[24:27], v[20:23], v[12:15], 0
    s_nop 0
    v_cvt_pk_bf16_f32 v30, v32, v33
    v_cvt_pk_bf16_f32 v31, v34, v35
    s_nop 1
    v_mfma_f32_16x16x32_bf16 v[32:35], v[28:31], v[12:15], 0
    s_nop 1
    v_cvt_pk_bf16_f32 v20, v24, v25
    v_cvt_pk_bf16_f32 v21, v26, v27
    v_smfmac_f32_16x16x64_bf16 v[36:39], v[60:63], v[152:159], v8
    s_nop 2
    s_nop 0
    v_cvt_pk_bf16_f32 v22, v32, v33
    v_cvt_pk_bf16_f32 v23, v34, v35
    v_add_u32 v10, s64, v0
    s_nop 0
    v_mfma_f32_16x16x32_bf16 v[24:27], v[44:47], v[20:23], 0
    v_mfma_f32_16x16x32_bf16 v[28:31], v[48:51], v[20:23], 0
    v_mfma_f32_16x16x32_bf16 v[32:35], v[20:23], v[20:23], 0
    v_smfmac_f32_16x16x64_bf16 v[40:43], v[60:63], v[224:231], v8
    v_mov_b32_dpp v24, v28 row_ror:8 row_mask:0xf bank_mask:0xc
    v_mov_b32_dpp v25, v29 row_ror:8 row_mask:0xf bank_mask:0xc
    v_mov_b32_dpp v26, v30 row_ror:8 row_mask:0xf bank_mask:0xc
    v_mov_b32_dpp v27, v31 row_ror:8 row_mask:0xf bank_mask:0xc
    ds_write_b128 v10, v[24:27] offset:0
    s_mov_b64 exec, s[66:67]
    ds_write_b128 v4, v[32:35] offset:0
    s_mov_b64 exec, -1
    v_smfmac_f32_16x16x64_bf16 v[36:39], v[64:67], v[160:167], v8
    buffer_load_dwordx4 v[44:47], v0, s[8:11], s15 offen sc1
    v_smfmac_f32_16x16x64_bf16 v[40:43], v[64:67], v[232:239], v8
    buffer_load_dwordx4 v[48:51], v0, s[8:11], s15 offen offset:1024 sc1
    v_smfmac_f32_16x16x64_bf16 v[36:39], v[68:71], v[168:175], v8
    v_smfmac_f32_16x16x64_bf16 v[40:43], v[68:71], v[240:247], v8
    s_waitcnt lgkmcnt(0)
    s_barrier
    ds_read_b128 v[60:63], v0 offset:0
    ds_read_b128 v[64:67], v0 offset:1280
    v_smfmac_f32_16x16x64_bf16 v[36:39], v[76:79], v[144:151], v8
    ds_read_b128 v[68:71], v0 offset:2560
    ds_read_b128 v[24:27], v0 offset:3840
    v_smfmac_f32_16x16x64_bf16 v[40:43], v[76:79], v[216:223], v8
    ds_read_b64 v[28:29], v5 offset:0
    ds_read_b64 v[30:31], v5 offset:1280
    v_smfmac_f32_16x16x64_bf16 v[36:39], v[72:75], v[176:183], v8
    ds_read_b64 v[32:33], v5 offset:2560
    ds_read_b64 v[34:35], v5 offset:3840
    v_smfmac_f32_16x16x64_bf16 v[40:43], v[72:75], v[248:255], v8
    s_waitcnt lgkmcnt(6)
    v_pk_add_f32 v[60:61], v[60:61], v[64:65]
    v_pk_add_f32 v[62:63], v[62:63], v[66:67]
    s_waitcnt lgkmcnt(4)
    v_pk_add_f32 v[24:25], v[24:25], v[68:69]
    v_pk_add_f32 v[26:27], v[26:27], v[70:71]
    s_waitcnt lgkmcnt(0)
    s_nop 0
    v_pk_add_f32 v[28:29], v[28:29], v[30:31]
    v_pk_add_f32 v[32:33], v[32:33], v[34:35]
    v_pk_add_f32 v[60:61], v[60:61], v[24:25]
    v_pk_add_f32 v[62:63], v[62:63], v[26:27]
    v_pk_add_f32 v[28:29], v[28:29], v[32:33]
    v_max3_f32 v10, v60, v61, v62
    v_max3_f32 v10, v10, v63, v28
    v_max_f32_e64 v10, v10, v29
    ds_read_b128 v[64:67], v7 offset:1024
    ds_read_b128 v[68:71], v7 offset:2048
    v_max_f32_dpp v10, v10, v10 row_ror:8 row_mask:0xf bank_mask:0xf
    v_mov_b32_e64 v11, v10
    v_cvt_pk_bf16_f32 v20, v36, v37
    v_cvt_pk_bf16_f32 v21, v38, v39
    v_permlane16_swap_b32 v10, v11
    v_max_f32 v10, v10, v11
    v_mov_b32_e64 v11, v10
    v_cvt_pk_bf16_f32 v22, v42, v43
    v_cvt_pk_bf16_f32 v23, v40, v41
    v_permlane32_swap_b32 v10, v11
    v_max_f32 v10, v10, v11
    v_mul_f32_e64 v10, s34, v10
    v_pk_fma_f32 v[60:61], v[60:61], s[34:35], v[10:11] op_sel_hi:[1,1,0] neg_lo:[0,0,1] neg_hi:[0,0,1]
    v_pk_fma_f32 v[62:63], v[62:63], s[34:35], v[10:11] op_sel_hi:[1,1,0] neg_lo:[0,0,1] neg_hi:[0,0,1]
    v_pk_fma_f32 v[28:29], v[28:29], s[34:35], v[10:11] op_sel_hi:[1,1,0] neg_lo:[0,0,1] neg_hi:[0,0,1]
    v_exp_f32 v60, v60
    v_exp_f32 v61, v61
    v_exp_f32 v62, v62
    v_exp_f32 v63, v63
    v_exp_f32 v28, v28
    v_exp_f32 v29, v29
    s_waitcnt vmcnt(6)
    v_swap_b32 v56, v58
    v_cvt_pk_bf16_f32 v24, v60, v61
    v_cvt_pk_bf16_f32 v25, v62, v63
    v_cvt_pk_bf16_f32 v32, v28, v29
    v_mov_b32_dpp v26, v24 row_ror:8 row_mask:0xf bank_mask:0xf
    v_mov_b32_dpp v27, v25 row_ror:8 row_mask:0xf bank_mask:0xf
    v_mov_b32_dpp v33, v32 row_ror:8 row_mask:0xf bank_mask:0xf
    v_swap_b32 v57, v59
    v_mfma_f32_16x16x32_bf16 v[72:75], v[52:55], v[24:27], 0
    v_add_f32 v11, v28, v29
    v_pk_add_f32 v[60:61], v[60:61], v[62:63]
    v_mfma_f32_16x16x32_bf16 v[76:79], v[56:59], v[24:27], 0
    v_add_f32_e64 v10, v60, v61
    v_fmac_f32 v10, 0.5, v11
    v_mfma_f32_16x16x16_bf16 v[72:75], v[20:21], v[32:33], v[72:75]
    s_nop 0
    v_add_f32_dpp v10, v10, v10 row_ror:8 row_mask:0xf bank_mask:0xf
    v_mfma_f32_16x16x16_bf16 v[76:79], v[22:23], v[32:33], v[76:79]
    v_mov_b32_e64 v11, v10
    ds_read_b128 v[32:35], v7 offset:0
    ds_read_b128 v[52:55], v7 offset:3072
    v_permlane16_swap_b32 v10, v11
    v_add_f32 v10, v10, v11
    v_mov_b32 v11, v10
    s_nop 1
    v_mov_b32_dpp v72, v76 quad_perm:[0,1,2,3] row_mask:0xf bank_mask:0xc
    v_mov_b32_dpp v73, v77 quad_perm:[0,1,2,3] row_mask:0xf bank_mask:0xc
    v_permlane32_swap_b32 v10, v11
    v_add_f32 v10, v10, v11
    v_rcp_f32_e64 v10, v10
    v_mov_b32_dpp v74, v78 quad_perm:[0,1,2,3] row_mask:0xf bank_mask:0xc
    v_mov_b32_dpp v75, v79 quad_perm:[0,1,2,3] row_mask:0xf bank_mask:0xc
    v_pk_mul_f32 v[72:73], v[72:73], v[10:11] op_sel_hi:[1,0]
    v_pk_mul_f32 v[74:75], v[74:75], v[10:11] op_sel_hi:[1,0]
    v_cvt_pk_bf16_f32 v72, v72, v73
    v_cvt_pk_bf16_f32 v73, v74, v75
    ds_write_b64 v6, v[72:73]
    ds_read_b128 v[56:59], v7 offset:4096
    ds_read_b128 v[36:39], v7 offset:5120
    ds_read_b128 v[40:43], v7 offset:6144
    s_add_u32 s18, s18, 16384
    s_and_b32 s18, s18, 4294770687
    s_add_u32 s21, s21, 16384
    s_and_b32 s21, s21, 4294770687
    s_add_u32 s39, s39, 16384
    s_and_b32 s39, s39, 4294770687
    s_add_u32 s65, s65, 16384
    s_and_b32 s65, s65, 4294770687
    s_waitcnt lgkmcnt(3)
    s_barrier
    ds_read_b128 v[72:75], v9 offset:0
    ds_read_b128 v[76:79], v9 offset:512
    ds_read_b128 v[28:31], v9 offset:1024
    ds_read_b128 v[60:63], v9 offset:1536
    s_add_u32 s24, s24, 16384
    s_and_b32 s24, s24, 4294770687
    s_add_u32 s23, s23, 524288
    s_add_u32 s25, s25, 32768
    s_xor_b32 s36, s36, 524288
    s_cmp_eq_u32 s12, 0
    v_add_u32 v10, s19, v0
    s_waitcnt lgkmcnt(3)
    v_mfma_f32_16x16x32_bf16 v[20:23], v[32:35], v[72:75], 0
    ds_read_b128 v[32:35], v7 offset:7168
    s_waitcnt lgkmcnt(3)
    v_mfma_f32_16x16x32_bf16 v[20:23], v[64:67], v[76:79], v[20:23]
    ds_read_b128 v[64:67], v7 offset:8192
    s_waitcnt lgkmcnt(3)
    v_mfma_f32_16x16x32_bf16 v[20:23], v[68:71], v[28:31], v[20:23]
    ds_read_b128 v[68:71], v7 offset:9216
    s_waitcnt lgkmcnt(3)
    v_mfma_f32_16x16x32_bf16 v[20:23], v[52:55], v[60:63], v[20:23]
    ds_read_b128 v[52:55], v7 offset:10240
    v_mfma_f32_16x16x32_bf16 v[24:27], v[56:59], v[72:75], 0
    ds_read_b128 v[56:59], v7 offset:11264
    v_mfma_f32_16x16x32_bf16 v[24:27], v[36:39], v[76:79], v[24:27]
    ds_read_b128 v[36:39], v7 offset:12288
    v_cvt_pk_bf16_f32 v20, v20, v21
    s_waitcnt lgkmcnt(5)
    v_mfma_f32_16x16x32_bf16 v[24:27], v[40:43], v[28:31], v[24:27]
    ds_read_b128 v[40:43], v7 offset:13312
    v_cvt_pk_bf16_f32 v21, v22, v23
    v_mfma_f32_16x16x32_bf16 v[24:27], v[32:35], v[60:63], v[24:27]
    ds_read_b128 v[32:35], v7 offset:14336
    buffer_store_dwordx2 v[20:21], v1, s[8:11], s52 offen
    s_waitcnt lgkmcnt(5)
    v_mfma_f32_16x16x32_bf16 v[20:23], v[64:67], v[72:75], 0
    ds_read_b128 v[64:67], v7 offset:15360
    v_mfma_f32_16x16x32_bf16 v[20:23], v[68:71], v[76:79], v[20:23]
    ds_read_b128 v[68:71], v7 offset:16384
    v_cvt_pk_bf16_f32 v24, v24, v25
    s_waitcnt lgkmcnt(5)
    v_mfma_f32_16x16x32_bf16 v[20:23], v[52:55], v[28:31], v[20:23]
    ds_read_b128 v[52:55], v7 offset:17408
    v_cvt_pk_bf16_f32 v25, v26, v27
    v_mfma_f32_16x16x32_bf16 v[20:23], v[56:59], v[60:63], v[20:23]
    ds_read_b128 v[56:59], v7 offset:18432
    buffer_store_dwordx2 v[24:25], v1, s[8:11], s53 offen
    s_waitcnt lgkmcnt(5)
    v_mfma_f32_16x16x32_bf16 v[24:27], v[36:39], v[72:75], 0
    ds_read_b128 v[36:39], v7 offset:19456
    v_mfma_f32_16x16x32_bf16 v[24:27], v[40:43], v[76:79], v[24:27]
    ds_read_b128 v[40:43], v7 offset:20480
    v_cvt_pk_bf16_f32 v20, v20, v21
    s_waitcnt lgkmcnt(5)
    v_mfma_f32_16x16x32_bf16 v[24:27], v[32:35], v[28:31], v[24:27]
    ds_read_b128 v[32:35], v7 offset:21504
    v_cvt_pk_bf16_f32 v21, v22, v23
    v_mfma_f32_16x16x32_bf16 v[24:27], v[64:67], v[60:63], v[24:27]
    ds_read_b128 v[64:67], v7 offset:22528
    buffer_store_dwordx2 v[20:21], v1, s[8:11], s54 offen
    s_cbranch_scc1 F_w0
    s_waitcnt lgkmcnt(5)
    v_mfma_f32_16x16x32_bf16 v[20:23], v[68:71], v[72:75], 0
    ds_read_b128 v[68:71], v7 offset:23552
    v_mfma_f32_16x16x32_bf16 v[20:23], v[52:55], v[76:79], v[20:23]
    ds_read_b128 v[52:55], v7 offset:24576
    v_cvt_pk_bf16_f32 v24, v24, v25
    s_waitcnt lgkmcnt(5)
    v_mfma_f32_16x16x32_bf16 v[20:23], v[56:59], v[28:31], v[20:23]
    ds_read_b128 v[56:59], v7 offset:25600
    v_cvt_pk_bf16_f32 v25, v26, v27
    v_mfma_f32_16x16x32_bf16 v[20:23], v[36:39], v[60:63], v[20:23]
    ds_read_b128 v[36:39], v7 offset:26624
    buffer_store_dwordx2 v[24:25], v1, s[8:11], s55 offen
    s_waitcnt lgkmcnt(5)
    v_mfma_f32_16x16x32_bf16 v[24:27], v[40:43], v[72:75], 0
    ds_read_b128 v[40:43], v7 offset:27648
    v_mfma_f32_16x16x32_bf16 v[24:27], v[32:35], v[76:79], v[24:27]
    ds_read_b128 v[32:35], v10 offset:0
    v_cvt_pk_bf16_f32 v20, v20, v21
    s_waitcnt lgkmcnt(5)
    v_mfma_f32_16x16x32_bf16 v[24:27], v[64:67], v[28:31], v[24:27]
    ds_read_b128 v[64:67], v10 offset:1024
    v_cvt_pk_bf16_f32 v21, v22, v23
    v_mfma_f32_16x16x32_bf16 v[24:27], v[68:71], v[60:63], v[24:27]
    ds_read_b128 v[68:71], v10 offset:2048
    buffer_store_dwordx2 v[20:21], v1, s[8:11], s56 offen
    s_waitcnt lgkmcnt(5)
    v_mfma_f32_16x16x32_bf16 v[20:23], v[52:55], v[72:75], 0
    ds_read_b128 v[52:55], v10 offset:3072
    v_mfma_f32_16x16x32_bf16 v[20:23], v[56:59], v[76:79], v[20:23]
    ds_read_b128 v[56:59], v7 offset:28672
    v_cvt_pk_bf16_f32 v24, v24, v25
    s_waitcnt lgkmcnt(5)
    v_mfma_f32_16x16x32_bf16 v[20:23], v[36:39], v[28:31], v[20:23]
    ds_read_b128 v[36:39], v7 offset:29696
    v_cvt_pk_bf16_f32 v25, v26, v27
    v_mfma_f32_16x16x32_bf16 v[20:23], v[40:43], v[60:63], v[20:23]
    ds_read_b128 v[40:43], v7 offset:30720
    buffer_store_dwordx2 v[24:25], v1, s[8:11], s57 offen
    s_waitcnt lgkmcnt(5)
    v_mfma_f32_16x16x32_bf16 v[24:27], v[32:35], v[72:75], 0
    ds_read_b128 v[32:35], v7 offset:31744
    s_cmp_eq_u32 s27, 1
    s_cbranch_scc1 F_w3e
    v_mfma_f32_16x16x32_bf16 v[24:27], v[64:67], v[76:79], v[24:27]
    ds_read_b128 v[64:67], v7 offset:32768
    v_cvt_pk_bf16_f32 v20, v20, v21
    s_waitcnt lgkmcnt(5)
    v_mfma_f32_16x16x32_bf16 v[24:27], v[68:71], v[28:31], v[24:27]
    ds_read_b128 v[68:71], v7 offset:33792
    v_cvt_pk_bf16_f32 v21, v22, v23
    v_mfma_f32_16x16x32_bf16 v[24:27], v[52:55], v[60:63], v[24:27]
    ds_read_b128 v[52:55], v7 offset:34816
    buffer_store_dwordx2 v[20:21], v1, s[8:11], s58 offen
    s_waitcnt lgkmcnt(5)
    v_mfma_f32_16x16x32_bf16 v[20:23], v[56:59], v[72:75], 0
    ds_read_b128 v[56:59], v7 offset:35840
    v_mfma_f32_16x16x32_bf16 v[20:23], v[36:39], v[76:79], v[20:23]
    v_cvt_pk_bf16_f32 v24, v24, v25
    s_waitcnt lgkmcnt(4)
    v_mfma_f32_16x16x32_bf16 v[20:23], v[40:43], v[28:31], v[20:23]
    v_cvt_pk_bf16_f32 v25, v26, v27
    v_mfma_f32_16x16x32_bf16 v[20:23], v[32:35], v[60:63], v[20:23]
    buffer_store_dwordx2 v[24:25], v1, s[8:11], s61 offen
    s_waitcnt lgkmcnt(2)
    v_mfma_f32_16x16x32_bf16 v[24:27], v[64:67], v[72:75], 0
    v_mov_b64 v[72:73], 0
    v_mov_b64 v[74:75], 0
    v_mfma_f32_16x16x32_bf16 v[24:27], v[68:71], v[76:79], v[24:27]
    v_cvt_pk_bf16_f32 v20, v20, v21
    v_mov_b32_dpp v72, v2 quad_perm:[0,1,2,3] row_mask:0xf bank_mask:0x1
    s_waitcnt lgkmcnt(0)
    v_mfma_f32_16x16x32_bf16 v[24:27], v[52:55], v[28:31], v[24:27]
    v_cvt_pk_bf16_f32 v21, v22, v23
    v_mov_b32_dpp v73, v3 quad_perm:[0,1,2,3] row_mask:0xf bank_mask:0x1
    v_mfma_f32_16x16x32_bf16 v[24:27], v[56:59], v[60:63], v[24:27]
    buffer_store_dwordx2 v[20:21], v1, s[8:11], s59 offen
    v_mov_b32_dpp v74, v2 quad_perm:[0,1,2,3] row_mask:0xf bank_mask:0x2
    v_mov_b32_dpp v75, v3 quad_perm:[0,1,2,3] row_mask:0xf bank_mask:0x2
    s_xor_b32 s52, s52, 524288
    s_xor_b32 s53, s53, 524288
    s_cmp_eq_u32 s27, 0
    s_nop 1
    v_cvt_pk_bf16_f32 v24, v24, v25
    v_cvt_pk_bf16_f32 v25, v26, v27
    buffer_store_dwordx2 v[24:25], v1, s[8:11], s60 offen
    s_cbranch_scc1 F_k2
    s_xor_b32 s54, s54, 524288
    s_xor_b32 s55, s55, 524288
    s_xor_b32 s56, s56, 524288
    s_xor_b32 s57, s57, 524288
    s_xor_b32 s58, s58, 524288
    s_xor_b32 s59, s59, 524288
    s_xor_b32 s60, s60, 524288
    s_xor_b32 s61, s61, 524288
F_lgate:
    ds_read_b32 v10, v0 offset:0
    s_add_u32 s37, s37, 1
    s_cmp_gt_u32 s37, 0x100000
    s_cbranch_scc1 F_lgated
    s_waitcnt lgkmcnt(0)
    v_cmp_ne_u32 vcc, s14, v10
    s_cbranch_vccnz F_lgate
F_lgated:
    v_mov_b64 v[20:21], 0
    v_mov_b64 v[22:23], 0
    v_mov_b64 v[24:25], 0
    v_mov_b64 v[26:27], 0
    v_mov_b64 v[28:29], 0
    v_mov_b64 v[30:31], 0
    buffer_load_dwordx4 v[64:67], v0, s[8:11], s22 offen offset:0 sc1
    buffer_load_dwordx4 v[68:71], v0, s[8:11], s22 offen offset:1024 sc1
    buffer_load_dwordx4 v[52:55], v0, s[8:11], s22 offen offset:2048 sc1
    buffer_load_dwordx4 v[56:59], v0, s[8:11], s22 offen offset:3072 sc1
    v_mov_b64 v[32:33], 0
    v_mov_b64 v[34:35], 0
    v_mov_b64 v[36:37], 0
    v_mov_b64 v[38:39], 0
    v_mov_b64 v[40:41], 0
    v_mov_b64 v[42:43], 0
F_l2:
    buffer_load_dwordx4 v[64:67], v0, s[8:11], s22 offen offset:0 sc1
    buffer_load_dwordx4 v[68:71], v0, s[8:11], s22 offen offset:1024 sc1
    buffer_load_dwordx4 v[52:55], v0, s[8:11], s22 offen offset:2048 sc1
    buffer_load_dwordx4 v[56:59], v0, s[8:11], s22 offen offset:3072 sc1
    s_waitcnt vmcnt(7)
    v_mfma_f32_16x16x32_bf16 v[60:63], v[72:75], v[64:67], 0
    s_waitcnt vmcnt(6)
    v_mfma_f32_16x16x32_bf16 v[60:63], v[72:75], v[68:71], v[60:63]
    s_waitcnt vmcnt(5)
    v_mfma_f32_16x16x32_bf16 v[60:63], v[72:75], v[52:55], v[60:63]
    s_waitcnt vmcnt(4)
    v_mfma_f32_16x16x32_bf16 v[60:63], v[72:75], v[56:59], v[60:63]
    s_nop 6
F_rl_c:
    s_nop 0
    v_cmp_u_f32_e64 vcc, v60, v60
    v_add_f32_dpp v60, v60, v60 row_ror:8 row_mask:0xf bank_mask:0xf
    v_add_f32_dpp v61, v61, v61 row_ror:8 row_mask:0xf bank_mask:0xf
    v_add_f32_dpp v62, v62, v62 row_ror:8 row_mask:0xf bank_mask:0xf
    v_add_f32_dpp v63, v63, v63 row_ror:8 row_mask:0xf bank_mask:0xf
    v_cvt_pk_bf16_f32 v16, v60, v61
    v_cvt_pk_bf16_f32 v17, v62, v63
    s_cbranch_vccnz F_lf
F_rl_ok:
    s_mov_b32 exec_hi, 0
    buffer_store_dwordx2 v[16:17], v1, s[8:11], s24 offen
    s_mov_b64 exec, -1
    s_xor_b32 s22, s22, 524288
    s_cmp_eq_u32 s14, 63
    s_cbranch_scc1 F_done
    s_waitcnt vmcnt(1)
    s_branch F_ok0
F_w0:
    s_nop 1
    s_waitcnt lgkmcnt(5)
    v_mfma_f32_16x16x32_bf16 v[20:23], v[68:71], v[72:75], 0
    ds_read_b128 v[68:71], v7 offset:23552
    v_mfma_f32_16x16x32_bf16 v[20:23], v[52:55], v[76:79], v[20:23]
    v_cvt_pk_bf16_f32 v24, v24, v25
    s_waitcnt lgkmcnt(4)
    v_mfma_f32_16x16x32_bf16 v[20:23], v[56:59], v[28:31], v[20:23]
    v_cvt_pk_bf16_f32 v25, v26, v27
    v_mfma_f32_16x16x32_bf16 v[20:23], v[36:39], v[60:63], v[20:23]
    buffer_store_dwordx2 v[24:25], v1, s[8:11], s55 offen
    s_waitcnt lgkmcnt(2)
    v_mfma_f32_16x16x32_bf16 v[24:27], v[40:43], v[72:75], 0
    v_mov_b64 v[72:73], 0
    v_mov_b64 v[74:75], 0
    v_mfma_f32_16x16x32_bf16 v[24:27], v[32:35], v[76:79], v[24:27]
    v_cvt_pk_bf16_f32 v20, v20, v21
    v_mov_b32_dpp v72, v2 quad_perm:[0,1,2,3] row_mask:0xf bank_mask:0x1
    s_waitcnt lgkmcnt(0)
    v_mfma_f32_16x16x32_bf16 v[24:27], v[64:67], v[28:31], v[24:27]
    v_cvt_pk_bf16_f32 v21, v22, v23
    v_mov_b32_dpp v73, v3 quad_perm:[0,1,2,3] row_mask:0xf bank_mask:0x1
    v_mfma_f32_16x16x32_bf16 v[24:27], v[68:71], v[60:63], v[24:27]
    buffer_store_dwordx2 v[20:21], v1, s[8:11], s56 offen
    v_mov_b32_dpp v74, v2 quad_perm:[0,1,2,3] row_mask:0xf bank_mask:0x2
    v_mov_b32_dpp v75, v3 quad_perm:[0,1,2,3] row_mask:0xf bank_mask:0x2
    s_xor_b32 s52, s52, 524288
    s_xor_b32 s53, s53, 524288
    s_cmp_eq_u32 s27, 0
    s_nop 1
    v_cvt_pk_bf16_f32 v24, v24, v25
    v_cvt_pk_bf16_f32 v25, v26, v27
    buffer_store_dwordx2 v[24:25], v1, s[8:11], s57 offen
    buffer_load_dwordx4 v[64:67], v0, s[8:11], s22 offen offset:0 sc1
    buffer_load_dwordx4 v[68:71], v0, s[8:11], s22 offen offset:1024 sc1
    buffer_load_dwordx4 v[52:55], v0, s[8:11], s22 offen offset:2048 sc1
    buffer_load_dwordx4 v[56:59], v0, s[8:11], s22 offen offset:3072 sc1
    s_nop 15
    s_nop 7
F_e2:
    buffer_load_dwordx4 v[64:67], v0, s[8:11], s22 offen offset:0 sc1
    buffer_load_dwordx4 v[68:71], v0, s[8:11], s22 offen offset:1024 sc1
    buffer_load_dwordx4 v[52:55], v0, s[8:11], s22 offen offset:2048 sc1
    buffer_load_dwordx4 v[56:59], v0, s[8:11], s22 offen offset:3072 sc1
    s_waitcnt vmcnt(7)
    v_mfma_f32_16x16x32_bf16 v[60:63], v[72:75], v[64:67], 0
    s_waitcnt vmcnt(6)
    v_mfma_f32_16x16x32_bf16 v[60:63], v[72:75], v[68:71], v[60:63]
    s_waitcnt vmcnt(5)
    v_mfma_f32_16x16x32_bf16 v[60:63], v[72:75], v[52:55], v[60:63]
    s_waitcnt vmcnt(4)
    v_mfma_f32_16x16x32_bf16 v[60:63], v[72:75], v[56:59], v[60:63]
    s_nop 6
F_re_c:
    s_nop 0
    v_cmp_u_f32_e64 vcc, v60, v60
    v_add_f32_dpp v60, v60, v60 row_ror:8 row_mask:0xf bank_mask:0xf
    v_add_f32_dpp v61, v61, v61 row_ror:8 row_mask:0xf bank_mask:0xf
    v_add_f32_dpp v62, v62, v62 row_ror:8 row_mask:0xf bank_mask:0xf
    v_add_f32_dpp v63, v63, v63 row_ror:8 row_mask:0xf bank_mask:0xf
    v_cvt_pk_bf16_f32 v16, v60, v61
    v_cvt_pk_bf16_f32 v17, v62, v63
    s_cbranch_vccnz F_ef
F_re_ok:
    s_mov_b32 exec_hi, 0
    buffer_store_dwordx2 v[16:17], v1, s[8:11], s24 offen
    s_mov_b64 exec, -1
    v_mov_b32 v10, s14
    ds_write_b32 v0, v10 offset:0
    s_xor_b32 s22, s22, 524288
    s_cmp_eq_u32 s14, 63
    s_cbranch_scc1 F_done
    s_branch F_loop
F_k2:
    s_cmp_eq_u32 s14, 63
    s_cbranch_scc1 F_end
    s_cmp_eq_u32 s12, 3
    s_cbranch_scc1 F_w3z
F_gate:
    ds_read_b32 v10, v0 offset:0
    s_add_u32 s37, s37, 1
    s_cmp_gt_u32 s37, 0x100000
    s_cbranch_scc1 F_gated
    s_waitcnt lgkmcnt(0)
    v_cmp_ne_u32 vcc, s14, v10
    s_cbranch_vccnz F_gate
F_gated:
    s_branch F_loop
F_w3e:
    v_mfma_f32_16x16x32_bf16 v[24:27], v[64:67], v[76:79], v[24:27]
    ds_read_b128 v[64:67], v7 offset:32768
    v_cvt_pk_bf16_f32 v20, v20, v21
    s_waitcnt lgkmcnt(5)
    v_mfma_f32_16x16x32_bf16 v[24:27], v[68:71], v[28:31], v[24:27]
    ds_read_b128 v[68:71], v7 offset:33792
    v_cvt_pk_bf16_f32 v21, v22, v23
    v_mfma_f32_16x16x32_bf16 v[24:27], v[52:55], v[60:63], v[24:27]
    ds_read_b128 v[52:55], v7 offset:34816
    buffer_store_dwordx2 v[20:21], v1, s[8:11], s58 offen
    s_waitcnt lgkmcnt(5)
    v_mfma_f32_16x16x32_bf16 v[20:23], v[56:59], v[72:75], 0
    ds_read_b128 v[56:59], v7 offset:35840
    v_mfma_f32_16x16x32_bf16 v[20:23], v[36:39], v[76:79], v[20:23]
    buffer_load_dwordx4 v[36:39], v0, s[8:11], s22 offen offset:0 sc1
    v_cvt_pk_bf16_f32 v24, v24, v25
    s_waitcnt lgkmcnt(4)
    v_mfma_f32_16x16x32_bf16 v[20:23], v[40:43], v[28:31], v[20:23]
    buffer_load_dwordx4 v[40:43], v0, s[8:11], s22 offen offset:1024 sc1
    v_cvt_pk_bf16_f32 v25, v26, v27
    v_mfma_f32_16x16x32_bf16 v[20:23], v[32:35], v[60:63], v[20:23]
    buffer_load_dwordx4 v[32:35], v0, s[8:11], s22 offen offset:2048 sc1
    buffer_store_dwordx2 v[24:25], v1, s[8:11], s61 offen
    s_waitcnt lgkmcnt(2)
    v_mfma_f32_16x16x32_bf16 v[24:27], v[64:67], v[72:75], 0
    buffer_load_dwordx4 v[64:67], v0, s[8:11], s22 offen offset:3072 sc1
    v_mov_b64 v[72:73], 0
    v_mov_b64 v[74:75], 0
    v_mfma_f32_16x16x32_bf16 v[24:27], v[68:71], v[76:79], v[24:27]
    v_cvt_pk_bf16_f32 v20, v20, v21
    v_mov_b32_dpp v72, v2 quad_perm:[0,1,2,3] row_mask:0xf bank_mask:0x1
    s_waitcnt lgkmcnt(0)
    v_mfma_f32_16x16x32_bf16 v[24:27], v[52:55], v[28:31], v[24:27]
    v_cvt_pk_bf16_f32 v21, v22, v23
    v_mov_b32_dpp v73, v3 quad_perm:[0,1,2,3] row_mask:0xf bank_mask:0x1
    v_mfma_f32_16x16x32_bf16 v[24:27], v[56:59], v[60:63], v[24:27]
    buffer_store_dwordx2 v[20:21], v1, s[8:11], s59 offen
    v_mov_b32_dpp v74, v2 quad_perm:[0,1,2,3] row_mask:0xf bank_mask:0x2
    v_mov_b32_dpp v75, v3 quad_perm:[0,1,2,3] row_mask:0xf bank_mask:0x2
    s_xor_b32 s52, s52, 524288
    s_xor_b32 s53, s53, 524288
    s_cmp_eq_u32 s27, 0
    s_nop 1
    v_cvt_pk_bf16_f32 v24, v24, v25
    v_cvt_pk_bf16_f32 v25, v26, v27
    buffer_store_dwordx2 v[24:25], v1, s[8:11], s60 offen
    s_waitcnt vmcnt(6)
    v_mfma_f32_16x16x32_bf16 v[60:63], v[72:75], v[36:39], 0
    s_waitcnt vmcnt(5)
    v_mfma_f32_16x16x32_bf16 v[60:63], v[72:75], v[40:43], v[60:63]
    s_waitcnt vmcnt(4)
    v_mfma_f32_16x16x32_bf16 v[60:63], v[72:75], v[32:35], v[60:63]
    s_waitcnt vmcnt(2)
    v_mfma_f32_16x16x32_bf16 v[60:63], v[72:75], v[64:67], v[60:63]
    s_nop 6
F_r3_c:
    s_nop 0
    v_cmp_u_f32_e64 vcc, v60, v60
    v_add_f32_dpp v60, v60, v60 row_ror:8 row_mask:0xf bank_mask:0xf
    v_add_f32_dpp v61, v61, v61 row_ror:8 row_mask:0xf bank_mask:0xf
    v_add_f32_dpp v62, v62, v62 row_ror:8 row_mask:0xf bank_mask:0xf
    v_add_f32_dpp v63, v63, v63 row_ror:8 row_mask:0xf bank_mask:0xf
    v_cvt_pk_bf16_f32 v16, v60, v61
    v_cvt_pk_bf16_f32 v17, v62, v63
    s_cbranch_vccnz F_3f
F_r3_ok:
    s_mov_b32 exec_hi, 0
    buffer_store_dwordx2 v[16:17], v1, s[8:11], s24 offen
    s_mov_b64 exec, -1
    s_xor_b32 s22, s22, 524288
    s_cmp_eq_u32 s14, 63
    s_cbranch_scc1 F_done
F_w3z:
    v_mov_b64 v[20:21], 0
    v_mov_b64 v[22:23], 0
    v_mov_b64 v[24:25], 0
    v_mov_b64 v[26:27], 0
    v_mov_b64 v[28:29], 0
    v_mov_b64 v[30:31], 0
    v_mov_b64 v[32:33], 0
    v_mov_b64 v[34:35], 0
    v_mov_b64 v[36:37], 0
    v_mov_b64 v[38:39], 0
    v_mov_b64 v[40:41], 0
    v_mov_b64_e64 v[42:43], 0
    s_xor_b32 s54, s54, 524288
    s_xor_b32 s55, s55, 524288
    s_xor_b32 s56, s56, 524288
    s_xor_b32 s57, s57, 524288
    s_xor_b32 s58, s58, 524288
    s_xor_b32 s59, s59, 524288
    s_xor_b32 s60, s60, 524288
    s_xor_b32 s61, s61, 524288
    s_branch F_ok0
F_rt0:
    s_add_u32 s37, s37, 1
    s_cmp_gt_u32 s37, 0x100000
    s_cbranch_scc1 F_ok0
    s_branch F_la
F_rt2:
    s_add_u32 s37, s37, 1
    s_cmp_gt_u32 s37, 0x100000
    s_cbranch_scc1 F_ok2
    buffer_load_dwordx4 v[76:79], v0, s[8:11], s39 offen offset:0 sc1
    s_mov_b32 exec_hi, 0xffff
    buffer_load_dwordx4 v[52:55], v0, s[8:11], s21 offen sc1
    s_mov_b32 exec_hi, -1
    buffer_load_dwordx4 v[60:63], v0, s[8:11], s39 offen offset:1024 sc1
    s_waitcnt vmcnt(2)
    v_cmp_u_f32_e64 vcc, v76, v78
    s_cbranch_vccnz F_rt2
    s_branch F_ok2
F_rt1:
    s_add_u32 s37, s37, 1
    s_cmp_gt_u32 s37, 0x100000
    s_cbranch_scc1 F_ok1
    s_mov_b32 exec_hi, 0xffff
    buffer_load_dwordx4 v[52:55], v0, s[8:11], s21 offen sc1
    s_mov_b32 exec_hi, -1
    buffer_load_dwordx4 v[60:63], v0, s[8:11], s39 offen offset:1024 sc1
    s_waitcnt vmcnt(0)
    s_mov_b32 exec_hi, 0xffff
    v_cmp_u_f32 vcc, v52, v54
    ds_write_b128 v11, v[52:55]
    s_mov_b32 exec_hi, -1
    v_cmp_u_f32 s[40:41], v60, v62
    s_nop 1
    s_or_b64 vcc, vcc, s[40:41]
    s_cbranch_vccnz F_rt1
    s_branch F_ok1
F_fl:
    s_add_u32 s37, s37, 1
    s_cmp_gt_u32 s37, 0x100000
    s_cbranch_scc1 F_flok
    v_lshrrev_b32 v10, 2, v0
    buffer_load_dword v19, v10, s[8:11], s69 offen sc1
    s_waitcnt vmcnt(0)
    v_cmp_eq_u32 s[2:3], v18, v19
    s_nop 1
    s_bitcmp1_b64 s[2:3], s14
    s_cbranch_scc0 F_fl
    s_branch F_flok
F_fa:
    v_lshrrev_b32 v11, 2, v0
    buffer_load_dword v19, v11, s[8:11], s69 offen sc1
    s_branch F_fad
F_lf:
    s_add_u32 s37, s37, 1
    s_cmp_gt_u32 s37, 0x100000
    s_cbranch_scc1 F_rl_ok
    s_branch F_l2
F_ef:
    s_add_u32 s37, s37, 1
    s_cmp_gt_u32 s37, 0x100000
    s_cbranch_scc1 F_re_ok
    s_branch F_e2
F_3f:
    s_add_u32 s37, s37, 1
    s_cmp_gt_u32 s37, 0x100000
    s_cbranch_scc1 F_r3_ok
    buffer_load_dwordx4 v[36:39], v0, s[8:11], s22 offen offset:0 sc1
    buffer_load_dwordx4 v[40:43], v0, s[8:11], s22 offen offset:1024 sc1
    buffer_load_dwordx4 v[32:35], v0, s[8:11], s22 offen offset:2048 sc1
    buffer_load_dwordx4 v[64:67], v0, s[8:11], s22 offen offset:3072 sc1
    s_waitcnt vmcnt(3)
    v_mfma_f32_16x16x32_bf16 v[60:63], v[72:75], v[36:39], 0
    s_waitcnt vmcnt(2)
    v_mfma_f32_16x16x32_bf16 v[60:63], v[72:75], v[40:43], v[60:63]
    s_waitcnt vmcnt(1)
    v_mfma_f32_16x16x32_bf16 v[60:63], v[72:75], v[32:35], v[60:63]
    s_waitcnt vmcnt(0)
    v_mfma_f32_16x16x32_bf16 v[60:63], v[72:75], v[64:67], v[60:63]
    s_nop 7
    s_branch F_r3_c
F_done:
    s_mov_b32 exec_hi, 0
    buffer_store_dwordx4 v[16:19], v9, s[8:11], s25 offen sc1
    s_mov_b64 exec, -1
F_end:
    s_branch C_fin
S_start:
    s_bitcmp1_b32 s12, 0
    s_cbranch_scc1 S_ok0
    s_xor_b32 s54, s54, 524288
    s_xor_b32 s55, s55, 524288
    s_xor_b32 s56, s56, 524288
    s_xor_b32 s57, s57, 524288
    s_xor_b32 s58, s58, 524288
    s_xor_b32 s59, s59, 524288
    s_xor_b32 s60, s60, 524288
    s_xor_b32 s61, s61, 524288
S_loop:
    buffer_load_dwordx4 v[52:55], v0, s[8:11], s18 offen offset:0 sc1
    buffer_load_dwordx4 v[56:59], v0, s[8:11], s18 offen offset:1024 sc1
    v_add_u32 v11, s38, v0
    v_mov_b64 v[20:21], 0
    v_mov_b64 v[22:23], 0
    v_mov_b64 v[24:25], 0
    v_mov_b64 v[26:27], 0
    v_mov_b64 v[28:29], 0
    v_mov_b64 v[30:31], 0
    v_mov_b64 v[32:33], 0
    v_mov_b64 v[34:35], 0
    v_mov_b64 v[36:37], 0
    v_mov_b64 v[38:39], 0
    v_mov_b64 v[40:41], 0
    v_mov_b64 v[42:43], 0
    s_xor_b32 s54, s54, 524288
    s_xor_b32 s55, s55, 524288
    s_xor_b32 s56, s56, 524288
    s_xor_b32 s57, s57, 524288
    s_xor_b32 s58, s58, 524288
    s_xor_b32 s59, s59, 524288
    s_xor_b32 s60, s60, 524288
    s_xor_b32 s61, s61, 524288
S_la:
    buffer_load_dwordx4 v[52:55], v0, s[8:11], s18 offen offset:0 sc1
    buffer_load_dwordx4 v[56:59], v0, s[8:11], s18 offen offset:1024 sc1
    s_waitcnt vmcnt(3)
    v_cmp_u_f32 s[40:41], v52, v54
    ds_write_b128 v11, v[52:55] offset:0
    s_waitcnt vmcnt(2)
    v_cmp_u_f32 vcc, v56, v58
    ds_write_b128 v11, v[56:59] offset:1024
    s_or_b64 vcc, vcc, s[40:41]
    s_cbranch_vccnz S_rt0
S_ok0:
    v_cmp_eq_u32 s[2:3], v18, v19
    s_add_u32 s15, s23, 524288
    s_add_u32 s14, s14, 1
    v_add_u32 v11, s43, v0
    s_waitcnt lgkmcnt(0)
    s_barrier
    ds_read_b128 v[60:63], v0 offset:7168
    ds_read_b128 v[64:67], v0 offset:8192
    ds_read_b128 v[68:71], v0 offset:9216
    ds_read_b128 v[72:75], v0 offset:10240
    s_waitcnt lgkmcnt(3)
    v_smfmac_f32_16x16x64_bf16 v[20:23], v[60:63], a[0:7], v8
    v_smfmac_f32_16x16x64_bf16 v[24:27], v[60:63], a[72:79], v8
    v_smfmac_f32_16x16x64_bf16 v[28:31], v[60:63], a[144:151], v8
    v_smfmac_f32_16x16x64_bf16 v[32:35], v[60:63], a[216:223], v8
    buffer_load_dwordx4 v[76:79], v0, s[8:11], s39 offen offset:0 sc1
    v_smfmac_f32_16x16x64_bf16 v[36:39], v[60:63], v[112:119], v8
    s_mov_b32 exec_hi, 0xffff
    buffer_load_dwordx4 v[52:55], v0, s[8:11], s21 offen sc1
    s_mov_b32 exec_hi, -1
    v_smfmac_f32_16x16x64_bf16 v[40:43], v[60:63], v[184:191], v8
    s_waitcnt lgkmcnt(2)
    v_smfmac_f32_16x16x64_bf16 v[20:23], v[64:67], a[8:15], v8
    buffer_load_dwordx4 v[60:63], v0, s[8:11], s39 offen offset:1024 sc1
    v_smfmac_f32_16x16x64_bf16 v[24:27], v[64:67], a[80:87], v8
    v_smfmac_f32_16x16x64_bf16 v[28:31], v[64:67], a[152:159], v8
    v_smfmac_f32_16x16x64_bf16 v[32:35], v[64:67], a[224:231], v8
    v_smfmac_f32_16x16x64_bf16 v[36:39], v[64:67], v[120:127], v8
    v_smfmac_f32_16x16x64_bf16 v[40:43], v[64:67], v[192:199], v8
    s_waitcnt lgkmcnt(1)
    v_smfmac_f32_16x16x64_bf16 v[20:23], v[68:71], a[16:23], v8
    v_smfmac_f32_16x16x64_bf16 v[24:27], v[68:71], a[88:95], v8
    v_smfmac_f32_16x16x64_bf16 v[28:31], v[68:71], a[160:167], v8
    v_smfmac_f32_16x16x64_bf16 v[32:35], v[68:71], a[232:239], v8
    v_smfmac_f32_16x16x64_bf16 v[36:39], v[68:71], v[128:135], v8
    v_smfmac_f32_16x16x64_bf16 v[40:43], v[68:71], v[200:207], v8
    s_waitcnt lgkmcnt(0)
    v_smfmac_f32_16x16x64_bf16 v[20:23], v[72:75], a[24:31], v8
    v_smfmac_f32_16x16x64_bf16 v[24:27], v[72:75], a[96:103], v8
    v_smfmac_f32_16x16x64_bf16 v[28:31], v[72:75], a[168:175], v8
    v_smfmac_f32_16x16x64_bf16 v[32:35], v[72:75], a[240:247], v8
    s_waitcnt vmcnt(2)
    v_cmp_u_f32 vcc, v76, v78
    v_smfmac_f32_16x16x64_bf16 v[36:39], v[72:75], v[136:143], v8
    v_smfmac_f32_16x16x64_bf16 v[40:43], v[72:75], v[208:215], v8
    s_cbranch_vccnz S_rt2
S_ok2:
    v_smfmac_f32_16x16x64_bf16 v[20:23], v[76:79], a[32:39], v8
    s_waitcnt vmcnt(1)
    s_mov_b32 exec_hi, 0xffff
    v_cmp_u_f32 vcc, v52, v54
    ds_write_b128 v11, v[52:55]
    s_mov_b32 exec_hi, -1
    v_smfmac_f32_16x16x64_bf16 v[24:27], v[76:79], a[104:111], v8
    s_waitcnt vmcnt(0)
    v_cmp_u_f32 s[40:41], v60, v62
    v_smfmac_f32_16x16x64_bf16 v[28:31], v[76:79], a[176:183], v8
    v_smfmac_f32_16x16x64_bf16 v[32:35], v[76:79], a[248:255], v8
    s_or_b64 vcc, vcc, s[40:41]
    s_cbranch_vccnz S_rt1
S_ok1:
    s_bitcmp1_b64 s[2:3], s14
    s_waitcnt lgkmcnt(0)
    s_barrier
    ds_read_b128 v[64:67], v0 offset:13312
    ds_read_b128 v[68:71], v0 offset:14336
    ds_read_b128 v[72:75], v0 offset:15360
    s_cbranch_scc0 S_fl
S_flok:
    s_cmp_eq_u64 s[2:3], -1
    v_smfmac_f32_16x16x64_bf16 v[20:23], v[60:63], a[40:47], v8
    s_cbranch_scc0 S_fa
S_fad:
    v_smfmac_f32_16x16x64_bf16 v[24:27], v[60:63], a[112:119], v8
    buffer_load_dwordx4 v[52:55], v0, s[8:11], s23 offen offset:2048 sc1
    v_smfmac_f32_16x16x64_bf16 v[28:31], v[60:63], a[184:191], v8
    v_smfmac_f32_16x16x64_bf16 v[32:35], v[60:63], v[80:87], v8
    buffer_load_dwordx4 v[56:59], v0, s[8:11], s23 offen offset:3072 sc1
    s_waitcnt lgkmcnt(2)
    v_smfmac_f32_16x16x64_bf16 v[20:23], v[64:67], a[48:55], v8
    v_mov_b64 v[10:11], -1
    s_mov_b32 exec_hi, 0
    buffer_store_dwordx4 v[16:19], v9, s[8:11], s25 offen sc1
    v_smfmac_f32_16x16x64_bf16 v[24:27], v[64:67], a[120:127], v8
    buffer_store_dwordx2 v[10:11], v1, s[8:11], s65 offen sc1
    s_mov_b32 exec_hi, -1
    v_lshlrev_b32 v11, 2, v0
    v_smfmac_f32_16x16x64_bf16 v[28:31], v[64:67], a[192:199], v8
    buffer_store_dword v10, v11, s[8:11], s36 offen sc1
    v_smfmac_f32_16x16x64_bf16 v[32:35], v[64:67], v[88:95], v8
    buffer_store_dword v10, v11, s[8:11], s36 offen offset:8 sc1
    s_waitcnt lgkmcnt(1)
    v_smfmac_f32_16x16x64_bf16 v[20:23], v[68:71], a[56:63], v8
    v_smfmac_f32_16x16x64_bf16 v[24:27], v[68:71], a[128:135], v8
    v_smfmac_f32_16x16x64_bf16 v[28:31], v[68:71], a[200:207], v8
    v_smfmac_f32_16x16x64_bf16 v[32:35], v[68:71], v[96:103], v8
    s_waitcnt lgkmcnt(0)
    v_smfmac_f32_16x16x64_bf16 v[20:23], v[72:75], a[64:71], v8
    v_smfmac_f32_16x16x64_bf16 v[24:27], v[72:75], a[136:143], v8
    v_smfmac_f32_16x16x64_bf16 v[28:31], v[72:75], a[208:215], v8
    v_cvt_pk_bf16_f32 v20, v20, v21
    v_smfmac_f32_16x16x64_bf16 v[32:35], v[72:75], v[104:111], v8
    v_cvt_pk_bf16_f32 v21, v22, v23
    v_cvt_pk_bf16_f32 v22, v24, v25
    v_cvt_pk_bf16_f32 v23, v26, v27
    s_nop 0
    v_cvt_pk_bf16_f32 v28, v28, v29
    v_cvt_pk_bf16_f32 v29, v30, v31
    v_mfma_f32_16x16x32_bf16 v[24:27], v[20:23], v[12:15], 0
    s_nop 0
    v_cvt_pk_bf16_f32 v30, v32, v33
    v_cvt_pk_bf16_f32 v31, v34, v35
    s_nop 1
    v_mfma_f32_16x16x32_bf16 v[32:35], v[28:31], v[12:15], 0
    s_nop 1
    v_cvt_pk_bf16_f32 v20, v24, v25
    v_cvt_pk_bf16_f32 v21, v26, v27
    v_smfmac_f32_16x16x64_bf16 v[36:39], v[60:63], v[152:159], v8
    s_nop 2
    v_cvt_pk_bf16_f32 v22, v32, v33
    v_cvt_pk_bf16_f32 v23, v34, v35
    v_add_u32 v10, s64, v0
    s_nop 0
    v_mfma_f32_16x16x32_bf16 v[24:27], v[44:47], v[20:23], 0
    v_mfma_f32_16x16x32_bf16 v[28:31], v[48:51], v[20:23], 0
    v_mfma_f32_16x16x32_bf16 v[32:35], v[20:23], v[20:23], 0
    v_smfmac_f32_16x16x64_bf16 v[40:43], v[60:63], v[224:231], v8
    v_mov_b32_dpp v24, v28 row_ror:8 row_mask:0xf bank_mask:0xc
    v_mov_b32_dpp v25, v29 row_ror:8 row_mask:0xf bank_mask:0xc
    v_mov_b32_dpp v26, v30 row_ror:8 row_mask:0xf bank_mask:0xc
    v_mov_b32_dpp v27, v31 row_ror:8 row_mask:0xf bank_mask:0xc
    ds_write_b128 v10, v[24:27] offset:0
    s_mov_b64 exec, s[66:67]
    ds_write_b128 v4, v[32:35] offset:0
    s_mov_b64 exec, -1
    v_smfmac_f32_16x16x64_bf16 v[36:39], v[64:67], v[160:167], v8
    buffer_load_dwordx4 v[44:47], v0, s[8:11], s15 offen sc1
    v_smfmac_f32_16x16x64_bf16 v[40:43], v[64:67], v[232:239], v8
    buffer_load_dwordx4 v[48:51], v0, s[8:11], s15 offen offset:1024 sc1
    v_smfmac_f32_16x16x64_bf16 v[36:39], v[68:71], v[168:175], v8
    v_smfmac_f32_16x16x64_bf16 v[40:43], v[68:71], v[240:247], v8
    s_waitcnt lgkmcnt(0)
    s_barrier
    ds_read_b128 v[60:63], v0 offset:0
    ds_read_b128 v[64:67], v0 offset:1280
    v_smfmac_f32_16x16x64_bf16 v[36:39], v[76:79], v[144:151], v8
    ds_read_b128 v[68:71], v0 offset:2560
    ds_read_b128 v[24:27], v0 offset:3840
    v_smfmac_f32_16x16x64_bf16 v[40:43], v[76:79], v[216:223], v8
    ds_read_b64 v[28:29], v5 offset:0
    ds_read_b64 v[30:31], v5 offset:1280
    v_smfmac_f32_16x16x64_bf16 v[36:39], v[72:75], v[176:183], v8
    ds_read_b64 v[32:33], v5 offset:2560
    ds_read_b64 v[34:35], v5 offset:3840
    v_smfmac_f32_16x16x64_bf16 v[40:43], v[72:75], v[248:255], v8
    s_waitcnt lgkmcnt(6)
    v_pk_add_f32 v[60:61], v[60:61], v[64:65]
    v_pk_add_f32 v[62:63], v[62:63], v[66:67]
    s_waitcnt lgkmcnt(4)
    v_pk_add_f32 v[24:25], v[24:25], v[68:69]
    v_pk_add_f32 v[26:27], v[26:27], v[70:71]
    s_waitcnt lgkmcnt(0)
    v_pk_add_f32 v[28:29], v[28:29], v[30:31]
    v_pk_add_f32 v[32:33], v[32:33], v[34:35]
    v_pk_add_f32 v[60:61], v[60:61], v[24:25]
    v_pk_add_f32 v[62:63], v[62:63], v[26:27]
    v_pk_add_f32 v[28:29], v[28:29], v[32:33]
    v_max3_f32 v10, v60, v61, v62
    v_max3_f32 v10, v10, v63, v28
    v_max_f32 v10, v10, v29
    ds_read_b128 v[64:67], v7 offset:1024
    ds_read_b128 v[68:71], v7 offset:2048
    v_max_f32_dpp v10, v10, v10 row_ror:8 row_mask:0xf bank_mask:0xf
    v_mov_b32 v11, v10
    v_cvt_pk_bf16_f32 v20, v36, v37
    v_cvt_pk_bf16_f32 v21, v38, v39
    v_permlane16_swap_b32 v10, v11
    v_max_f32 v10, v10, v11
    v_mov_b32 v11, v10
    v_cvt_pk_bf16_f32 v22, v42, v43
    v_cvt_pk_bf16_f32 v23, v40, v41
    v_permlane32_swap_b32 v10, v11
    v_max_f32 v10, v10, v11
    v_mul_f32 v10, s34, v10
    v_pk_fma_f32 v[60:61], v[60:61], s[34:35], v[10:11] op_sel_hi:[1,1,0] neg_lo:[0,0,1] neg_hi:[0,0,1]
    v_pk_fma_f32 v[62:63], v[62:63], s[34:35], v[10:11] op_sel_hi:[1,1,0] neg_lo:[0,0,1] neg_hi:[0,0,1]
    v_pk_fma_f32 v[28:29], v[28:29], s[34:35], v[10:11] op_sel_hi:[1,1,0] neg_lo:[0,0,1] neg_hi:[0,0,1]
    v_exp_f32 v60, v60
    v_exp_f32 v61, v61
    v_exp_f32 v62, v62
    v_exp_f32 v63, v63
    v_exp_f32 v28, v28
    v_exp_f32 v29, v29
    s_waitcnt vmcnt(6)
    v_swap_b32 v56, v58
    v_cvt_pk_bf16_f32 v24, v60, v61
    v_cvt_pk_bf16_f32 v25, v62, v63
    v_cvt_pk_bf16_f32 v32, v28, v29
    v_mov_b32_dpp v26, v24 row_ror:8 row_mask:0xf bank_mask:0xf
    v_mov_b32_dpp v27, v25 row_ror:8 row_mask:0xf bank_mask:0xf
    v_mov_b32_dpp v33, v32 row_ror:8 row_mask:0xf bank_mask:0xf
    v_swap_b32 v57, v59
    v_mfma_f32_16x16x32_bf16 v[72:75], v[52:55], v[24:27], 0
    v_add_f32 v11, v28, v29
    v_pk_add_f32 v[60:61], v[60:61], v[62:63]
    v_mfma_f32_16x16x32_bf16 v[76:79], v[56:59], v[24:27], 0
    v_add_f32 v10, v60, v61
    v_fmac_f32 v10, 0.5, v11
    v_mfma_f32_16x16x16_bf16 v[72:75], v[20:21], v[32:33], v[72:75]
    s_nop 0
    v_add_f32_dpp v10, v10, v10 row_ror:8 row_mask:0xf bank_mask:0xf
    v_mfma_f32_16x16x16_bf16 v[76:79], v[22:23], v[32:33], v[76:79]
    v_mov_b32 v11, v10
    ds_read_b128 v[32:35], v7 offset:0
    ds_read_b128 v[52:55], v7 offset:3072
    v_permlane16_swap_b32 v10, v11
    v_add_f32 v10, v10, v11
    v_mov_b32 v11, v10
    s_nop 1
    v_mov_b32_dpp v72, v76 quad_perm:[0,1,2,3] row_mask:0xf bank_mask:0xc
    v_mov_b32_dpp v73, v77 quad_perm:[0,1,2,3] row_mask:0xf bank_mask:0xc
    v_permlane32_swap_b32 v10, v11
    v_add_f32 v10, v10, v11
    v_rcp_f32 v10, v10
    v_mov_b32_dpp v74, v78 quad_perm:[0,1,2,3] row_mask:0xf bank_mask:0xc
    v_mov_b32_dpp v75, v79 quad_perm:[0,1,2,3] row_mask:0xf bank_mask:0xc
    v_pk_mul_f32 v[72:73], v[72:73], v[10:11] op_sel_hi:[1,0]
    v_pk_mul_f32 v[74:75], v[74:75], v[10:11] op_sel_hi:[1,0]
    v_cvt_pk_bf16_f32 v72, v72, v73
    v_cvt_pk_bf16_f32 v73, v74, v75
    ds_write_b64 v6, v[72:73]
    ds_read_b128 v[56:59], v7 offset:4096
    ds_read_b128 v[36:39], v7 offset:5120
    ds_read_b128 v[40:43], v7 offset:6144
    s_add_u32 s18, s18, 16384
    s_and_b32 s18, s18, 4294770687
    s_add_u32 s21, s21, 16384
    s_and_b32 s21, s21, 4294770687
    s_add_u32 s39, s39, 16384
    s_and_b32 s39, s39, 4294770687
    s_add_u32 s65, s65, 16384
    s_and_b32 s65, s65, 4294770687
    s_waitcnt lgkmcnt(3)
    s_barrier
    ds_read_b128 v[72:75], v9 offset:0
    ds_read_b128 v[76:79], v9 offset:512
    ds_read_b128 v[28:31], v9 offset:1024
    ds_read_b128 v[60:63], v9 offset:1536
    s_add_u32 s24, s24, 16384
    s_and_b32 s24, s24, 4294770687
    s_add_u32 s23, s23, 524288
    s_add_u32 s25, s25, 32768
    s_xor_b32 s36, s36, 524288
    s_cmp_eq_u32 s12, 0
    v_add_u32 v10, s19, v0
    s_waitcnt lgkmcnt(3)
    v_mfma_f32_16x16x32_bf16 v[20:23], v[32:35], v[72:75], 0
    ds_read_b128 v[32:35], v7 offset:7168
    s_waitcnt lgkmcnt(3)
    v_mfma_f32_16x16x32_bf16 v[20:23], v[64:67], v[76:79], v[20:23]
    ds_read_b128 v[64:67], v7 offset:8192
    s_waitcnt lgkmcnt(3)
    v_mfma_f32_16x16x32_bf16 v[20:23], v[68:71], v[28:31], v[20:23]
    ds_read_b128 v[68:71], v7 offset:9216
    s_waitcnt lgkmcnt(3)
    v_mfma_f32_16x16x32_bf16 v[20:23], v[52:55], v[60:63], v[20:23]
    ds_read_b128 v[52:55], v7 offset:10240
    v_mfma_f32_16x16x32_bf16 v[24:27], v[56:59], v[72:75], 0
    ds_read_b128 v[56:59], v7 offset:11264
    v_mfma_f32_16x16x32_bf16 v[24:27], v[36:39], v[76:79], v[24:27]
    ds_read_b128 v[36:39], v7 offset:12288
    v_cvt_pk_bf16_f32 v20, v20, v21
    s_waitcnt lgkmcnt(5)
    v_mfma_f32_16x16x32_bf16 v[24:27], v[40:43], v[28:31], v[24:27]
    ds_read_b128 v[40:43], v7 offset:13312
    v_cvt_pk_bf16_f32 v21, v22, v23
    v_mfma_f32_16x16x32_bf16 v[24:27], v[32:35], v[60:63], v[24:27]
    ds_read_b128 v[32:35], v7 offset:14336
    buffer_store_dwordx2 v[20:21], v1, s[8:11], s52 offen sc1
    s_waitcnt lgkmcnt(5)
    v_mfma_f32_16x16x32_bf16 v[20:23], v[64:67], v[72:75], 0
    ds_read_b128 v[64:67], v7 offset:15360
    v_mfma_f32_16x16x32_bf16 v[20:23], v[68:71], v[76:79], v[20:23]
    ds_read_b128 v[68:71], v7 offset:16384
    v_cvt_pk_bf16_f32 v24, v24, v25
    s_waitcnt lgkmcnt(5)
    v_mfma_f32_16x16x32_bf16 v[20:23], v[52:55], v[28:31], v[20:23]
    ds_read_b128 v[52:55], v7 offset:17408
    v_cvt_pk_bf16_f32 v25, v26, v27
    v_mfma_f32_16x16x32_bf16 v[20:23], v[56:59], v[60:63], v[20:23]
    ds_read_b128 v[56:59], v7 offset:18432
    buffer_store_dwordx2 v[24:25], v1, s[8:11], s53 offen sc1
    s_waitcnt lgkmcnt(5)
    v_mfma_f32_16x16x32_bf16 v[24:27], v[36:39], v[72:75], 0
    ds_read_b128 v[36:39], v7 offset:19456
    v_mfma_f32_16x16x32_bf16 v[24:27], v[40:43], v[76:79], v[24:27]
    ds_read_b128 v[40:43], v7 offset:20480
    v_cvt_pk_bf16_f32 v20, v20, v21
    s_waitcnt lgkmcnt(5)
    v_mfma_f32_16x16x32_bf16 v[24:27], v[32:35], v[28:31], v[24:27]
    ds_read_b128 v[32:35], v7 offset:21504
    v_cvt_pk_bf16_f32 v21, v22, v23
    v_mfma_f32_16x16x32_bf16 v[24:27], v[64:67], v[60:63], v[24:27]
    ds_read_b128 v[64:67], v7 offset:22528
    buffer_store_dwordx2 v[20:21], v1, s[8:11], s54 offen sc1
    s_cbranch_scc1 S_w0
    s_waitcnt lgkmcnt(5)
    v_mfma_f32_16x16x32_bf16 v[20:23], v[68:71], v[72:75], 0
    ds_read_b128 v[68:71], v7 offset:23552
    v_mfma_f32_16x16x32_bf16 v[20:23], v[52:55], v[76:79], v[20:23]
    ds_read_b128 v[52:55], v7 offset:24576
    v_cvt_pk_bf16_f32 v24, v24, v25
    s_waitcnt lgkmcnt(5)
    v_mfma_f32_16x16x32_bf16 v[20:23], v[56:59], v[28:31], v[20:23]
    ds_read_b128 v[56:59], v7 offset:25600
    v_cvt_pk_bf16_f32 v25, v26, v27
    v_mfma_f32_16x16x32_bf16 v[20:23], v[36:39], v[60:63], v[20:23]
    ds_read_b128 v[36:39], v7 offset:26624
    buffer_store_dwordx2 v[24:25], v1, s[8:11], s55 offen sc1
    s_waitcnt lgkmcnt(5)
    v_mfma_f32_16x16x32_bf16 v[24:27], v[40:43], v[72:75], 0
    ds_read_b128 v[40:43], v7 offset:27648
    v_mfma_f32_16x16x32_bf16 v[24:27], v[32:35], v[76:79], v[24:27]
    ds_read_b128 v[32:35], v10 offset:0
    v_cvt_pk_bf16_f32 v20, v20, v21
    s_waitcnt lgkmcnt(5)
    v_mfma_f32_16x16x32_bf16 v[24:27], v[64:67], v[28:31], v[24:27]
    ds_read_b128 v[64:67], v10 offset:1024
    v_cvt_pk_bf16_f32 v21, v22, v23
    v_mfma_f32_16x16x32_bf16 v[24:27], v[68:71], v[60:63], v[24:27]
    ds_read_b128 v[68:71], v10 offset:2048
    buffer_store_dwordx2 v[20:21], v1, s[8:11], s56 offen sc1
    s_waitcnt lgkmcnt(5)
    v_mfma_f32_16x16x32_bf16 v[20:23], v[52:55], v[72:75], 0
    ds_read_b128 v[52:55], v10 offset:3072
    v_mfma_f32_16x16x32_bf16 v[20:23], v[56:59], v[76:79], v[20:23]
    ds_read_b128 v[56:59], v7 offset:28672
    v_cvt_pk_bf16_f32 v24, v24, v25
    s_waitcnt lgkmcnt(5)
    v_mfma_f32_16x16x32_bf16 v[20:23], v[36:39], v[28:31], v[20:23]
    ds_read_b128 v[36:39], v7 offset:29696
    v_cvt_pk_bf16_f32 v25, v26, v27
    v_mfma_f32_16x16x32_bf16 v[20:23], v[40:43], v[60:63], v[20:23]
    ds_read_b128 v[40:43], v7 offset:30720
    buffer_store_dwordx2 v[24:25], v1, s[8:11], s57 offen sc1
    s_waitcnt lgkmcnt(5)
    v_mfma_f32_16x16x32_bf16 v[24:27], v[32:35], v[72:75], 0
    ds_read_b128 v[32:35], v7 offset:31744
    s_cmp_eq_u32 s27, 1
    s_cbranch_scc1 S_w3e
    v_mfma_f32_16x16x32_bf16 v[24:27], v[64:67], v[76:79], v[24:27]
    ds_read_b128 v[64:67], v7 offset:32768
    v_cvt_pk_bf16_f32 v20, v20, v21
    s_waitcnt lgkmcnt(5)
    v_mfma_f32_16x16x32_bf16 v[24:27], v[68:71], v[28:31], v[24:27]
    ds_read_b128 v[68:71], v7 offset:33792
    v_cvt_pk_bf16_f32 v21, v22, v23
    v_mfma_f32_16x16x32_bf16 v[24:27], v[52:55], v[60:63], v[24:27]
    ds_read_b128 v[52:55], v7 offset:34816
    buffer_store_dwordx2 v[20:21], v1, s[8:11], s58 offen sc1
    s_waitcnt lgkmcnt(5)
    v_mfma_f32_16x16x32_bf16 v[20:23], v[56:59], v[72:75], 0
    ds_read_b128 v[56:59], v7 offset:35840
    v_mfma_f32_16x16x32_bf16 v[20:23], v[36:39], v[76:79], v[20:23]
    v_cvt_pk_bf16_f32 v24, v24, v25
    s_waitcnt lgkmcnt(4)
    v_mfma_f32_16x16x32_bf16 v[20:23], v[40:43], v[28:31], v[20:23]
    v_cvt_pk_bf16_f32 v25, v26, v27
    v_mfma_f32_16x16x32_bf16 v[20:23], v[32:35], v[60:63], v[20:23]
    buffer_store_dwordx2 v[24:25], v1, s[8:11], s61 offen sc1
    s_waitcnt lgkmcnt(2)
    v_mfma_f32_16x16x32_bf16 v[24:27], v[64:67], v[72:75], 0
    v_mov_b64 v[72:73], 0
    v_mov_b64 v[74:75], 0
    v_mfma_f32_16x16x32_bf16 v[24:27], v[68:71], v[76:79], v[24:27]
    v_cvt_pk_bf16_f32 v20, v20, v21
    v_mov_b32_dpp v72, v2 quad_perm:[0,1,2,3] row_mask:0xf bank_mask:0x1
    s_waitcnt lgkmcnt(0)
    v_mfma_f32_16x16x32_bf16 v[24:27], v[52:55], v[28:31], v[24:27]
    v_cvt_pk_bf16_f32 v21, v22, v23
    v_mov_b32_dpp v73, v3 quad_perm:[0,1,2,3] row_mask:0xf bank_mask:0x1
    v_mfma_f32_16x16x32_bf16 v[24:27], v[56:59], v[60:63], v[24:27]
    buffer_store_dwordx2 v[20:21], v1, s[8:11], s59 offen sc1
    v_mov_b32_dpp v74, v2 quad_perm:[0,1,2,3] row_mask:0xf bank_mask:0x2
    v_mov_b32_dpp v75, v3 quad_perm:[0,1,2,3] row_mask:0xf bank_mask:0x2
    s_xor_b32 s52, s52, 524288
    s_xor_b32 s53, s53, 524288
    s_cmp_eq_u32 s27, 0
    s_nop 1
    v_cvt_pk_bf16_f32 v24, v24, v25
    v_cvt_pk_bf16_f32 v25, v26, v27
    buffer_store_dwordx2 v[24:25], v1, s[8:11], s60 offen sc1
    s_cbranch_scc1 S_k2
    s_xor_b32 s54, s54, 524288
    s_xor_b32 s55, s55, 524288
    s_xor_b32 s56, s56, 524288
    s_xor_b32 s57, s57, 524288
    s_xor_b32 s58, s58, 524288
    s_xor_b32 s59, s59, 524288
    s_xor_b32 s60, s60, 524288
    s_xor_b32 s61, s61, 524288
S_lgate:
    ds_read_b32 v10, v0 offset:0
    s_add_u32 s37, s37, 1
    s_cmp_gt_u32 s37, 0x100000
    s_cbranch_scc1 S_lgated
    s_waitcnt lgkmcnt(0)
    v_cmp_ne_u32 vcc, s14, v10
    s_cbranch_vccnz S_lgate
S_lgated:
    v_mov_b64 v[20:21], 0
    v_mov_b64 v[22:23], 0
    v_mov_b64 v[24:25], 0
    v_mov_b64 v[26:27], 0
    v_mov_b64 v[28:29], 0
    v_mov_b64 v[30:31], 0
    buffer_load_dwordx4 v[64:67], v0, s[8:11], s22 offen offset:0 sc1
    buffer_load_dwordx4 v[68:71], v0, s[8:11], s22 offen offset:1024 sc1
    buffer_load_dwordx4 v[52:55], v0, s[8:11], s22 offen offset:2048 sc1
    buffer_load_dwordx4 v[56:59], v0, s[8:11], s22 offen offset:3072 sc1
    v_mov_b64 v[32:33], 0
    v_mov_b64 v[34:35], 0
    v_mov_b64 v[36:37], 0
    v_mov_b64 v[38:39], 0
    v_mov_b64 v[40:41], 0
    v_mov_b64 v[42:43], 0
S_l2:
    buffer_load_dwordx4 v[64:67], v0, s[8:11], s22 offen offset:0 sc1
    buffer_load_dwordx4 v[68:71], v0, s[8:11], s22 offen offset:1024 sc1
    buffer_load_dwordx4 v[52:55], v0, s[8:11], s22 offen offset:2048 sc1
    buffer_load_dwordx4 v[56:59], v0, s[8:11], s22 offen offset:3072 sc1
    s_waitcnt vmcnt(7)
    v_mfma_f32_16x16x32_bf16 v[60:63], v[72:75], v[64:67], 0
    s_waitcnt vmcnt(6)
    v_mfma_f32_16x16x32_bf16 v[60:63], v[72:75], v[68:71], v[60:63]
    s_waitcnt vmcnt(5)
    v_mfma_f32_16x16x32_bf16 v[60:63], v[72:75], v[52:55], v[60:63]
    s_waitcnt vmcnt(4)
    v_mfma_f32_16x16x32_bf16 v[60:63], v[72:75], v[56:59], v[60:63]
    s_nop 6
S_rl_c:
    s_nop 0
    v_cmp_u_f32 vcc, v60, v60
    v_add_f32_dpp v60, v60, v60 row_ror:8 row_mask:0xf bank_mask:0xf
    v_add_f32_dpp v61, v61, v61 row_ror:8 row_mask:0xf bank_mask:0xf
    v_add_f32_dpp v62, v62, v62 row_ror:8 row_mask:0xf bank_mask:0xf
    v_add_f32_dpp v63, v63, v63 row_ror:8 row_mask:0xf bank_mask:0xf
    v_cvt_pk_bf16_f32 v16, v60, v61
    v_cvt_pk_bf16_f32 v17, v62, v63
    s_cbranch_vccnz S_lf
S_rl_ok:
    s_mov_b32 exec_hi, 0
    buffer_store_dwordx2 v[16:17], v1, s[8:11], s24 offen sc1
    s_mov_b64 exec, -1
    s_xor_b32 s22, s22, 524288
    s_cmp_eq_u32 s14, 63
    s_cbranch_scc1 S_done
    s_waitcnt vmcnt(1)
    s_branch S_ok0
S_w0:
    s_nop 1
    s_waitcnt lgkmcnt(5)
    v_mfma_f32_16x16x32_bf16 v[20:23], v[68:71], v[72:75], 0
    ds_read_b128 v[68:71], v7 offset:23552
    v_mfma_f32_16x16x32_bf16 v[20:23], v[52:55], v[76:79], v[20:23]
    v_cvt_pk_bf16_f32 v24, v24, v25
    s_waitcnt lgkmcnt(4)
    v_mfma_f32_16x16x32_bf16 v[20:23], v[56:59], v[28:31], v[20:23]
    v_cvt_pk_bf16_f32 v25, v26, v27
    v_mfma_f32_16x16x32_bf16 v[20:23], v[36:39], v[60:63], v[20:23]
    buffer_store_dwordx2 v[24:25], v1, s[8:11], s55 offen sc1
    s_waitcnt lgkmcnt(2)
    v_mfma_f32_16x16x32_bf16 v[24:27], v[40:43], v[72:75], 0
    v_mov_b64 v[72:73], 0
    v_mov_b64 v[74:75], 0
    v_mfma_f32_16x16x32_bf16 v[24:27], v[32:35], v[76:79], v[24:27]
    v_cvt_pk_bf16_f32 v20, v20, v21
    v_mov_b32_dpp v72, v2 quad_perm:[0,1,2,3] row_mask:0xf bank_mask:0x1
    s_waitcnt lgkmcnt(0)
    v_mfma_f32_16x16x32_bf16 v[24:27], v[64:67], v[28:31], v[24:27]
    v_cvt_pk_bf16_f32 v21, v22, v23
    v_mov_b32_dpp v73, v3 quad_perm:[0,1,2,3] row_mask:0xf bank_mask:0x1
    v_mfma_f32_16x16x32_bf16 v[24:27], v[68:71], v[60:63], v[24:27]
    buffer_store_dwordx2 v[20:21], v1, s[8:11], s56 offen sc1
    v_mov_b32_dpp v74, v2 quad_perm:[0,1,2,3] row_mask:0xf bank_mask:0x2
    v_mov_b32_dpp v75, v3 quad_perm:[0,1,2,3] row_mask:0xf bank_mask:0x2
    s_xor_b32 s52, s52, 524288
    s_xor_b32 s53, s53, 524288
    s_cmp_eq_u32 s27, 0
    s_nop 1
    v_cvt_pk_bf16_f32 v24, v24, v25
    v_cvt_pk_bf16_f32 v25, v26, v27
    buffer_store_dwordx2 v[24:25], v1, s[8:11], s57 offen sc1
    buffer_load_dwordx4 v[64:67], v0, s[8:11], s22 offen offset:0 sc1
    buffer_load_dwordx4 v[68:71], v0, s[8:11], s22 offen offset:1024 sc1
    buffer_load_dwordx4 v[52:55], v0, s[8:11], s22 offen offset:2048 sc1
    buffer_load_dwordx4 v[56:59], v0, s[8:11], s22 offen offset:3072 sc1
    s_nop 15
    s_nop 7
S_e2:
    buffer_load_dwordx4 v[64:67], v0, s[8:11], s22 offen offset:0 sc1
    buffer_load_dwordx4 v[68:71], v0, s[8:11], s22 offen offset:1024 sc1
    buffer_load_dwordx4 v[52:55], v0, s[8:11], s22 offen offset:2048 sc1
    buffer_load_dwordx4 v[56:59], v0, s[8:11], s22 offen offset:3072 sc1
    s_waitcnt vmcnt(7)
    v_mfma_f32_16x16x32_bf16 v[60:63], v[72:75], v[64:67], 0
    s_waitcnt vmcnt(6)
    v_mfma_f32_16x16x32_bf16 v[60:63], v[72:75], v[68:71], v[60:63]
    s_waitcnt vmcnt(5)
    v_mfma_f32_16x16x32_bf16 v[60:63], v[72:75], v[52:55], v[60:63]
    s_waitcnt vmcnt(4)
    v_mfma_f32_16x16x32_bf16 v[60:63], v[72:75], v[56:59], v[60:63]
    s_nop 6
S_re_c:
    s_nop 0
    v_cmp_u_f32 vcc, v60, v60
    v_add_f32_dpp v60, v60, v60 row_ror:8 row_mask:0xf bank_mask:0xf
    v_add_f32_dpp v61, v61, v61 row_ror:8 row_mask:0xf bank_mask:0xf
    v_add_f32_dpp v62, v62, v62 row_ror:8 row_mask:0xf bank_mask:0xf
    v_add_f32_dpp v63, v63, v63 row_ror:8 row_mask:0xf bank_mask:0xf
    v_cvt_pk_bf16_f32 v16, v60, v61
    v_cvt_pk_bf16_f32 v17, v62, v63
    s_cbranch_vccnz S_ef
S_re_ok:
    s_mov_b32 exec_hi, 0
    buffer_store_dwordx2 v[16:17], v1, s[8:11], s24 offen sc1
    s_mov_b64 exec, -1
    v_mov_b32 v10, s14
    ds_write_b32 v0, v10 offset:0
    s_xor_b32 s22, s22, 524288
    s_cmp_eq_u32 s14, 63
    s_cbranch_scc1 S_done
    s_branch S_loop
S_k2:
    s_cmp_eq_u32 s14, 63
    s_cbranch_scc1 S_end
    s_cmp_eq_u32 s12, 3
    s_cbranch_scc1 S_w3z
S_gate:
    ds_read_b32 v10, v0 offset:0
    s_add_u32 s37, s37, 1
    s_cmp_gt_u32 s37, 0x100000
    s_cbranch_scc1 S_gated
    s_waitcnt lgkmcnt(0)
    v_cmp_ne_u32 vcc, s14, v10
    s_cbranch_vccnz S_gate
S_gated:
    s_branch S_loop
S_w3e:
    v_mfma_f32_16x16x32_bf16 v[24:27], v[64:67], v[76:79], v[24:27]
    ds_read_b128 v[64:67], v7 offset:32768
    v_cvt_pk_bf16_f32 v20, v20, v21
    s_waitcnt lgkmcnt(5)
    v_mfma_f32_16x16x32_bf16 v[24:27], v[68:71], v[28:31], v[24:27]
    ds_read_b128 v[68:71], v7 offset:33792
    v_cvt_pk_bf16_f32 v21, v22, v23
    v_mfma_f32_16x16x32_bf16 v[24:27], v[52:55], v[60:63], v[24:27]
    ds_read_b128 v[52:55], v7 offset:34816
    buffer_store_dwordx2 v[20:21], v1, s[8:11], s58 offen sc1
    s_waitcnt lgkmcnt(5)
    v_mfma_f32_16x16x32_bf16 v[20:23], v[56:59], v[72:75], 0
    ds_read_b128 v[56:59], v7 offset:35840
    v_mfma_f32_16x16x32_bf16 v[20:23], v[36:39], v[76:79], v[20:23]
    buffer_load_dwordx4 v[36:39], v0, s[8:11], s22 offen offset:0 sc1
    v_cvt_pk_bf16_f32 v24, v24, v25
    s_waitcnt lgkmcnt(4)
    v_mfma_f32_16x16x32_bf16 v[20:23], v[40:43], v[28:31], v[20:23]
    buffer_load_dwordx4 v[40:43], v0, s[8:11], s22 offen offset:1024 sc1
    v_cvt_pk_bf16_f32 v25, v26, v27
    v_mfma_f32_16x16x32_bf16 v[20:23], v[32:35], v[60:63], v[20:23]
    buffer_load_dwordx4 v[32:35], v0, s[8:11], s22 offen offset:2048 sc1
    buffer_store_dwordx2 v[24:25], v1, s[8:11], s61 offen sc1
    s_waitcnt lgkmcnt(2)
    v_mfma_f32_16x16x32_bf16 v[24:27], v[64:67], v[72:75], 0
    buffer_load_dwordx4 v[64:67], v0, s[8:11], s22 offen offset:3072 sc1
    v_mov_b64 v[72:73], 0
    v_mov_b64 v[74:75], 0
    v_mfma_f32_16x16x32_bf16 v[24:27], v[68:71], v[76:79], v[24:27]
    v_cvt_pk_bf16_f32 v20, v20, v21
    v_mov_b32_dpp v72, v2 quad_perm:[0,1,2,3] row_mask:0xf bank_mask:0x1
    s_waitcnt lgkmcnt(0)
    v_mfma_f32_16x16x32_bf16 v[24:27], v[52:55], v[28:31], v[24:27]
    v_cvt_pk_bf16_f32 v21, v22, v23
    v_mov_b32_dpp v73, v3 quad_perm:[0,1,2,3] row_mask:0xf bank_mask:0x1
    v_mfma_f32_16x16x32_bf16 v[24:27], v[56:59], v[60:63], v[24:27]
    buffer_store_dwordx2 v[20:21], v1, s[8:11], s59 offen sc1
    v_mov_b32_dpp v74, v2 quad_perm:[0,1,2,3] row_mask:0xf bank_mask:0x2
    v_mov_b32_dpp v75, v3 quad_perm:[0,1,2,3] row_mask:0xf bank_mask:0x2
    s_xor_b32 s52, s52, 524288
    s_xor_b32 s53, s53, 524288
    s_cmp_eq_u32 s27, 0
    s_nop 1
    v_cvt_pk_bf16_f32 v24, v24, v25
    v_cvt_pk_bf16_f32 v25, v26, v27
    buffer_store_dwordx2 v[24:25], v1, s[8:11], s60 offen sc1
    s_waitcnt vmcnt(6)
    v_mfma_f32_16x16x32_bf16 v[60:63], v[72:75], v[36:39], 0
    s_waitcnt vmcnt(5)
    v_mfma_f32_16x16x32_bf16 v[60:63], v[72:75], v[40:43], v[60:63]
    s_waitcnt vmcnt(4)
    v_mfma_f32_16x16x32_bf16 v[60:63], v[72:75], v[32:35], v[60:63]
    s_waitcnt vmcnt(2)
    v_mfma_f32_16x16x32_bf16 v[60:63], v[72:75], v[64:67], v[60:63]
    s_nop 6
S_r3_c:
    s_nop 0
    v_cmp_u_f32 vcc, v60, v60
    v_add_f32_dpp v60, v60, v60 row_ror:8 row_mask:0xf bank_mask:0xf
    v_add_f32_dpp v61, v61, v61 row_ror:8 row_mask:0xf bank_mask:0xf
    v_add_f32_dpp v62, v62, v62 row_ror:8 row_mask:0xf bank_mask:0xf
    v_add_f32_dpp v63, v63, v63 row_ror:8 row_mask:0xf bank_mask:0xf
    v_cvt_pk_bf16_f32 v16, v60, v61
    v_cvt_pk_bf16_f32 v17, v62, v63
    s_cbranch_vccnz S_3f
S_r3_ok:
    s_mov_b32 exec_hi, 0
    buffer_store_dwordx2 v[16:17], v1, s[8:11], s24 offen sc1
    s_mov_b64 exec, -1
    s_xor_b32 s22, s22, 524288
    s_cmp_eq_u32 s14, 63
    s_cbranch_scc1 S_done
S_w3z:
    v_mov_b64 v[20:21], 0
    v_mov_b64 v[22:23], 0
    v_mov_b64 v[24:25], 0
    v_mov_b64 v[26:27], 0
    v_mov_b64 v[28:29], 0
    v_mov_b64 v[30:31], 0
    v_mov_b64 v[32:33], 0
    v_mov_b64 v[34:35], 0
    v_mov_b64 v[36:37], 0
    v_mov_b64 v[38:39], 0
    v_mov_b64 v[40:41], 0
    v_mov_b64 v[42:43], 0
    s_xor_b32 s54, s54, 524288
    s_xor_b32 s55, s55, 524288
    s_xor_b32 s56, s56, 524288
    s_xor_b32 s57, s57, 524288
    s_xor_b32 s58, s58, 524288
    s_xor_b32 s59, s59, 524288
    s_xor_b32 s60, s60, 524288
    s_xor_b32 s61, s61, 524288
    s_branch S_ok0
S_rt0:
    s_add_u32 s37, s37, 1
    s_cmp_gt_u32 s37, 0x100000
    s_cbranch_scc1 S_ok0
    s_branch S_la
S_rt2:
    s_add_u32 s37, s37, 1
    s_cmp_gt_u32 s37, 0x100000
    s_cbranch_scc1 S_ok2
    buffer_load_dwordx4 v[76:79], v0, s[8:11], s39 offen offset:0 sc1
    s_mov_b32 exec_hi, 0xffff
    buffer_load_dwordx4 v[52:55], v0, s[8:11], s21 offen sc1
    s_mov_b32 exec_hi, -1
    buffer_load_dwordx4 v[60:63], v0, s[8:11], s39 offen offset:1024 sc1
    s_waitcnt vmcnt(2)
    v_cmp_u_f32 vcc, v76, v78
    s_cbranch_vccnz S_rt2
    s_branch S_ok2
S_rt1:
    s_add_u32 s37, s37, 1
    s_cmp_gt_u32 s37, 0x100000
    s_cbranch_scc1 S_ok1
    s_mov_b32 exec_hi, 0xffff
    buffer_load_dwordx4 v[52:55], v0, s[8:11], s21 offen sc1
    s_mov_b32 exec_hi, -1
    buffer_load_dwordx4 v[60:63], v0, s[8:11], s39 offen offset:1024 sc1
    s_waitcnt vmcnt(0)
    s_mov_b32 exec_hi, 0xffff
    v_cmp_u_f32 vcc, v52, v54
    ds_write_b128 v11, v[52:55]
    s_mov_b32 exec_hi, -1
    v_cmp_u_f32 s[40:41], v60, v62
    s_nop 1
    s_or_b64 vcc, vcc, s[40:41]
    s_cbranch_vccnz S_rt1
    s_branch S_ok1
S_fl:
    s_add_u32 s37, s37, 1
    s_cmp_gt_u32 s37, 0x100000
    s_cbranch_scc1 S_flok
    v_lshrrev_b32 v10, 2, v0
    buffer_load_dword v19, v10, s[8:11], s69 offen sc1
    s_waitcnt vmcnt(0)
    v_cmp_eq_u32 s[2:3], v18, v19
    s_nop 1
    s_bitcmp1_b64 s[2:3], s14
    s_cbranch_scc0 S_fl
    s_branch S_flok
S_fa:
    v_lshrrev_b32 v11, 2, v0
    buffer_load_dword v19, v11, s[8:11], s69 offen sc1
    s_branch S_fad
S_lf:
    s_add_u32 s37, s37, 1
    s_cmp_gt_u32 s37, 0x100000
    s_cbranch_scc1 S_rl_ok
    s_branch S_l2
S_ef:
    s_add_u32 s37, s37, 1
    s_cmp_gt_u32 s37, 0x100000
    s_cbranch_scc1 S_re_ok
    s_branch S_e2
S_3f:
    s_add_u32 s37, s37, 1
    s_cmp_gt_u32 s37, 0x100000
    s_cbranch_scc1 S_r3_ok
    buffer_load_dwordx4 v[36:39], v0, s[8:11], s22 offen offset:0 sc1
    buffer_load_dwordx4 v[40:43], v0, s[8:11], s22 offen offset:1024 sc1
    buffer_load_dwordx4 v[32:35], v0, s[8:11], s22 offen offset:2048 sc1
    buffer_load_dwordx4 v[64:67], v0, s[8:11], s22 offen offset:3072 sc1
    s_waitcnt vmcnt(3)
    v_mfma_f32_16x16x32_bf16 v[60:63], v[72:75], v[36:39], 0
    s_waitcnt vmcnt(2)
    v_mfma_f32_16x16x32_bf16 v[60:63], v[72:75], v[40:43], v[60:63]
    s_waitcnt vmcnt(1)
    v_mfma_f32_16x16x32_bf16 v[60:63], v[72:75], v[32:35], v[60:63]
    s_waitcnt vmcnt(0)
    v_mfma_f32_16x16x32_bf16 v[60:63], v[72:75], v[64:67], v[60:63]
    s_nop 7
    s_branch S_r3_c
S_done:
    s_mov_b32 exec_hi, 0
    buffer_store_dwordx4 v[16:19], v9, s[8:11], s25 offen sc1
    s_mov_b64 exec, -1
S_end:
C_fin:
    s_endpgm
R_fft:
    s_load_dwordx2 s[24:25], s[0:1], 0
    s_mov_b32 s26, 2359296
    s_mov_b32 s27, 0x00020000
    s_load_dwordx2 s[28:29], s[0:1], 8
    s_mov_b32 s30, 1183744
    s_mov_b32 s31, 0x00020000
    s_load_dwordx2 s[32:33], s[0:1], 16
    s_mov_b32 s34, 1183744
    s_mov_b32 s35, 0x00020000
    s_load_dwordx2 s[36:37], s[0:1], 80
    s_mov_b32 s38, 4718592
    s_mov_b32 s39, 0x00020000
    s_load_dwordx2 s[40:41], s[0:1], 88
    s_load_dwordx2 s[44:45], s[0:1], 40
    s_mov_b32 s46, 4718592
    s_mov_b32 s47, 0x00020000
    s_load_dwordx2 s[48:49], s[0:1], 48
    s_mov_b32 s50, 4718592
    s_mov_b32 s51, 0x00020000
    s_load_dwordx2 s[52:53], s[0:1], 56
    s_mov_b32 s54, 4718592
    s_mov_b32 s55, 0x00020000
    s_load_dwordx2 s[56:57], s[0:1], 64
    s_mov_b32 s58, 4718592
    s_mov_b32 s59, 0x00020000
    s_sub_u32 s12, s4, 5
    s_lshl_b32 s12, s12, 5
    s_add_u32 s12, s12, s5
    s_mov_b32 s19, 0
    v_and_b32 v1, 63, v0
    v_lshrrev_b32 v2, 5, v1
    v_and_b32 v3, 31, v1
    s_waitcnt lgkmcnt(0)
    s_lshl_b32 s13, s12, 2
    s_add_u32 s21, s13, s6
    s_mul_i32 s14, s21, 12288
    v_lshlrev_b32 v4, 4, v1
    s_add_u32 s15, s14, 0
    buffer_load_dwordx4 v[100:103], v4, s[44:47], s15 offen offset:0
    buffer_load_dwordx4 v[100:103], v4, s[44:47], s15 offen offset:1024
    buffer_load_dwordx4 v[100:103], v4, s[44:47], s15 offen offset:2048
    buffer_load_dwordx4 v[100:103], v4, s[44:47], s15 offen offset:3072
    s_add_u32 s15, s14, 4096
    buffer_load_dwordx4 v[100:103], v4, s[44:47], s15 offen offset:0
    buffer_load_dwordx4 v[100:103], v4, s[44:47], s15 offen offset:1024
    buffer_load_dwordx4 v[100:103], v4, s[44:47], s15 offen offset:2048
    buffer_load_dwordx4 v[100:103], v4, s[44:47], s15 offen offset:3072
    s_add_u32 s15, s14, 8192
    buffer_load_dwordx4 v[100:103], v4, s[44:47], s15 offen offset:0
    buffer_load_dwordx4 v[100:103], v4, s[44:47], s15 offen offset:1024
    buffer_load_dwordx4 v[100:103], v4, s[44:47], s15 offen offset:2048
    buffer_load_dwordx4 v[100:103], v4, s[44:47], s15 offen offset:3072
    s_add_u32 s15, s14, 0
    buffer_load_dwordx4 v[100:103], v4, s[48:51], s15 offen offset:0
    buffer_load_dwordx4 v[100:103], v4, s[48:51], s15 offen offset:1024
    buffer_load_dwordx4 v[100:103], v4, s[48:51], s15 offen offset:2048
    buffer_load_dwordx4 v[100:103], v4, s[48:51], s15 offen offset:3072
    s_add_u32 s15, s14, 4096
    buffer_load_dwordx4 v[100:103], v4, s[48:51], s15 offen offset:0
    buffer_load_dwordx4 v[100:103], v4, s[48:51], s15 offen offset:1024
    buffer_load_dwordx4 v[100:103], v4, s[48:51], s15 offen offset:2048
    buffer_load_dwordx4 v[100:103], v4, s[48:51], s15 offen offset:3072
    s_add_u32 s15, s14, 8192
    buffer_load_dwordx4 v[100:103], v4, s[48:51], s15 offen offset:0
    buffer_load_dwordx4 v[100:103], v4, s[48:51], s15 offen offset:1024
    buffer_load_dwordx4 v[100:103], v4, s[48:51], s15 offen offset:2048
    buffer_load_dwordx4 v[100:103], v4, s[48:51], s15 offen offset:3072
    s_add_u32 s15, s14, 0
    buffer_load_dwordx4 v[100:103], v4, s[52:55], s15 offen offset:0
    buffer_load_dwordx4 v[100:103], v4, s[52:55], s15 offen offset:1024
    buffer_load_dwordx4 v[100:103], v4, s[52:55], s15 offen offset:2048
    buffer_load_dwordx4 v[100:103], v4, s[52:55], s15 offen offset:3072
    s_add_u32 s15, s14, 4096
    buffer_load_dwordx4 v[100:103], v4, s[52:55], s15 offen offset:0
    buffer_load_dwordx4 v[100:103], v4, s[52:55], s15 offen offset:1024
    buffer_load_dwordx4 v[100:103], v4, s[52:55], s15 offen offset:2048
    buffer_load_dwordx4 v[100:103], v4, s[52:55], s15 offen offset:3072
    s_add_u32 s15, s14, 8192
    buffer_load_dwordx4 v[100:103], v4, s[52:55], s15 offen offset:0
    buffer_load_dwordx4 v[100:103], v4, s[52:55], s15 offen offset:1024
    buffer_load_dwordx4 v[100:103], v4, s[52:55], s15 offen offset:2048
    buffer_load_dwordx4 v[100:103], v4, s[52:55], s15 offen offset:3072
    s_add_u32 s15, s14, 0
    buffer_load_dwordx4 v[100:103], v4, s[56:59], s15 offen offset:0
    buffer_load_dwordx4 v[100:103], v4, s[56:59], s15 offen offset:1024
    buffer_load_dwordx4 v[100:103], v4, s[56:59], s15 offen offset:2048
    buffer_load_dwordx4 v[100:103], v4, s[56:59], s15 offen offset:3072
    s_add_u32 s15, s14, 4096
    buffer_load_dwordx4 v[100:103], v4, s[56:59], s15 offen offset:0
    buffer_load_dwordx4 v[100:103], v4, s[56:59], s15 offen offset:1024
    buffer_load_dwordx4 v[100:103], v4, s[56:59], s15 offen offset:2048
    buffer_load_dwordx4 v[100:103], v4, s[56:59], s15 offen offset:3072
    s_add_u32 s15, s14, 8192
    buffer_load_dwordx4 v[100:103], v4, s[56:59], s15 offen offset:0
    buffer_load_dwordx4 v[100:103], v4, s[56:59], s15 offen offset:1024
    buffer_load_dwordx4 v[100:103], v4, s[56:59], s15 offen offset:2048
    buffer_load_dwordx4 v[100:103], v4, s[56:59], s15 offen offset:3072
    s_waitcnt vmcnt(0)
    v_readfirstlane_b32 s7, v59
    s_nop 0
    s_add_u32 s7, s7, 1
    s_load_dwordx2 s[60:61], s[0:1], 32
    s_mov_b32 s62, 9216
    s_mov_b32 s63, 0x00020000
    s_cmp_ge_u32 s12, 45
    s_cbranch_scc1 F_noinit
    v_mov_b64 v[100:101], -1
    v_mov_b64 v[102:103], -1
    v_lshlrev_b32 v4, 6, v1
    s_cmp_ge_u32 s21, 144
    s_cbranch_scc1 F_imb
    s_cmp_ge_u32 s21, 72
    s_cselect_b32 s14, 229376, 0
    s_lshl_b32 s15, s21, 12
    s_add_u32 s15, s15, s14
    s_add_u32 s15, s15, 8388608
    s_branch F_ist
F_imb:
    s_sub_u32 s14, s21, 144
    s_mul_i32 s15, s14, 57
    s_lshr_b32 s15, s15, 9
    s_mul_i32 s22, s15, 9
    s_sub_u32 s22, s14, s22
    s_cmp_lg_u32 s15, 0
    s_cbranch_scc1 F_imn
    v_and_b32 v4, 7, v1
    v_mul_u32_u24 v4, 1152, v4
    v_lshrrev_b32 v5, 3, v1
    v_lshl_add_u32 v4, v5, 4, v4
    s_lshl_b32 s23, s22, 7
    s_waitcnt lgkmcnt(0)
    buffer_load_dwordx4 v[100:103], v4, s[60:63], s23 offen
F_imn:
    v_lshlrev_b32 v4, 4, v1
    s_lshl_b32 s15, s15, 14
    s_lshl_b32 s22, s22, 10
    s_add_u32 s15, s15, s22
    s_add_u32 s15, s15, 1049600
    s_waitcnt vmcnt(0)
F_ist:
    buffer_store_dwordx4 v[100:103], v4, s[8:11], s15 offen sc1
    s_waitcnt vmcnt(0)
    s_barrier
    s_cmp_lg_u32 s6, 0
    s_cbranch_scc1 FB_na64
    s_mov_b64 exec, 1
    v_mov_b32 v4, 64
    v_mov_b32 v5, 1
    global_atomic_add v4, v5, s[40:41]
    s_mov_b64 exec, -1
FB_na64:
F_noinit:
    s_cmp_eq_u32 s3, 0
    s_cbranch_scc1 FF_la
    s_cmp_lg_u32 s6, 0
    s_cbranch_scc1 FF_la
    s_mov_b64 exec, 1
    v_mov_b32 v4, 32
    v_mov_b32 v5, 1
    global_atomic_add v4, v5, s[40:41]
    s_mov_b64 exec, -1
FF_la:
    s_cmp_gt_u32 s21, 288
    s_cbranch_scc1 F_now
    v_lshl_add_u32 v4, v2, 7, v3
    v_mul_u32_u24 v4, 578, v4
    s_lshl_b32 s14, s21, 1
    s_add_u32 s15, s14, 0
    buffer_load_ushort v64, v4, s[28:31], s15 offen
    buffer_load_ushort v16, v4, s[32:35], s15 offen
    s_add_u32 s15, s14, 18496
    buffer_load_ushort v65, v4, s[28:31], s15 offen
    buffer_load_ushort v17, v4, s[32:35], s15 offen
    s_add_u32 s15, s14, 36992
    buffer_load_ushort v66, v4, s[28:31], s15 offen
    buffer_load_ushort v18, v4, s[32:35], s15 offen
    s_add_u32 s15, s14, 55488
    buffer_load_ushort v67, v4, s[28:31], s15 offen
    buffer_load_ushort v19, v4, s[32:35], s15 offen
    s_add_u32 s15, s14, 147968
    buffer_load_ushort v68, v4, s[28:31], s15 offen
    buffer_load_ushort v20, v4, s[32:35], s15 offen
    s_add_u32 s15, s14, 166464
    buffer_load_ushort v69, v4, s[28:31], s15 offen
    buffer_load_ushort v21, v4, s[32:35], s15 offen
    s_add_u32 s15, s14, 184960
    buffer_load_ushort v70, v4, s[28:31], s15 offen
    buffer_load_ushort v22, v4, s[32:35], s15 offen
    s_add_u32 s15, s14, 203456
    buffer_load_ushort v71, v4, s[28:31], s15 offen
    buffer_load_ushort v23, v4, s[32:35], s15 offen
    s_waitcnt vmcnt(40)
    s_add_u32 s15, s14, 295936
    buffer_load_ushort v72, v4, s[28:31], s15 offen
    buffer_load_ushort v24, v4, s[32:35], s15 offen
    s_add_u32 s15, s14, 314432
    buffer_load_ushort v73, v4, s[28:31], s15 offen
    buffer_load_ushort v25, v4, s[32:35], s15 offen
    s_add_u32 s15, s14, 332928
    buffer_load_ushort v74, v4, s[28:31], s15 offen
    buffer_load_ushort v26, v4, s[32:35], s15 offen
    s_add_u32 s15, s14, 351424
    buffer_load_ushort v75, v4, s[28:31], s15 offen
    buffer_load_ushort v27, v4, s[32:35], s15 offen
    s_add_u32 s15, s14, 443904
    buffer_load_ushort v76, v4, s[28:31], s15 offen
    buffer_load_ushort v28, v4, s[32:35], s15 offen
    s_add_u32 s15, s14, 462400
    buffer_load_ushort v77, v4, s[28:31], s15 offen
    buffer_load_ushort v29, v4, s[32:35], s15 offen
    s_add_u32 s15, s14, 480896
    buffer_load_ushort v78, v4, s[28:31], s15 offen
    buffer_load_ushort v30, v4, s[32:35], s15 offen
    s_add_u32 s15, s14, 499392
    buffer_load_ushort v79, v4, s[28:31], s15 offen
    buffer_load_ushort v31, v4, s[32:35], s15 offen
    s_waitcnt vmcnt(40)
    s_add_u32 s15, s14, 591872
    buffer_load_ushort v80, v4, s[28:31], s15 offen
    buffer_load_ushort v32, v4, s[32:35], s15 offen
    s_add_u32 s15, s14, 610368
    buffer_load_ushort v81, v4, s[28:31], s15 offen
    buffer_load_ushort v33, v4, s[32:35], s15 offen
    s_add_u32 s15, s14, 628864
    buffer_load_ushort v82, v4, s[28:31], s15 offen
    buffer_load_ushort v34, v4, s[32:35], s15 offen
    s_add_u32 s15, s14, 647360
    buffer_load_ushort v83, v4, s[28:31], s15 offen
    buffer_load_ushort v35, v4, s[32:35], s15 offen
    s_add_u32 s15, s14, 739840
    buffer_load_ushort v84, v4, s[28:31], s15 offen
    buffer_load_ushort v36, v4, s[32:35], s15 offen
    s_add_u32 s15, s14, 758336
    buffer_load_ushort v85, v4, s[28:31], s15 offen
    buffer_load_ushort v37, v4, s[32:35], s15 offen
    s_add_u32 s15, s14, 776832
    buffer_load_ushort v86, v4, s[28:31], s15 offen
    buffer_load_ushort v38, v4, s[32:35], s15 offen
    s_add_u32 s15, s14, 795328
    buffer_load_ushort v87, v4, s[28:31], s15 offen
    buffer_load_ushort v39, v4, s[32:35], s15 offen
    s_waitcnt vmcnt(40)
    s_add_u32 s15, s14, 887808
    buffer_load_ushort v88, v4, s[28:31], s15 offen
    buffer_load_ushort v40, v4, s[32:35], s15 offen
    s_add_u32 s15, s14, 906304
    buffer_load_ushort v89, v4, s[28:31], s15 offen
    buffer_load_ushort v41, v4, s[32:35], s15 offen
    s_add_u32 s15, s14, 924800
    buffer_load_ushort v90, v4, s[28:31], s15 offen
    buffer_load_ushort v42, v4, s[32:35], s15 offen
    s_add_u32 s15, s14, 943296
    buffer_load_ushort v91, v4, s[28:31], s15 offen
    buffer_load_ushort v43, v4, s[32:35], s15 offen
    s_add_u32 s15, s14, 1035776
    buffer_load_ushort v92, v4, s[28:31], s15 offen
    buffer_load_ushort v44, v4, s[32:35], s15 offen
    s_add_u32 s15, s14, 1054272
    buffer_load_ushort v93, v4, s[28:31], s15 offen
    buffer_load_ushort v45, v4, s[32:35], s15 offen
    s_add_u32 s15, s14, 1072768
    buffer_load_ushort v94, v4, s[28:31], s15 offen
    buffer_load_ushort v46, v4, s[32:35], s15 offen
    s_add_u32 s15, s14, 1091264
    buffer_load_ushort v95, v4, s[28:31], s15 offen
    buffer_load_ushort v47, v4, s[32:35], s15 offen
    s_waitcnt vmcnt(40)
F_now:
    s_mul_i32 s13, s12, 205
    s_lshr_b32 s22, s13, 10
    s_mul_i32 s13, s22, 5
    s_sub_u32 s13, s12, s13
    s_lshl_b32 s13, s13, 2
    s_add_u32 s23, s13, s6
    s_lshl_b32 s13, s23, 4
    v_lshrrev_b32 v4, 1, v3
    v_add_u32 v4, s13, v4
    v_cvt_f32_u32 v4, v4
    v_mul_f32 v11, 0x3ae38e39, v4
    v_and_b32 v4, 1, v3
    v_cvt_f32_u32 v4, v4
    v_mul_f32 v12, 0.25, v4
    v_cvt_f32_u32 v5, v2
    v_mul_f32 v5, 0x41000000, v5
    v_fmac_f32 v12, v5, v11
    v_bfe_u32 v4, v1, 4, 1
    v_lshlrev_b32 v8, 10, v4
    v_lshl_add_u32 v8, v2, 8, v8
    v_and_b32 v4, 15, v1
    v_lshl_add_u32 v8, v4, 4, v8
    v_bfe_u32 v4, v1, 3, 1
    v_lshlrev_b32 v4, 3, v4
    v_and_b32 v5, 3, v1
    v_add_u32 v4, v4, v5
    v_lshlrev_b32 v4, 6, v4
    v_bfe_u32 v5, v1, 2, 1
    v_add_u32 v4, v4, v5
    s_and_b32 s13, s6, 1
    s_lshl_b32 s13, s13, 1
    v_add_u32 v4, s13, v4
    v_mul_u32_u24 v9, 1152, v4
    v_lshrrev_b32 v4, 4, v1
    v_lshl_add_u32 v9, v4, 4, v9
    s_lshr_b32 s13, s6, 1
    s_lshl_b32 s13, s13, 6
    v_add_u32 v9, s13, v9
    v_lshlrev_b32 v10, 12, v3
    v_lshl_add_u32 v10, v2, 4, v10
    s_lshl_b32 s17, s6, 10
    s_mov_b32 s16, s22
    s_cmp_ge_u32 s12, 95
    s_cbranch_scc1 F_a1done
    s_lshr_b32 s13, s16, 5
    s_lshl_b32 s13, s13, 10
    s_bfe_u32 s14, s16, 0x10004
    s_lshl_b32 s14, s14, 8
    s_add_u32 s13, s13, s14
    s_and_b32 s14, s16, 15
    s_lshl_b32 s14, s14, 2
    s_add_u32 s13, s13, s14
    s_mul_i32 s18, s13, 1152
    s_cmp_ge_u32 s16, 64
    s_cselect_b32 s18, 2130706432, s18
    s_add_u32 m0, s17, 0
    s_nop 0
    buffer_load_dwordx4 v9, s[24:27], s18 offen offset:0 lds
    s_add_u32 m0, s17, 3968
    s_nop 0
    buffer_load_dwordx4 v9, s[24:27], s18 offen offset:128 lds
    s_add_u32 m0, s17, 7936
    s_nop 0
    buffer_load_dwordx4 v9, s[24:27], s18 offen offset:256 lds
    s_add_u32 m0, s17, 11904
    s_nop 0
    buffer_load_dwordx4 v9, s[24:27], s18 offen offset:384 lds
    s_add_u32 m0, s17, 15872
    s_nop 0
    buffer_load_dwordx4 v9, s[24:27], s18 offen offset:512 lds
    s_add_u32 m0, s17, 19840
    s_nop 0
    buffer_load_dwordx4 v9, s[24:27], s18 offen offset:640 lds
    s_add_u32 m0, s17, 23808
    s_nop 0
    buffer_load_dwordx4 v9, s[24:27], s18 offen offset:768 lds
    s_add_u32 m0, s17, 27776
    s_nop 0
    buffer_load_dwordx4 v9, s[24:27], s18 offen offset:896 lds
    s_add_u32 m0, s17, 31744
    s_nop 0
    buffer_load_dwordx4 v9, s[24:27], s18 offen offset:1024 lds
    v_fmamk_f32 v4, v11, 0x00000000, v12
    v_fmamk_f32 v5, v11, 0x3f800000, v12
    v_fract_f32 v4, v4
    v_fract_f32 v5, v5
    v_cos_f32 v4, v4
    v_cos_f32 v5, v5
    s_nop 0
    v_cvt_pk_bf16_f32 v100, v4, v5
    v_fmamk_f32 v4, v11, 0x40000000, v12
    v_fmamk_f32 v5, v11, 0x40400000, v12
    v_fract_f32 v4, v4
    v_fract_f32 v5, v5
    v_cos_f32 v4, v4
    v_cos_f32 v5, v5
    s_nop 0
    v_cvt_pk_bf16_f32 v101, v4, v5
    v_fmamk_f32 v4, v11, 0x40800000, v12
    v_fmamk_f32 v5, v11, 0x40a00000, v12
    v_fract_f32 v4, v4
    v_fract_f32 v5, v5
    v_cos_f32 v4, v4
    v_cos_f32 v5, v5
    s_nop 0
    v_cvt_pk_bf16_f32 v102, v4, v5
    v_fmamk_f32 v4, v11, 0x40c00000, v12
    v_fmamk_f32 v5, v11, 0x40e00000, v12
    v_fract_f32 v4, v4
    v_fract_f32 v5, v5
    v_cos_f32 v4, v4
    v_cos_f32 v5, v5
    s_nop 0
    v_cvt_pk_bf16_f32 v103, v4, v5
    v_fmamk_f32 v4, v11, 0x41800000, v12
    v_fmamk_f32 v5, v11, 0x41880000, v12
    v_fract_f32 v4, v4
    v_fract_f32 v5, v5
    v_cos_f32 v4, v4
    v_cos_f32 v5, v5
    s_nop 0
    v_cvt_pk_bf16_f32 v104, v4, v5
    v_fmamk_f32 v4, v11, 0x41900000, v12
    v_fmamk_f32 v5, v11, 0x41980000, v12
    v_fract_f32 v4, v4
    v_fract_f32 v5, v5
    v_cos_f32 v4, v4
    v_cos_f32 v5, v5
    s_nop 0
    v_cvt_pk_bf16_f32 v105, v4, v5
    v_fmamk_f32 v4, v11, 0x41a00000, v12
    v_fmamk_f32 v5, v11, 0x41a80000, v12
    v_fract_f32 v4, v4
    v_fract_f32 v5, v5
    v_cos_f32 v4, v4
    v_cos_f32 v5, v5
    s_nop 0
    v_cvt_pk_bf16_f32 v106, v4, v5
    v_fmamk_f32 v4, v11, 0x41b00000, v12
    v_fmamk_f32 v5, v11, 0x41b80000, v12
    v_fract_f32 v4, v4
    v_fract_f32 v5, v5
    v_cos_f32 v4, v4
    v_cos_f32 v5, v5
    s_nop 0
    v_cvt_pk_bf16_f32 v107, v4, v5
    v_fmamk_f32 v4, v11, 0x42000000, v12
    v_fmamk_f32 v5, v11, 0x42040000, v12
    v_fract_f32 v4, v4
    v_fract_f32 v5, v5
    v_cos_f32 v4, v4
    v_cos_f32 v5, v5
    s_nop 0
    v_cvt_pk_bf16_f32 v108, v4, v5
    v_fmamk_f32 v4, v11, 0x42080000, v12
    v_fmamk_f32 v5, v11, 0x420c0000, v12
    v_fract_f32 v4, v4
    v_fract_f32 v5, v5
    v_cos_f32 v4, v4
    v_cos_f32 v5, v5
    s_nop 0
    v_cvt_pk_bf16_f32 v109, v4, v5
    v_fmamk_f32 v4, v11, 0x42100000, v12
    v_fmamk_f32 v5, v11, 0x42140000, v12
    v_fract_f32 v4, v4
    v_fract_f32 v5, v5
    v_cos_f32 v4, v4
    v_cos_f32 v5, v5
    s_nop 0
    v_cvt_pk_bf16_f32 v110, v4, v5
    v_fmamk_f32 v4, v11, 0x42180000, v12
    v_fmamk_f32 v5, v11, 0x421c0000, v12
    v_fract_f32 v4, v4
    v_fract_f32 v5, v5
    v_cos_f32 v4, v4
    v_cos_f32 v5, v5
    s_nop 0
    v_cvt_pk_bf16_f32 v111, v4, v5
    v_fmamk_f32 v4, v11, 0x42400000, v12
    v_fmamk_f32 v5, v11, 0x42440000, v12
    v_fract_f32 v4, v4
    v_fract_f32 v5, v5
    v_cos_f32 v4, v4
    v_cos_f32 v5, v5
    s_nop 0
    v_cvt_pk_bf16_f32 v112, v4, v5
    v_fmamk_f32 v4, v11, 0x42480000, v12
    v_fmamk_f32 v5, v11, 0x424c0000, v12
    v_fract_f32 v4, v4
    v_fract_f32 v5, v5
    v_cos_f32 v4, v4
    v_cos_f32 v5, v5
    s_nop 0
    v_cvt_pk_bf16_f32 v113, v4, v5
    v_fmamk_f32 v4, v11, 0x42500000, v12
    v_fmamk_f32 v5, v11, 0x42540000, v12
    v_fract_f32 v4, v4
    v_fract_f32 v5, v5
    v_cos_f32 v4, v4
    v_cos_f32 v5, v5
    s_nop 0
    v_cvt_pk_bf16_f32 v114, v4, v5
    v_fmamk_f32 v4, v11, 0x42580000, v12
    v_fmamk_f32 v5, v11, 0x425c0000, v12
    v_fract_f32 v4, v4
    v_fract_f32 v5, v5
    v_cos_f32 v4, v4
    v_cos_f32 v5, v5
    s_nop 0
    v_cvt_pk_bf16_f32 v115, v4, v5
    v_fmamk_f32 v4, v11, 0x42800000, v12
    v_fmamk_f32 v5, v11, 0x42820000, v12
    v_fract_f32 v4, v4
    v_fract_f32 v5, v5
    v_cos_f32 v4, v4
    v_cos_f32 v5, v5
    s_nop 0
    v_cvt_pk_bf16_f32 v116, v4, v5
    v_fmamk_f32 v4, v11, 0x42840000, v12
    v_fmamk_f32 v5, v11, 0x42860000, v12
    v_fract_f32 v4, v4
    v_fract_f32 v5, v5
    v_cos_f32 v4, v4
    v_cos_f32 v5, v5
    s_nop 0
    v_cvt_pk_bf16_f32 v117, v4, v5
    v_fmamk_f32 v4, v11, 0x42880000, v12
    v_fmamk_f32 v5, v11, 0x428a0000, v12
    v_fract_f32 v4, v4
    v_fract_f32 v5, v5
    v_cos_f32 v4, v4
    v_cos_f32 v5, v5
    s_nop 0
    v_cvt_pk_bf16_f32 v118, v4, v5
    v_fmamk_f32 v4, v11, 0x428c0000, v12
    v_fmamk_f32 v5, v11, 0x428e0000, v12
    v_fract_f32 v4, v4
    v_fract_f32 v5, v5
    v_cos_f32 v4, v4
    v_cos_f32 v5, v5
    s_nop 0
    v_cvt_pk_bf16_f32 v119, v4, v5
    v_fmamk_f32 v4, v11, 0x42a00000, v12
    v_fmamk_f32 v5, v11, 0x42a20000, v12
    v_fract_f32 v4, v4
    v_fract_f32 v5, v5
    v_cos_f32 v4, v4
    v_cos_f32 v5, v5
    s_nop 0
    v_cvt_pk_bf16_f32 v120, v4, v5
    v_fmamk_f32 v4, v11, 0x42a40000, v12
    v_fmamk_f32 v5, v11, 0x42a60000, v12
    v_fract_f32 v4, v4
    v_fract_f32 v5, v5
    v_cos_f32 v4, v4
    v_cos_f32 v5, v5
    s_nop 0
    v_cvt_pk_bf16_f32 v121, v4, v5
    v_fmamk_f32 v4, v11, 0x42a80000, v12
    v_fmamk_f32 v5, v11, 0x42aa0000, v12
    v_fract_f32 v4, v4
    v_fract_f32 v5, v5
    v_cos_f32 v4, v4
    v_cos_f32 v5, v5
    s_nop 0
    v_cvt_pk_bf16_f32 v122, v4, v5
    v_fmamk_f32 v4, v11, 0x42ac0000, v12
    v_fmamk_f32 v5, v11, 0x42ae0000, v12
    v_fract_f32 v4, v4
    v_fract_f32 v5, v5
    v_cos_f32 v4, v4
    v_cos_f32 v5, v5
    s_nop 0
    v_cvt_pk_bf16_f32 v123, v4, v5
    v_fmamk_f32 v4, v11, 0x42c00000, v12
    v_fmamk_f32 v5, v11, 0x42c20000, v12
    v_fract_f32 v4, v4
    v_fract_f32 v5, v5
    v_cos_f32 v4, v4
    v_cos_f32 v5, v5
    s_nop 0
    v_cvt_pk_bf16_f32 v124, v4, v5
    v_fmamk_f32 v4, v11, 0x42c40000, v12
    v_fmamk_f32 v5, v11, 0x42c60000, v12
    v_fract_f32 v4, v4
    v_fract_f32 v5, v5
    v_cos_f32 v4, v4
    v_cos_f32 v5, v5
    s_nop 0
    v_cvt_pk_bf16_f32 v125, v4, v5
    v_fmamk_f32 v4, v11, 0x42c80000, v12
    v_fmamk_f32 v5, v11, 0x42ca0000, v12
    v_fract_f32 v4, v4
    v_fract_f32 v5, v5
    v_cos_f32 v4, v4
    v_cos_f32 v5, v5
    s_nop 0
    v_cvt_pk_bf16_f32 v126, v4, v5
    v_fmamk_f32 v4, v11, 0x42cc0000, v12
    v_fmamk_f32 v5, v11, 0x42ce0000, v12
    v_fract_f32 v4, v4
    v_fract_f32 v5, v5
    v_cos_f32 v4, v4
    v_cos_f32 v5, v5
    s_nop 0
    v_cvt_pk_bf16_f32 v127, v4, v5
    v_fmamk_f32 v4, v11, 0x42e00000, v12
    v_fmamk_f32 v5, v11, 0x42e20000, v12
    v_fract_f32 v4, v4
    v_fract_f32 v5, v5
    v_cos_f32 v4, v4
    v_cos_f32 v5, v5
    s_nop 0
    v_cvt_pk_bf16_f32 v128, v4, v5
    v_fmamk_f32 v4, v11, 0x42e40000, v12
    v_fmamk_f32 v5, v11, 0x42e60000, v12
    v_fract_f32 v4, v4
    v_fract_f32 v5, v5
    v_cos_f32 v4, v4
    v_cos_f32 v5, v5
    s_nop 0
    v_cvt_pk_bf16_f32 v129, v4, v5
    v_fmamk_f32 v4, v11, 0x42e80000, v12
    v_fmamk_f32 v5, v11, 0x42ea0000, v12
    v_fract_f32 v4, v4
    v_fract_f32 v5, v5
    v_cos_f32 v4, v4
    v_cos_f32 v5, v5
    s_nop 0
    v_cvt_pk_bf16_f32 v130, v4, v5
    v_fmamk_f32 v4, v11, 0x42ec0000, v12
    v_fmamk_f32 v5, v11, 0x42ee0000, v12
    v_fract_f32 v4, v4
    v_fract_f32 v5, v5
    v_cos_f32 v4, v4
    v_cos_f32 v5, v5
    s_nop 0
    v_cvt_pk_bf16_f32 v131, v4, v5
    v_fmamk_f32 v4, v11, 0x43000000, v12
    v_fmamk_f32 v5, v11, 0x43010000, v12
    v_fract_f32 v4, v4
    v_fract_f32 v5, v5
    v_cos_f32 v4, v4
    v_cos_f32 v5, v5
    s_nop 0
    v_cvt_pk_bf16_f32 v132, v4, v5
    v_fmamk_f32 v4, v11, 0x43020000, v12
    v_fmamk_f32 v5, v11, 0x43030000, v12
    v_fract_f32 v4, v4
    v_fract_f32 v5, v5
    v_cos_f32 v4, v4
    v_cos_f32 v5, v5
    s_nop 0
    v_cvt_pk_bf16_f32 v133, v4, v5
    v_fmamk_f32 v4, v11, 0x43040000, v12
    v_fmamk_f32 v5, v11, 0x43050000, v12
    v_fract_f32 v4, v4
    v_fract_f32 v5, v5
    v_cos_f32 v4, v4
    v_cos_f32 v5, v5
    s_nop 0
    v_cvt_pk_bf16_f32 v134, v4, v5
    v_fmamk_f32 v4, v11, 0x43060000, v12
    v_fmamk_f32 v5, v11, 0x43070000, v12
    v_fract_f32 v4, v4
    v_fract_f32 v5, v5
    v_cos_f32 v4, v4
    v_cos_f32 v5, v5
    s_nop 0
    v_cvt_pk_bf16_f32 v135, v4, v5
    v_fmamk_f32 v4, v11, 0x43100000, v12
    v_fmamk_f32 v5, v11, 0x43110000, v12
    v_fract_f32 v4, v4
    v_fract_f32 v5, v5
    v_cos_f32 v4, v4
    v_cos_f32 v5, v5
    s_nop 0
    v_cvt_pk_bf16_f32 v136, v4, v5
    v_fmamk_f32 v4, v11, 0x43120000, v12
    v_fmamk_f32 v5, v11, 0x43130000, v12
    v_fract_f32 v4, v4
    v_fract_f32 v5, v5
    v_cos_f32 v4, v4
    v_cos_f32 v5, v5
    s_nop 0
    v_cvt_pk_bf16_f32 v137, v4, v5
    v_fmamk_f32 v4, v11, 0x43140000, v12
    v_fmamk_f32 v5, v11, 0x43150000, v12
    v_fract_f32 v4, v4
    v_fract_f32 v5, v5
    v_cos_f32 v4, v4
    v_cos_f32 v5, v5
    s_nop 0
    v_cvt_pk_bf16_f32 v138, v4, v5
    v_fmamk_f32 v4, v11, 0x43160000, v12
    v_fmamk_f32 v5, v11, 0x43170000, v12
    v_fract_f32 v4, v4
    v_fract_f32 v5, v5
    v_cos_f32 v4, v4
    v_cos_f32 v5, v5
    s_nop 0
    v_cvt_pk_bf16_f32 v139, v4, v5
    v_fmamk_f32 v4, v11, 0x43200000, v12
    v_fmamk_f32 v5, v11, 0x43210000, v12
    v_fract_f32 v4, v4
    v_fract_f32 v5, v5
    v_cos_f32 v4, v4
    v_cos_f32 v5, v5
    s_nop 0
    v_cvt_pk_bf16_f32 v140, v4, v5
    v_fmamk_f32 v4, v11, 0x43220000, v12
    v_fmamk_f32 v5, v11, 0x43230000, v12
    v_fract_f32 v4, v4
    v_fract_f32 v5, v5
    v_cos_f32 v4, v4
    v_cos_f32 v5, v5
    s_nop 0
    v_cvt_pk_bf16_f32 v141, v4, v5
    v_fmamk_f32 v4, v11, 0x43240000, v12
    v_fmamk_f32 v5, v11, 0x43250000, v12
    v_fract_f32 v4, v4
    v_fract_f32 v5, v5
    v_cos_f32 v4, v4
    v_cos_f32 v5, v5
    s_nop 0
    v_cvt_pk_bf16_f32 v142, v4, v5
    v_fmamk_f32 v4, v11, 0x43260000, v12
    v_fmamk_f32 v5, v11, 0x43270000, v12
    v_fract_f32 v4, v4
    v_fract_f32 v5, v5
    v_cos_f32 v4, v4
    v_cos_f32 v5, v5
    s_nop 0
    v_cvt_pk_bf16_f32 v143, v4, v5
    v_fmamk_f32 v4, v11, 0x43300000, v12
    v_fmamk_f32 v5, v11, 0x43310000, v12
    v_fract_f32 v4, v4
    v_fract_f32 v5, v5
    v_cos_f32 v4, v4
    v_cos_f32 v5, v5
    s_nop 0
    v_cvt_pk_bf16_f32 v144, v4, v5
    v_fmamk_f32 v4, v11, 0x43320000, v12
    v_fmamk_f32 v5, v11, 0x43330000, v12
    v_fract_f32 v4, v4
    v_fract_f32 v5, v5
    v_cos_f32 v4, v4
    v_cos_f32 v5, v5
    s_nop 0
    v_cvt_pk_bf16_f32 v145, v4, v5
    v_fmamk_f32 v4, v11, 0x43340000, v12
    v_fmamk_f32 v5, v11, 0x43350000, v12
    v_fract_f32 v4, v4
    v_fract_f32 v5, v5
    v_cos_f32 v4, v4
    v_cos_f32 v5, v5
    s_nop 0
    v_cvt_pk_bf16_f32 v146, v4, v5
    v_fmamk_f32 v4, v11, 0x43360000, v12
    v_fmamk_f32 v5, v11, 0x43370000, v12
    v_fract_f32 v4, v4
    v_fract_f32 v5, v5
    v_cos_f32 v4, v4
    v_cos_f32 v5, v5
    s_nop 0
    v_cvt_pk_bf16_f32 v147, v4, v5
    v_fmamk_f32 v4, v11, 0x43400000, v12
    v_fmamk_f32 v5, v11, 0x43410000, v12
    v_fract_f32 v4, v4
    v_fract_f32 v5, v5
    v_cos_f32 v4, v4
    v_cos_f32 v5, v5
    s_nop 0
    v_cvt_pk_bf16_f32 v148, v4, v5
    v_fmamk_f32 v4, v11, 0x43420000, v12
    v_fmamk_f32 v5, v11, 0x43430000, v12
    v_fract_f32 v4, v4
    v_fract_f32 v5, v5
    v_cos_f32 v4, v4
    v_cos_f32 v5, v5
    s_nop 0
    v_cvt_pk_bf16_f32 v149, v4, v5
    v_fmamk_f32 v4, v11, 0x43440000, v12
    v_fmamk_f32 v5, v11, 0x43450000, v12
    v_fract_f32 v4, v4
    v_fract_f32 v5, v5
    v_cos_f32 v4, v4
    v_cos_f32 v5, v5
    s_nop 0
    v_cvt_pk_bf16_f32 v150, v4, v5
    v_fmamk_f32 v4, v11, 0x43460000, v12
    v_fmamk_f32 v5, v11, 0x43470000, v12
    v_fract_f32 v4, v4
    v_fract_f32 v5, v5
    v_cos_f32 v4, v4
    v_cos_f32 v5, v5
    s_nop 0
    v_cvt_pk_bf16_f32 v151, v4, v5
    v_fmamk_f32 v4, v11, 0x43500000, v12
    v_fmamk_f32 v5, v11, 0x43510000, v12
    v_fract_f32 v4, v4
    v_fract_f32 v5, v5
    v_cos_f32 v4, v4
    v_cos_f32 v5, v5
    s_nop 0
    v_cvt_pk_bf16_f32 v152, v4, v5
    v_fmamk_f32 v4, v11, 0x43520000, v12
    v_fmamk_f32 v5, v11, 0x43530000, v12
    v_fract_f32 v4, v4
    v_fract_f32 v5, v5
    v_cos_f32 v4, v4
    v_cos_f32 v5, v5
    s_nop 0
    v_cvt_pk_bf16_f32 v153, v4, v5
    v_fmamk_f32 v4, v11, 0x43540000, v12
    v_fmamk_f32 v5, v11, 0x43550000, v12
    v_fract_f32 v4, v4
    v_fract_f32 v5, v5
    v_cos_f32 v4, v4
    v_cos_f32 v5, v5
    s_nop 0
    v_cvt_pk_bf16_f32 v154, v4, v5
    v_fmamk_f32 v4, v11, 0x43560000, v12
    v_fmamk_f32 v5, v11, 0x43570000, v12
    v_fract_f32 v4, v4
    v_fract_f32 v5, v5
    v_cos_f32 v4, v4
    v_cos_f32 v5, v5
    s_nop 0
    v_cvt_pk_bf16_f32 v155, v4, v5
    v_fmamk_f32 v4, v11, 0x43600000, v12
    v_fmamk_f32 v5, v11, 0x43610000, v12
    v_fract_f32 v4, v4
    v_fract_f32 v5, v5
    v_cos_f32 v4, v4
    v_cos_f32 v5, v5
    s_nop 0
    v_cvt_pk_bf16_f32 v156, v4, v5
    v_fmamk_f32 v4, v11, 0x43620000, v12
    v_fmamk_f32 v5, v11, 0x43630000, v12
    v_fract_f32 v4, v4
    v_fract_f32 v5, v5
    v_cos_f32 v4, v4
    v_cos_f32 v5, v5
    s_nop 0
    v_cvt_pk_bf16_f32 v157, v4, v5
    v_fmamk_f32 v4, v11, 0x43640000, v12
    v_fmamk_f32 v5, v11, 0x43650000, v12
    v_fract_f32 v4, v4
    v_fract_f32 v5, v5
    v_cos_f32 v4, v4
    v_cos_f32 v5, v5
    s_nop 0
    v_cvt_pk_bf16_f32 v158, v4, v5
    v_fmamk_f32 v4, v11, 0x43660000, v12
    v_fmamk_f32 v5, v11, 0x43670000, v12
    v_fract_f32 v4, v4
    v_fract_f32 v5, v5
    v_cos_f32 v4, v4
    v_cos_f32 v5, v5
    s_nop 0
    v_cvt_pk_bf16_f32 v159, v4, v5
    v_fmamk_f32 v4, v11, 0x43700000, v12
    v_fmamk_f32 v5, v11, 0x43710000, v12
    v_fract_f32 v4, v4
    v_fract_f32 v5, v5
    v_cos_f32 v4, v4
    v_cos_f32 v5, v5
    s_nop 0
    v_cvt_pk_bf16_f32 v160, v4, v5
    v_fmamk_f32 v4, v11, 0x43720000, v12
    v_fmamk_f32 v5, v11, 0x43730000, v12
    v_fract_f32 v4, v4
    v_fract_f32 v5, v5
    v_cos_f32 v4, v4
    v_cos_f32 v5, v5
    s_nop 0
    v_cvt_pk_bf16_f32 v161, v4, v5
    v_fmamk_f32 v4, v11, 0x43740000, v12
    v_fmamk_f32 v5, v11, 0x43750000, v12
    v_fract_f32 v4, v4
    v_fract_f32 v5, v5
    v_cos_f32 v4, v4
    v_cos_f32 v5, v5
    s_nop 0
    v_cvt_pk_bf16_f32 v162, v4, v5
    v_fmamk_f32 v4, v11, 0x43760000, v12
    v_fmamk_f32 v5, v11, 0x43770000, v12
    v_fract_f32 v4, v4
    v_fract_f32 v5, v5
    v_cos_f32 v4, v4
    v_cos_f32 v5, v5
    s_nop 0
    v_cvt_pk_bf16_f32 v163, v4, v5
    v_fmamk_f32 v4, v11, 0x43800000, v12
    v_fmamk_f32 v5, v11, 0x43808000, v12
    v_fract_f32 v4, v4
    v_fract_f32 v5, v5
    v_cos_f32 v4, v4
    v_cos_f32 v5, v5
    s_nop 0
    v_cvt_pk_bf16_f32 v164, v4, v5
    v_fmamk_f32 v4, v11, 0x43810000, v12
    v_fmamk_f32 v5, v11, 0x43818000, v12
    v_fract_f32 v4, v4
    v_fract_f32 v5, v5
    v_cos_f32 v4, v4
    v_cos_f32 v5, v5
    s_nop 0
    v_cvt_pk_bf16_f32 v165, v4, v5
    v_fmamk_f32 v4, v11, 0x43820000, v12
    v_fmamk_f32 v5, v11, 0x43828000, v12
    v_fract_f32 v4, v4
    v_fract_f32 v5, v5
    v_cos_f32 v4, v4
    v_cos_f32 v5, v5
    s_nop 0
    v_cvt_pk_bf16_f32 v166, v4, v5
    v_fmamk_f32 v4, v11, 0x43830000, v12
    v_fmamk_f32 v5, v11, 0x43838000, v12
    v_fract_f32 v4, v4
    v_fract_f32 v5, v5
    v_cos_f32 v4, v4
    v_cos_f32 v5, v5
    s_nop 0
    v_cvt_pk_bf16_f32 v167, v4, v5
    v_fmamk_f32 v4, v11, 0x43880000, v12
    v_fmamk_f32 v5, v11, 0x43888000, v12
    v_fract_f32 v4, v4
    v_fract_f32 v5, v5
    v_cos_f32 v4, v4
    v_cos_f32 v5, v5
    s_nop 0
    v_cvt_pk_bf16_f32 v168, v4, v5
    v_fmamk_f32 v4, v11, 0x43890000, v12
    v_fmamk_f32 v5, v11, 0x43898000, v12
    v_fract_f32 v4, v4
    v_fract_f32 v5, v5
    v_cos_f32 v4, v4
    v_cos_f32 v5, v5
    s_nop 0
    v_cvt_pk_bf16_f32 v169, v4, v5
    v_fmamk_f32 v4, v11, 0x438a0000, v12
    v_fmamk_f32 v5, v11, 0x438a8000, v12
    v_fract_f32 v4, v4
    v_fract_f32 v5, v5
    v_cos_f32 v4, v4
    v_cos_f32 v5, v5
    s_nop 0
    v_cvt_pk_bf16_f32 v170, v4, v5
    v_fmamk_f32 v4, v11, 0x438b0000, v12
    v_fmamk_f32 v5, v11, 0x438b8000, v12
    v_fract_f32 v4, v4
    v_fract_f32 v5, v5
    v_cos_f32 v4, v4
    v_cos_f32 v5, v5
    s_nop 0
    v_cvt_pk_bf16_f32 v171, v4, v5
    v_fmamk_f32 v4, v11, 0x43900000, v12
    v_fmamk_f32 v5, v11, 0x43908000, v12
    v_fract_f32 v4, v4
    v_fract_f32 v5, v5
    v_cos_f32 v4, v4
    v_cos_f32 v5, v5
    s_nop 0
    v_cvt_pk_bf16_f32 v172, v4, v5
    v_fmamk_f32 v4, v11, 0x43910000, v12
    v_fmamk_f32 v5, v11, 0x43918000, v12
    v_fract_f32 v4, v4
    v_fract_f32 v5, v5
    v_cos_f32 v4, v4
    v_cos_f32 v5, v5
    s_nop 0
    v_cvt_pk_bf16_f32 v173, v4, v5
    v_fmamk_f32 v4, v11, 0x43920000, v12
    v_fmamk_f32 v5, v11, 0x43928000, v12
    v_fract_f32 v4, v4
    v_fract_f32 v5, v5
    v_cos_f32 v4, v4
    v_cos_f32 v5, v5
    s_nop 0
    v_cvt_pk_bf16_f32 v174, v4, v5
    v_fmamk_f32 v4, v11, 0x43930000, v12
    v_fmamk_f32 v5, v11, 0x43938000, v12
    v_fract_f32 v4, v4
    v_fract_f32 v5, v5
    v_cos_f32 v4, v4
    v_cos_f32 v5, v5
    s_nop 0
    v_cvt_pk_bf16_f32 v175, v4, v5
    v_fmamk_f32 v4, v11, 0x43980000, v12
    v_fmamk_f32 v5, v11, 0x43988000, v12
    v_fract_f32 v4, v4
    v_fract_f32 v5, v5
    v_cos_f32 v4, v4
    v_cos_f32 v5, v5
    s_nop 0
    v_cvt_pk_bf16_f32 v176, v4, v5
    v_fmamk_f32 v4, v11, 0x43990000, v12
    v_fmamk_f32 v5, v11, 0x43998000, v12
    v_fract_f32 v4, v4
    v_fract_f32 v5, v5
    v_cos_f32 v4, v4
    v_cos_f32 v5, v5
    s_nop 0
    v_cvt_pk_bf16_f32 v177, v4, v5
    v_fmamk_f32 v4, v11, 0x439a0000, v12
    v_fmamk_f32 v5, v11, 0x439a8000, v12
    v_fract_f32 v4, v4
    v_fract_f32 v5, v5
    v_cos_f32 v4, v4
    v_cos_f32 v5, v5
    s_nop 0
    v_cvt_pk_bf16_f32 v178, v4, v5
    v_fmamk_f32 v4, v11, 0x439b0000, v12
    v_fmamk_f32 v5, v11, 0x439b8000, v12
    v_fract_f32 v4, v4
    v_fract_f32 v5, v5
    v_cos_f32 v4, v4
    v_cos_f32 v5, v5
    s_nop 0
    v_cvt_pk_bf16_f32 v179, v4, v5
    v_fmamk_f32 v4, v11, 0x43a00000, v12
    v_fmamk_f32 v5, v11, 0x43a08000, v12
    v_fract_f32 v4, v4
    v_fract_f32 v5, v5
    v_cos_f32 v4, v4
    v_cos_f32 v5, v5
    s_nop 0
    v_cvt_pk_bf16_f32 v180, v4, v5
    v_fmamk_f32 v4, v11, 0x43a10000, v12
    v_fmamk_f32 v5, v11, 0x43a18000, v12
    v_fract_f32 v4, v4
    v_fract_f32 v5, v5
    v_cos_f32 v4, v4
    v_cos_f32 v5, v5
    s_nop 0
    v_cvt_pk_bf16_f32 v181, v4, v5
    v_fmamk_f32 v4, v11, 0x43a20000, v12
    v_fmamk_f32 v5, v11, 0x43a28000, v12
    v_fract_f32 v4, v4
    v_fract_f32 v5, v5
    v_cos_f32 v4, v4
    v_cos_f32 v5, v5
    s_nop 0
    v_cvt_pk_bf16_f32 v182, v4, v5
    v_fmamk_f32 v4, v11, 0x43a30000, v12
    v_fmamk_f32 v5, v11, 0x43a38000, v12
    v_fract_f32 v4, v4
    v_fract_f32 v5, v5
    v_cos_f32 v4, v4
    v_cos_f32 v5, v5
    s_nop 0
    v_cvt_pk_bf16_f32 v183, v4, v5
    v_fmamk_f32 v4, v11, 0x43a80000, v12
    v_fmamk_f32 v5, v11, 0x43a88000, v12
    v_fract_f32 v4, v4
    v_fract_f32 v5, v5
    v_cos_f32 v4, v4
    v_cos_f32 v5, v5
    s_nop 0
    v_cvt_pk_bf16_f32 v184, v4, v5
    v_fmamk_f32 v4, v11, 0x43a90000, v12
    v_fmamk_f32 v5, v11, 0x43a98000, v12
    v_fract_f32 v4, v4
    v_fract_f32 v5, v5
    v_cos_f32 v4, v4
    v_cos_f32 v5, v5
    s_nop 0
    v_cvt_pk_bf16_f32 v185, v4, v5
    v_fmamk_f32 v4, v11, 0x43aa0000, v12
    v_fmamk_f32 v5, v11, 0x43aa8000, v12
    v_fract_f32 v4, v4
    v_fract_f32 v5, v5
    v_cos_f32 v4, v4
    v_cos_f32 v5, v5
    s_nop 0
    v_cvt_pk_bf16_f32 v186, v4, v5
    v_fmamk_f32 v4, v11, 0x43ab0000, v12
    v_fmamk_f32 v5, v11, 0x43ab8000, v12
    v_fract_f32 v4, v4
    v_fract_f32 v5, v5
    v_cos_f32 v4, v4
    v_cos_f32 v5, v5
    s_nop 0
    v_cvt_pk_bf16_f32 v187, v4, v5
    v_fmamk_f32 v4, v11, 0x43b00000, v12
    v_fmamk_f32 v5, v11, 0x43b08000, v12
    v_fract_f32 v4, v4
    v_fract_f32 v5, v5
    v_cos_f32 v4, v4
    v_cos_f32 v5, v5
    s_nop 0
    v_cvt_pk_bf16_f32 v188, v4, v5
    v_fmamk_f32 v4, v11, 0x43b10000, v12
    v_fmamk_f32 v5, v11, 0x43b18000, v12
    v_fract_f32 v4, v4
    v_fract_f32 v5, v5
    v_cos_f32 v4, v4
    v_cos_f32 v5, v5
    s_nop 0
    v_cvt_pk_bf16_f32 v189, v4, v5
    v_fmamk_f32 v4, v11, 0x43b20000, v12
    v_fmamk_f32 v5, v11, 0x43b28000, v12
    v_fract_f32 v4, v4
    v_fract_f32 v5, v5
    v_cos_f32 v4, v4
    v_cos_f32 v5, v5
    s_nop 0
    v_cvt_pk_bf16_f32 v190, v4, v5
    v_fmamk_f32 v4, v11, 0x43b30000, v12
    v_fmamk_f32 v5, v11, 0x43b38000, v12
    v_fract_f32 v4, v4
    v_fract_f32 v5, v5
    v_cos_f32 v4, v4
    v_cos_f32 v5, v5
    s_nop 0
    v_cvt_pk_bf16_f32 v191, v4, v5
    v_fmamk_f32 v4, v11, 0x43b80000, v12
    v_fmamk_f32 v5, v11, 0x43b88000, v12
    v_fract_f32 v4, v4
    v_fract_f32 v5, v5
    v_cos_f32 v4, v4
    v_cos_f32 v5, v5
    s_nop 0
    v_cvt_pk_bf16_f32 v192, v4, v5
    v_fmamk_f32 v4, v11, 0x43b90000, v12
    v_fmamk_f32 v5, v11, 0x43b98000, v12
    v_fract_f32 v4, v4
    v_fract_f32 v5, v5
    v_cos_f32 v4, v4
    v_cos_f32 v5, v5
    s_nop 0
    v_cvt_pk_bf16_f32 v193, v4, v5
    v_fmamk_f32 v4, v11, 0x43ba0000, v12
    v_fmamk_f32 v5, v11, 0x43ba8000, v12
    v_fract_f32 v4, v4
    v_fract_f32 v5, v5
    v_cos_f32 v4, v4
    v_cos_f32 v5, v5
    s_nop 0
    v_cvt_pk_bf16_f32 v194, v4, v5
    v_fmamk_f32 v4, v11, 0x43bb0000, v12
    v_fmamk_f32 v5, v11, 0x43bb8000, v12
    v_fract_f32 v4, v4
    v_fract_f32 v5, v5
    v_cos_f32 v4, v4
    v_cos_f32 v5, v5
    s_nop 0
    v_cvt_pk_bf16_f32 v195, v4, v5
    v_fmamk_f32 v4, v11, 0x43c00000, v12
    v_fmamk_f32 v5, v11, 0x43c08000, v12
    v_fract_f32 v4, v4
    v_fract_f32 v5, v5
    v_cos_f32 v4, v4
    v_cos_f32 v5, v5
    s_nop 0
    v_cvt_pk_bf16_f32 v196, v4, v5
    v_fmamk_f32 v4, v11, 0x43c10000, v12
    v_fmamk_f32 v5, v11, 0x43c18000, v12
    v_fract_f32 v4, v4
    v_fract_f32 v5, v5
    v_cos_f32 v4, v4
    v_cos_f32 v5, v5
    s_nop 0
    v_cvt_pk_bf16_f32 v197, v4, v5
    v_fmamk_f32 v4, v11, 0x43c20000, v12
    v_fmamk_f32 v5, v11, 0x43c28000, v12
    v_fract_f32 v4, v4
    v_fract_f32 v5, v5
    v_cos_f32 v4, v4
    v_cos_f32 v5, v5
    s_nop 0
    v_cvt_pk_bf16_f32 v198, v4, v5
    v_fmamk_f32 v4, v11, 0x43c30000, v12
    v_fmamk_f32 v5, v11, 0x43c38000, v12
    v_fract_f32 v4, v4
    v_fract_f32 v5, v5
    v_cos_f32 v4, v4
    v_cos_f32 v5, v5
    s_nop 0
    v_cvt_pk_bf16_f32 v199, v4, v5
    v_fmamk_f32 v4, v11, 0x43c80000, v12
    v_fmamk_f32 v5, v11, 0x43c88000, v12
    v_fract_f32 v4, v4
    v_fract_f32 v5, v5
    v_cos_f32 v4, v4
    v_cos_f32 v5, v5
    s_nop 0
    v_cvt_pk_bf16_f32 v200, v4, v5
    v_fmamk_f32 v4, v11, 0x43c90000, v12
    v_fmamk_f32 v5, v11, 0x43c98000, v12
    v_fract_f32 v4, v4
    v_fract_f32 v5, v5
    v_cos_f32 v4, v4
    v_cos_f32 v5, v5
    s_nop 0
    v_cvt_pk_bf16_f32 v201, v4, v5
    v_fmamk_f32 v4, v11, 0x43ca0000, v12
    v_fmamk_f32 v5, v11, 0x43ca8000, v12
    v_fract_f32 v4, v4
    v_fract_f32 v5, v5
    v_cos_f32 v4, v4
    v_cos_f32 v5, v5
    s_nop 0
    v_cvt_pk_bf16_f32 v202, v4, v5
    v_fmamk_f32 v4, v11, 0x43cb0000, v12
    v_fmamk_f32 v5, v11, 0x43cb8000, v12
    v_fract_f32 v4, v4
    v_fract_f32 v5, v5
    v_cos_f32 v4, v4
    v_cos_f32 v5, v5
    s_nop 0
    v_cvt_pk_bf16_f32 v203, v4, v5
    v_fmamk_f32 v4, v11, 0x43d00000, v12
    v_fmamk_f32 v5, v11, 0x43d08000, v12
    v_fract_f32 v4, v4
    v_fract_f32 v5, v5
    v_cos_f32 v4, v4
    v_cos_f32 v5, v5
    s_nop 0
    v_cvt_pk_bf16_f32 v204, v4, v5
    v_fmamk_f32 v4, v11, 0x43d10000, v12
    v_fmamk_f32 v5, v11, 0x43d18000, v12
    v_fract_f32 v4, v4
    v_fract_f32 v5, v5
    v_cos_f32 v4, v4
    v_cos_f32 v5, v5
    s_nop 0
    v_cvt_pk_bf16_f32 v205, v4, v5
    v_fmamk_f32 v4, v11, 0x43d20000, v12
    v_fmamk_f32 v5, v11, 0x43d28000, v12
    v_fract_f32 v4, v4
    v_fract_f32 v5, v5
    v_cos_f32 v4, v4
    v_cos_f32 v5, v5
    s_nop 0
    v_cvt_pk_bf16_f32 v206, v4, v5
    v_fmamk_f32 v4, v11, 0x43d30000, v12
    v_fmamk_f32 v5, v11, 0x43d38000, v12
    v_fract_f32 v4, v4
    v_fract_f32 v5, v5
    v_cos_f32 v4, v4
    v_cos_f32 v5, v5
    s_nop 0
    v_cvt_pk_bf16_f32 v207, v4, v5
    v_fmamk_f32 v4, v11, 0x43d80000, v12
    v_fmamk_f32 v5, v11, 0x43d88000, v12
    v_fract_f32 v4, v4
    v_fract_f32 v5, v5
    v_cos_f32 v4, v4
    v_cos_f32 v5, v5
    s_nop 0
    v_cvt_pk_bf16_f32 v208, v4, v5
    v_fmamk_f32 v4, v11, 0x43d90000, v12
    v_fmamk_f32 v5, v11, 0x43d98000, v12
    v_fract_f32 v4, v4
    v_fract_f32 v5, v5
    v_cos_f32 v4, v4
    v_cos_f32 v5, v5
    s_nop 0
    v_cvt_pk_bf16_f32 v209, v4, v5
    v_fmamk_f32 v4, v11, 0x43da0000, v12
    v_fmamk_f32 v5, v11, 0x43da8000, v12
    v_fract_f32 v4, v4
    v_fract_f32 v5, v5
    v_cos_f32 v4, v4
    v_cos_f32 v5, v5
    s_nop 0
    v_cvt_pk_bf16_f32 v210, v4, v5
    v_fmamk_f32 v4, v11, 0x43db0000, v12
    v_fmamk_f32 v5, v11, 0x43db8000, v12
    v_fract_f32 v4, v4
    v_fract_f32 v5, v5
    v_cos_f32 v4, v4
    v_cos_f32 v5, v5
    s_nop 0
    v_cvt_pk_bf16_f32 v211, v4, v5
    v_fmamk_f32 v4, v11, 0x43e00000, v12
    v_fmamk_f32 v5, v11, 0x43e08000, v12
    v_fract_f32 v4, v4
    v_fract_f32 v5, v5
    v_cos_f32 v4, v4
    v_cos_f32 v5, v5
    s_nop 0
    v_cvt_pk_bf16_f32 v212, v4, v5
    v_fmamk_f32 v4, v11, 0x43e10000, v12
    v_fmamk_f32 v5, v11, 0x43e18000, v12
    v_fract_f32 v4, v4
    v_fract_f32 v5, v5
    v_cos_f32 v4, v4
    v_cos_f32 v5, v5
    s_nop 0
    v_cvt_pk_bf16_f32 v213, v4, v5
    v_fmamk_f32 v4, v11, 0x43e20000, v12
    v_fmamk_f32 v5, v11, 0x43e28000, v12
    v_fract_f32 v4, v4
    v_fract_f32 v5, v5
    v_cos_f32 v4, v4
    v_cos_f32 v5, v5
    s_nop 0
    v_cvt_pk_bf16_f32 v214, v4, v5
    v_fmamk_f32 v4, v11, 0x43e30000, v12
    v_fmamk_f32 v5, v11, 0x43e38000, v12
    v_fract_f32 v4, v4
    v_fract_f32 v5, v5
    v_cos_f32 v4, v4
    v_cos_f32 v5, v5
    s_nop 0
    v_cvt_pk_bf16_f32 v215, v4, v5
    v_fmamk_f32 v4, v11, 0x43e80000, v12
    v_fmamk_f32 v5, v11, 0x43e88000, v12
    v_fract_f32 v4, v4
    v_fract_f32 v5, v5
    v_cos_f32 v4, v4
    v_cos_f32 v5, v5
    s_nop 0
    v_cvt_pk_bf16_f32 v216, v4, v5
    v_fmamk_f32 v4, v11, 0x43e90000, v12
    v_fmamk_f32 v5, v11, 0x43e98000, v12
    v_fract_f32 v4, v4
    v_fract_f32 v5, v5
    v_cos_f32 v4, v4
    v_cos_f32 v5, v5
    s_nop 0
    v_cvt_pk_bf16_f32 v217, v4, v5
    v_fmamk_f32 v4, v11, 0x43ea0000, v12
    v_fmamk_f32 v5, v11, 0x43ea8000, v12
    v_fract_f32 v4, v4
    v_fract_f32 v5, v5
    v_cos_f32 v4, v4
    v_cos_f32 v5, v5
    s_nop 0
    v_cvt_pk_bf16_f32 v218, v4, v5
    v_fmamk_f32 v4, v11, 0x43eb0000, v12
    v_fmamk_f32 v5, v11, 0x43eb8000, v12
    v_fract_f32 v4, v4
    v_fract_f32 v5, v5
    v_cos_f32 v4, v4
    v_cos_f32 v5, v5
    s_nop 0
    v_cvt_pk_bf16_f32 v219, v4, v5
    v_fmamk_f32 v4, v11, 0x43f00000, v12
    v_fmamk_f32 v5, v11, 0x43f08000, v12
    v_fract_f32 v4, v4
    v_fract_f32 v5, v5
    v_cos_f32 v4, v4
    v_cos_f32 v5, v5
    s_nop 0
    v_cvt_pk_bf16_f32 v220, v4, v5
    v_fmamk_f32 v4, v11, 0x43f10000, v12
    v_fmamk_f32 v5, v11, 0x43f18000, v12
    v_fract_f32 v4, v4
    v_fract_f32 v5, v5
    v_cos_f32 v4, v4
    v_cos_f32 v5, v5
    s_nop 0
    v_cvt_pk_bf16_f32 v221, v4, v5
    v_fmamk_f32 v4, v11, 0x43f20000, v12
    v_fmamk_f32 v5, v11, 0x43f28000, v12
    v_fract_f32 v4, v4
    v_fract_f32 v5, v5
    v_cos_f32 v4, v4
    v_cos_f32 v5, v5
    s_nop 0
    v_cvt_pk_bf16_f32 v222, v4, v5
    v_fmamk_f32 v4, v11, 0x43f30000, v12
    v_fmamk_f32 v5, v11, 0x43f38000, v12
    v_fract_f32 v4, v4
    v_fract_f32 v5, v5
    v_cos_f32 v4, v4
    v_cos_f32 v5, v5
    s_nop 0
    v_cvt_pk_bf16_f32 v223, v4, v5
    v_fmamk_f32 v4, v11, 0x43f80000, v12
    v_fmamk_f32 v5, v11, 0x43f88000, v12
    v_fract_f32 v4, v4
    v_fract_f32 v5, v5
    v_cos_f32 v4, v4
    v_cos_f32 v5, v5
    s_nop 0
    v_cvt_pk_bf16_f32 v224, v4, v5
    v_fmamk_f32 v4, v11, 0x43f90000, v12
    v_fmamk_f32 v5, v11, 0x43f98000, v12
    v_fract_f32 v4, v4
    v_fract_f32 v5, v5
    v_cos_f32 v4, v4
    v_cos_f32 v5, v5
    s_nop 0
    v_cvt_pk_bf16_f32 v225, v4, v5
    v_fmamk_f32 v4, v11, 0x43fa0000, v12
    v_fmamk_f32 v5, v11, 0x43fa8000, v12
    v_fract_f32 v4, v4
    v_fract_f32 v5, v5
    v_cos_f32 v4, v4
    v_cos_f32 v5, v5
    s_nop 0
    v_cvt_pk_bf16_f32 v226, v4, v5
    v_fmamk_f32 v4, v11, 0x43fb0000, v12
    v_fmamk_f32 v5, v11, 0x43fb8000, v12
    v_fract_f32 v4, v4
    v_fract_f32 v5, v5
    v_cos_f32 v4, v4
    v_cos_f32 v5, v5
    s_nop 0
    v_cvt_pk_bf16_f32 v227, v4, v5
    v_fmamk_f32 v4, v11, 0x44000000, v12
    v_fmamk_f32 v5, v11, 0x44004000, v12
    v_fract_f32 v4, v4
    v_fract_f32 v5, v5
    v_cos_f32 v4, v4
    v_cos_f32 v5, v5
    s_nop 0
    v_cvt_pk_bf16_f32 v228, v4, v5
    v_fmamk_f32 v4, v11, 0x44008000, v12
    v_fmamk_f32 v5, v11, 0x4400c000, v12
    v_fract_f32 v4, v4
    v_fract_f32 v5, v5
    v_cos_f32 v4, v4
    v_cos_f32 v5, v5
    s_nop 0
    v_cvt_pk_bf16_f32 v229, v4, v5
    v_fmamk_f32 v4, v11, 0x44010000, v12
    v_fmamk_f32 v5, v11, 0x44014000, v12
    v_fract_f32 v4, v4
    v_fract_f32 v5, v5
    v_cos_f32 v4, v4
    v_cos_f32 v5, v5
    s_nop 0
    v_cvt_pk_bf16_f32 v230, v4, v5
    v_fmamk_f32 v4, v11, 0x44018000, v12
    v_fmamk_f32 v5, v11, 0x4401c000, v12
    v_fract_f32 v4, v4
    v_fract_f32 v5, v5
    v_cos_f32 v4, v4
    v_cos_f32 v5, v5
    s_nop 0
    v_cvt_pk_bf16_f32 v231, v4, v5
    v_fmamk_f32 v4, v11, 0x44040000, v12
    v_fmamk_f32 v5, v11, 0x44044000, v12
    v_fract_f32 v4, v4
    v_fract_f32 v5, v5
    v_cos_f32 v4, v4
    v_cos_f32 v5, v5
    s_nop 0
    v_cvt_pk_bf16_f32 v232, v4, v5
    v_fmamk_f32 v4, v11, 0x44048000, v12
    v_fmamk_f32 v5, v11, 0x4404c000, v12
    v_fract_f32 v4, v4
    v_fract_f32 v5, v5
    v_cos_f32 v4, v4
    v_cos_f32 v5, v5
    s_nop 0
    v_cvt_pk_bf16_f32 v233, v4, v5
    v_fmamk_f32 v4, v11, 0x44050000, v12
    v_fmamk_f32 v5, v11, 0x44054000, v12
    v_fract_f32 v4, v4
    v_fract_f32 v5, v5
    v_cos_f32 v4, v4
    v_cos_f32 v5, v5
    s_nop 0
    v_cvt_pk_bf16_f32 v234, v4, v5
    v_fmamk_f32 v4, v11, 0x44058000, v12
    v_fmamk_f32 v5, v11, 0x4405c000, v12
    v_fract_f32 v4, v4
    v_fract_f32 v5, v5
    v_cos_f32 v4, v4
    v_cos_f32 v5, v5
    s_nop 0
    v_cvt_pk_bf16_f32 v235, v4, v5
    v_fmamk_f32 v4, v11, 0x44080000, v12
    v_fmamk_f32 v5, v11, 0x44084000, v12
    v_fract_f32 v4, v4
    v_fract_f32 v5, v5
    v_cos_f32 v4, v4
    v_cos_f32 v5, v5
    s_nop 0
    v_cvt_pk_bf16_f32 v236, v4, v5
    v_fmamk_f32 v4, v11, 0x44088000, v12
    v_fmamk_f32 v5, v11, 0x4408c000, v12
    v_fract_f32 v4, v4
    v_fract_f32 v5, v5
    v_cos_f32 v4, v4
    v_cos_f32 v5, v5
    s_nop 0
    v_cvt_pk_bf16_f32 v237, v4, v5
    v_fmamk_f32 v4, v11, 0x44090000, v12
    v_fmamk_f32 v5, v11, 0x44094000, v12
    v_fract_f32 v4, v4
    v_fract_f32 v5, v5
    v_cos_f32 v4, v4
    v_cos_f32 v5, v5
    s_nop 0
    v_cvt_pk_bf16_f32 v238, v4, v5
    v_fmamk_f32 v4, v11, 0x44098000, v12
    v_fmamk_f32 v5, v11, 0x4409c000, v12
    v_fract_f32 v4, v4
    v_fract_f32 v5, v5
    v_cos_f32 v4, v4
    v_cos_f32 v5, v5
    s_nop 0
    v_cvt_pk_bf16_f32 v239, v4, v5
    v_fmamk_f32 v4, v11, 0x440c0000, v12
    v_fmamk_f32 v5, v11, 0x440c4000, v12
    v_fract_f32 v4, v4
    v_fract_f32 v5, v5
    v_cos_f32 v4, v4
    v_cos_f32 v5, v5
    s_nop 0
    v_cvt_pk_bf16_f32 v240, v4, v5
    v_fmamk_f32 v4, v11, 0x440c8000, v12
    v_fmamk_f32 v5, v11, 0x440cc000, v12
    v_fract_f32 v4, v4
    v_fract_f32 v5, v5
    v_cos_f32 v4, v4
    v_cos_f32 v5, v5
    s_nop 0
    v_cvt_pk_bf16_f32 v241, v4, v5
    v_fmamk_f32 v4, v11, 0x440d0000, v12
    v_fmamk_f32 v5, v11, 0x440d4000, v12
    v_fract_f32 v4, v4
    v_fract_f32 v5, v5
    v_cos_f32 v4, v4
    v_cos_f32 v5, v5
    s_nop 0
    v_cvt_pk_bf16_f32 v242, v4, v5
    v_fmamk_f32 v4, v11, 0x440d8000, v12
    v_fmamk_f32 v5, v11, 0x440dc000, v12
    v_fract_f32 v4, v4
    v_fract_f32 v5, v5
    v_cos_f32 v4, v4
    v_cos_f32 v5, v5
    s_nop 0
    v_cvt_pk_bf16_f32 v243, v4, v5
    s_waitcnt vmcnt(0)
    v_lshl_or_b32 v64, v16, 16, v64
    v_lshl_or_b32 v65, v17, 16, v65
    v_lshl_or_b32 v66, v18, 16, v66
    v_lshl_or_b32 v67, v19, 16, v67
    v_lshl_or_b32 v68, v20, 16, v68
    v_lshl_or_b32 v69, v21, 16, v69
    v_lshl_or_b32 v70, v22, 16, v70
    v_lshl_or_b32 v71, v23, 16, v71
    v_lshl_or_b32 v72, v24, 16, v72
    v_lshl_or_b32 v73, v25, 16, v73
    v_lshl_or_b32 v74, v26, 16, v74
    v_lshl_or_b32 v75, v27, 16, v75
    v_lshl_or_b32 v76, v28, 16, v76
    v_lshl_or_b32 v77, v29, 16, v77
    v_lshl_or_b32 v78, v30, 16, v78
    v_lshl_or_b32 v79, v31, 16, v79
    v_lshl_or_b32 v80, v32, 16, v80
    v_lshl_or_b32 v81, v33, 16, v81
    v_lshl_or_b32 v82, v34, 16, v82
    v_lshl_or_b32 v83, v35, 16, v83
    v_lshl_or_b32 v84, v36, 16, v84
    v_lshl_or_b32 v85, v37, 16, v85
    v_lshl_or_b32 v86, v38, 16, v86
    v_lshl_or_b32 v87, v39, 16, v87
    v_lshl_or_b32 v88, v40, 16, v88
    v_lshl_or_b32 v89, v41, 16, v89
    v_lshl_or_b32 v90, v42, 16, v90
    v_lshl_or_b32 v91, v43, 16, v91
    v_lshl_or_b32 v92, v44, 16, v92
    v_lshl_or_b32 v93, v45, 16, v93
    v_lshl_or_b32 v94, v46, 16, v94
    v_lshl_or_b32 v95, v47, 16, v95
F_a1loop:
    s_barrier
    s_lshl_b32 s20, s23, 17
    s_lshr_b32 s13, s16, 4
    s_lshl_b32 s13, s13, 10
    s_add_u32 s20, s20, s13
    s_and_b32 s13, s16, 15
    s_lshl_b32 s13, s13, 6
    s_add_u32 s20, s20, s13
    s_add_u32 s20, s20, 102760448
    s_cmp_ge_u32 s23, 19
    s_cselect_b32 s20, 2130706432, s20
    s_xor_b32 s17, s17, 0x10000
    s_add_u32 s16, s16, 19
    s_lshr_b32 s13, s16, 5
    s_lshl_b32 s13, s13, 10
    s_bfe_u32 s14, s16, 0x10004
    s_lshl_b32 s14, s14, 8
    s_add_u32 s13, s13, s14
    s_and_b32 s14, s16, 15
    s_lshl_b32 s14, s14, 2
    s_add_u32 s13, s13, s14
    s_mul_i32 s18, s13, 1152
    s_cmp_ge_u32 s16, 64
    s_cselect_b32 s18, 2130706432, s18
    ds_read_b128 v[32:35], v8 offset:0
    ds_read_b128 v[36:39], v8 offset:512
    ds_read_b128 v[40:43], v8 offset:2048
    ds_read_b128 v[44:47], v8 offset:2560
    s_waitcnt lgkmcnt(3)
    v_mfma_f32_32x32x16_bf16 v[16:31], v[32:35], v[100:103], 0
    s_add_u32 m0, s17, 0
    s_nop 0
    buffer_load_dwordx4 v9, s[24:27], s18 offen offset:0 lds
    ds_read_b128 v[32:35], v8 offset:4096
    s_waitcnt lgkmcnt(3)
    v_mfma_f32_32x32x16_bf16 v[16:31], v[36:39], v[104:107], v[16:31]
    s_add_u32 m0, s17, 3968
    s_nop 0
    buffer_load_dwordx4 v9, s[24:27], s18 offen offset:128 lds
    ds_read_b128 v[36:39], v8 offset:4608
    s_waitcnt lgkmcnt(3)
    v_mfma_f32_32x32x16_bf16 v[16:31], v[40:43], v[108:111], v[16:31]
    s_add_u32 m0, s17, 7936
    s_nop 0
    buffer_load_dwordx4 v9, s[24:27], s18 offen offset:256 lds
    ds_read_b128 v[40:43], v8 offset:6144
    s_waitcnt lgkmcnt(3)
    v_mfma_f32_32x32x16_bf16 v[16:31], v[44:47], v[112:115], v[16:31]
    s_add_u32 m0, s17, 11904
    s_nop 0
    buffer_load_dwordx4 v9, s[24:27], s18 offen offset:384 lds
    ds_read_b128 v[44:47], v8 offset:6656
    s_waitcnt lgkmcnt(3)
    v_mfma_f32_32x32x16_bf16 v[16:31], v[32:35], v[116:119], v[16:31]
    s_add_u32 m0, s17, 15872
    s_nop 0
    buffer_load_dwordx4 v9, s[24:27], s18 offen offset:512 lds
    ds_read_b128 v[32:35], v8 offset:8192
    s_waitcnt lgkmcnt(3)
    v_mfma_f32_32x32x16_bf16 v[16:31], v[36:39], v[120:123], v[16:31]
    s_add_u32 m0, s17, 19840
    s_nop 0
    buffer_load_dwordx4 v9, s[24:27], s18 offen offset:640 lds
    ds_read_b128 v[36:39], v8 offset:8704
    s_waitcnt lgkmcnt(3)
    v_mfma_f32_32x32x16_bf16 v[16:31], v[40:43], v[124:127], v[16:31]
    s_add_u32 m0, s17, 23808
    s_nop 0
    buffer_load_dwordx4 v9, s[24:27], s18 offen offset:768 lds
    ds_read_b128 v[40:43], v8 offset:10240
    s_waitcnt lgkmcnt(3)
    v_mfma_f32_32x32x16_bf16 v[16:31], v[44:47], v[128:131], v[16:31]
    s_add_u32 m0, s17, 27776
    s_nop 0
    buffer_load_dwordx4 v9, s[24:27], s18 offen offset:896 lds
    ds_read_b128 v[44:47], v8 offset:10752
    s_waitcnt lgkmcnt(3)
    v_mfma_f32_32x32x16_bf16 v[16:31], v[32:35], v[132:135], v[16:31]
    s_add_u32 m0, s17, 31744
    s_nop 0
    buffer_load_dwordx4 v9, s[24:27], s18 offen offset:1024 lds
    ds_read_b128 v[32:35], v8 offset:12288
    s_waitcnt lgkmcnt(3)
    v_mfma_f32_32x32x16_bf16 v[16:31], v[36:39], v[136:139], v[16:31]
    ds_read_b128 v[36:39], v8 offset:12800
    s_waitcnt lgkmcnt(3)
    v_mfma_f32_32x32x16_bf16 v[16:31], v[40:43], v[140:143], v[16:31]
    ds_read_b128 v[40:43], v8 offset:14336
    s_waitcnt lgkmcnt(3)
    v_mfma_f32_32x32x16_bf16 v[16:31], v[44:47], v[144:147], v[16:31]
    ds_read_b128 v[44:47], v8 offset:14848
    s_waitcnt lgkmcnt(3)
    v_mfma_f32_32x32x16_bf16 v[16:31], v[32:35], v[148:151], v[16:31]
    ds_read_b128 v[32:35], v8 offset:16384
    s_waitcnt lgkmcnt(3)
    v_mfma_f32_32x32x16_bf16 v[16:31], v[36:39], v[152:155], v[16:31]
    ds_read_b128 v[36:39], v8 offset:16896
    s_waitcnt lgkmcnt(3)
    v_mfma_f32_32x32x16_bf16 v[16:31], v[40:43], v[156:159], v[16:31]
    ds_read_b128 v[40:43], v8 offset:18432
    s_waitcnt lgkmcnt(3)
    v_mfma_f32_32x32x16_bf16 v[16:31], v[44:47], v[160:163], v[16:31]
    ds_read_b128 v[44:47], v8 offset:18944
    s_waitcnt lgkmcnt(3)
    v_mfma_f32_32x32x16_bf16 v[16:31], v[32:35], v[164:167], v[16:31]
    ds_read_b128 v[32:35], v8 offset:20480
    s_waitcnt lgkmcnt(3)
    v_mfma_f32_32x32x16_bf16 v[16:31], v[36:39], v[168:171], v[16:31]
    ds_read_b128 v[36:39], v8 offset:20992
    s_waitcnt lgkmcnt(3)
    v_mfma_f32_32x32x16_bf16 v[16:31], v[40:43], v[172:175], v[16:31]
    ds_read_b128 v[40:43], v8 offset:22528
    s_waitcnt lgkmcnt(3)
    v_mfma_f32_32x32x16_bf16 v[16:31], v[44:47], v[176:179], v[16:31]
    ds_read_b128 v[44:47], v8 offset:23040
    s_waitcnt lgkmcnt(3)
    v_mfma_f32_32x32x16_bf16 v[16:31], v[32:35], v[180:183], v[16:31]
    ds_read_b128 v[32:35], v8 offset:24576
    s_waitcnt lgkmcnt(3)
    v_mfma_f32_32x32x16_bf16 v[16:31], v[36:39], v[184:187], v[16:31]
    ds_read_b128 v[36:39], v8 offset:25088
    s_waitcnt lgkmcnt(3)
    v_mfma_f32_32x32x16_bf16 v[16:31], v[40:43], v[188:191], v[16:31]
    ds_read_b128 v[40:43], v8 offset:26624
    s_waitcnt lgkmcnt(3)
    v_mfma_f32_32x32x16_bf16 v[16:31], v[44:47], v[192:195], v[16:31]
    ds_read_b128 v[44:47], v8 offset:27136
    s_waitcnt lgkmcnt(3)
    v_mfma_f32_32x32x16_bf16 v[16:31], v[32:35], v[196:199], v[16:31]
    ds_read_b128 v[32:35], v8 offset:28672
    s_waitcnt lgkmcnt(3)
    v_mfma_f32_32x32x16_bf16 v[16:31], v[36:39], v[200:203], v[16:31]
    ds_read_b128 v[36:39], v8 offset:29184
    s_waitcnt lgkmcnt(3)
    v_mfma_f32_32x32x16_bf16 v[16:31], v[40:43], v[204:207], v[16:31]
    ds_read_b128 v[40:43], v8 offset:30720
    s_waitcnt lgkmcnt(3)
    v_mfma_f32_32x32x16_bf16 v[16:31], v[44:47], v[208:211], v[16:31]
    ds_read_b128 v[44:47], v8 offset:31232
    s_waitcnt lgkmcnt(3)
    v_mfma_f32_32x32x16_bf16 v[16:31], v[32:35], v[212:215], v[16:31]
    ds_read_b128 v[32:35], v8 offset:32768
    s_waitcnt lgkmcnt(3)
    v_mfma_f32_32x32x16_bf16 v[16:31], v[36:39], v[216:219], v[16:31]
    ds_read_b128 v[36:39], v8 offset:33280
    s_waitcnt lgkmcnt(3)
    v_mfma_f32_32x32x16_bf16 v[16:31], v[40:43], v[220:223], v[16:31]
    ds_read_b128 v[40:43], v8 offset:34816
    s_waitcnt lgkmcnt(3)
    v_mfma_f32_32x32x16_bf16 v[16:31], v[44:47], v[224:227], v[16:31]
    ds_read_b128 v[44:47], v8 offset:35328
    s_waitcnt lgkmcnt(3)
    v_mfma_f32_32x32x16_bf16 v[16:31], v[32:35], v[228:231], v[16:31]
    s_waitcnt lgkmcnt(2)
    v_mfma_f32_32x32x16_bf16 v[16:31], v[36:39], v[232:235], v[16:31]
    s_waitcnt lgkmcnt(1)
    v_mfma_f32_32x32x16_bf16 v[16:31], v[40:43], v[236:239], v[16:31]
    s_waitcnt lgkmcnt(0)
    v_mfma_f32_32x32x16_bf16 v[16:31], v[44:47], v[240:243], v[16:31]
    v_xor_b32 v8, 0x10000, v8
    s_nop 10
    v_cvt_pk_bf16_f32 v16, v16, v17
    v_cvt_pk_bf16_f32 v17, v18, v19
    v_cvt_pk_bf16_f32 v18, v20, v21
    v_cvt_pk_bf16_f32 v19, v22, v23
    v_cvt_pk_bf16_f32 v20, v24, v25
    v_cvt_pk_bf16_f32 v21, v26, v27
    v_cvt_pk_bf16_f32 v22, v28, v29
    v_cvt_pk_bf16_f32 v23, v30, v31
    buffer_store_dwordx4 v[16:19], v10, s[8:11], s20 offen sc1
    buffer_store_dwordx4 v[20:23], v10, s[8:11], s20 offen offset:32 sc1
    s_cmp_lt_u32 s16, 64
    s_waitcnt vmcnt(2)
    s_cbranch_scc1 F_a1loop
F_a1done:
    s_waitcnt vmcnt(0)
    s_barrier
    s_cmp_lg_u32 s6, 0
    s_cbranch_scc1 FB_na68
    s_mov_b64 exec, 1
    v_mov_b32 v4, 68
    v_mov_b32 v5, 1
    global_atomic_add v4, v5, s[40:41]
    s_mov_b64 exec, -1
FB_na68:
    v_cvt_f32_u32 v7, v3
    v_cvt_f32_u32 v13, v2
    v_mul_f32 v13, 4.0, v13
    v_mul_f32 v11, 0x3d000000, v7
    v_mul_f32 v12, v13, v11
    v_fmamk_f32 v4, v11, 0x00000000, v12
    v_fmamk_f32 v5, v11, 0x3f800000, v12
    v_fract_f32 v4, v4
    v_fract_f32 v5, v5
    v_cos_f32 v4, v4
    v_cos_f32 v5, v5
    s_nop 0
    v_cvt_pk_bf16_f32 v224, v4, v5
    v_fmamk_f32 v4, v11, 0x00000000, v12
    v_fmamk_f32 v5, v11, 0x3f800000, v12
    v_fract_f32 v4, v4
    v_fract_f32 v5, v5
    v_sin_f32 v4, v4
    v_sin_f32 v5, v5
    s_nop 0
    v_cvt_pk_bf16_f32 v232, v4, v5
    v_xor_b32 v240, 0x80008000, v232
    v_fmamk_f32 v4, v11, 0x40000000, v12
    v_fmamk_f32 v5, v11, 0x40400000, v12
    v_fract_f32 v4, v4
    v_fract_f32 v5, v5
    v_cos_f32 v4, v4
    v_cos_f32 v5, v5
    s_nop 0
    v_cvt_pk_bf16_f32 v225, v4, v5
    v_fmamk_f32 v4, v11, 0x40000000, v12
    v_fmamk_f32 v5, v11, 0x40400000, v12
    v_fract_f32 v4, v4
    v_fract_f32 v5, v5
    v_sin_f32 v4, v4
    v_sin_f32 v5, v5
    s_nop 0
    v_cvt_pk_bf16_f32 v233, v4, v5
    v_xor_b32 v241, 0x80008000, v233
    v_fmamk_f32 v4, v11, 0x41000000, v12
    v_fmamk_f32 v5, v11, 0x41100000, v12
    v_fract_f32 v4, v4
    v_fract_f32 v5, v5
    v_cos_f32 v4, v4
    v_cos_f32 v5, v5
    s_nop 0
    v_cvt_pk_bf16_f32 v226, v4, v5
    v_fmamk_f32 v4, v11, 0x41000000, v12
    v_fmamk_f32 v5, v11, 0x41100000, v12
    v_fract_f32 v4, v4
    v_fract_f32 v5, v5
    v_sin_f32 v4, v4
    v_sin_f32 v5, v5
    s_nop 0
    v_cvt_pk_bf16_f32 v234, v4, v5
    v_xor_b32 v242, 0x80008000, v234
    v_fmamk_f32 v4, v11, 0x41200000, v12
    v_fmamk_f32 v5, v11, 0x41300000, v12
    v_fract_f32 v4, v4
    v_fract_f32 v5, v5
    v_cos_f32 v4, v4
    v_cos_f32 v5, v5
    s_nop 0
    v_cvt_pk_bf16_f32 v227, v4, v5
    v_fmamk_f32 v4, v11, 0x41200000, v12
    v_fmamk_f32 v5, v11, 0x41300000, v12
    v_fract_f32 v4, v4
    v_fract_f32 v5, v5
    v_sin_f32 v4, v4
    v_sin_f32 v5, v5
    s_nop 0
    v_cvt_pk_bf16_f32 v235, v4, v5
    v_xor_b32 v243, 0x80008000, v235
    v_fmamk_f32 v4, v11, 0x41800000, v12
    v_fmamk_f32 v5, v11, 0x41880000, v12
    v_fract_f32 v4, v4
    v_fract_f32 v5, v5
    v_cos_f32 v4, v4
    v_cos_f32 v5, v5
    s_nop 0
    v_cvt_pk_bf16_f32 v228, v4, v5
    v_fmamk_f32 v4, v11, 0x41800000, v12
    v_fmamk_f32 v5, v11, 0x41880000, v12
    v_fract_f32 v4, v4
    v_fract_f32 v5, v5
    v_sin_f32 v4, v4
    v_sin_f32 v5, v5
    s_nop 0
    v_cvt_pk_bf16_f32 v236, v4, v5
    v_xor_b32 v244, 0x80008000, v236
    v_fmamk_f32 v4, v11, 0x41900000, v12
    v_fmamk_f32 v5, v11, 0x41980000, v12
    v_fract_f32 v4, v4
    v_fract_f32 v5, v5
    v_cos_f32 v4, v4
    v_cos_f32 v5, v5
    s_nop 0
    v_cvt_pk_bf16_f32 v229, v4, v5
    v_fmamk_f32 v4, v11, 0x41900000, v12
    v_fmamk_f32 v5, v11, 0x41980000, v12
    v_fract_f32 v4, v4
    v_fract_f32 v5, v5
    v_sin_f32 v4, v4
    v_sin_f32 v5, v5
    s_nop 0
    v_cvt_pk_bf16_f32 v237, v4, v5
    v_xor_b32 v245, 0x80008000, v237
    v_fmamk_f32 v4, v11, 0x41c00000, v12
    v_fmamk_f32 v5, v11, 0x41c80000, v12
    v_fract_f32 v4, v4
    v_fract_f32 v5, v5
    v_cos_f32 v4, v4
    v_cos_f32 v5, v5
    s_nop 0
    v_cvt_pk_bf16_f32 v230, v4, v5
    v_fmamk_f32 v4, v11, 0x41c00000, v12
    v_fmamk_f32 v5, v11, 0x41c80000, v12
    v_fract_f32 v4, v4
    v_fract_f32 v5, v5
    v_sin_f32 v4, v4
    v_sin_f32 v5, v5
    s_nop 0
    v_cvt_pk_bf16_f32 v238, v4, v5
    v_xor_b32 v246, 0x80008000, v238
    v_fmamk_f32 v4, v11, 0x41d00000, v12
    v_fmamk_f32 v5, v11, 0x41d80000, v12
    v_fract_f32 v4, v4
    v_fract_f32 v5, v5
    v_cos_f32 v4, v4
    v_cos_f32 v5, v5
    s_nop 0
    v_cvt_pk_bf16_f32 v231, v4, v5
    v_fmamk_f32 v4, v11, 0x41d00000, v12
    v_fmamk_f32 v5, v11, 0x41d80000, v12
    v_fract_f32 v4, v4
    v_fract_f32 v5, v5
    v_sin_f32 v4, v4
    v_sin_f32 v5, v5
    s_nop 0
    v_cvt_pk_bf16_f32 v239, v4, v5
    v_xor_b32 v247, 0x80008000, v239
    v_add_f32 v11, 0x00000000, v7
    v_mul_f32 v11, 0x3c800000, v11
    v_mul_f32 v12, v13, v11
    v_fmamk_f32 v4, v11, 0x00000000, v12
    v_fmamk_f32 v5, v11, 0x3f800000, v12
    v_fract_f32 v4, v4
    v_fract_f32 v5, v5
    v_cos_f32 v4, v4
    v_cos_f32 v5, v5
    s_nop 0
    v_cvt_pk_bf16_f32 v6, v4, v5
    v_accvgpr_write_b32 a0, v6
    v_fmamk_f32 v4, v11, 0x00000000, v12
    v_fmamk_f32 v5, v11, 0x3f800000, v12
    v_fract_f32 v4, v4
    v_fract_f32 v5, v5
    v_sin_f32 v4, v4
    v_sin_f32 v5, v5
    s_nop 0
    v_cvt_pk_bf16_f32 v6, v4, v5
    v_accvgpr_write_b32 a32, v6
    v_xor_b32 v6, 0x80008000, v6
    v_accvgpr_write_b32 a64, v6
    v_fmamk_f32 v4, v11, 0x40000000, v12
    v_fmamk_f32 v5, v11, 0x40400000, v12
    v_fract_f32 v4, v4
    v_fract_f32 v5, v5
    v_cos_f32 v4, v4
    v_cos_f32 v5, v5
    s_nop 0
    v_cvt_pk_bf16_f32 v6, v4, v5
    v_accvgpr_write_b32 a1, v6
    v_fmamk_f32 v4, v11, 0x40000000, v12
    v_fmamk_f32 v5, v11, 0x40400000, v12
    v_fract_f32 v4, v4
    v_fract_f32 v5, v5
    v_sin_f32 v4, v4
    v_sin_f32 v5, v5
    s_nop 0
    v_cvt_pk_bf16_f32 v6, v4, v5
    v_accvgpr_write_b32 a33, v6
    v_xor_b32 v6, 0x80008000, v6
    v_accvgpr_write_b32 a65, v6
    v_fmamk_f32 v4, v11, 0x41000000, v12
    v_fmamk_f32 v5, v11, 0x41100000, v12
    v_fract_f32 v4, v4
    v_fract_f32 v5, v5
    v_cos_f32 v4, v4
    v_cos_f32 v5, v5
    s_nop 0
    v_cvt_pk_bf16_f32 v6, v4, v5
    v_accvgpr_write_b32 a2, v6
    v_fmamk_f32 v4, v11, 0x41000000, v12
    v_fmamk_f32 v5, v11, 0x41100000, v12
    v_fract_f32 v4, v4
    v_fract_f32 v5, v5
    v_sin_f32 v4, v4
    v_sin_f32 v5, v5
    s_nop 0
    v_cvt_pk_bf16_f32 v6, v4, v5
    v_accvgpr_write_b32 a34, v6
    v_xor_b32 v6, 0x80008000, v6
    v_accvgpr_write_b32 a66, v6
    v_fmamk_f32 v4, v11, 0x41200000, v12
    v_fmamk_f32 v5, v11, 0x41300000, v12
    v_fract_f32 v4, v4
    v_fract_f32 v5, v5
    v_cos_f32 v4, v4
    v_cos_f32 v5, v5
    s_nop 0
    v_cvt_pk_bf16_f32 v6, v4, v5
    v_accvgpr_write_b32 a3, v6
    v_fmamk_f32 v4, v11, 0x41200000, v12
    v_fmamk_f32 v5, v11, 0x41300000, v12
    v_fract_f32 v4, v4
    v_fract_f32 v5, v5
    v_sin_f32 v4, v4
    v_sin_f32 v5, v5
    s_nop 0
    v_cvt_pk_bf16_f32 v6, v4, v5
    v_accvgpr_write_b32 a35, v6
    v_xor_b32 v6, 0x80008000, v6
    v_accvgpr_write_b32 a67, v6
    v_fmamk_f32 v4, v11, 0x41800000, v12
    v_fmamk_f32 v5, v11, 0x41880000, v12
    v_fract_f32 v4, v4
    v_fract_f32 v5, v5
    v_cos_f32 v4, v4
    v_cos_f32 v5, v5
    s_nop 0
    v_cvt_pk_bf16_f32 v6, v4, v5
    v_accvgpr_write_b32 a4, v6
    v_fmamk_f32 v4, v11, 0x41800000, v12
    v_fmamk_f32 v5, v11, 0x41880000, v12
    v_fract_f32 v4, v4
    v_fract_f32 v5, v5
    v_sin_f32 v4, v4
    v_sin_f32 v5, v5
    s_nop 0
    v_cvt_pk_bf16_f32 v6, v4, v5
    v_accvgpr_write_b32 a36, v6
    v_xor_b32 v6, 0x80008000, v6
    v_accvgpr_write_b32 a68, v6
    v_fmamk_f32 v4, v11, 0x41900000, v12
    v_fmamk_f32 v5, v11, 0x41980000, v12
    v_fract_f32 v4, v4
    v_fract_f32 v5, v5
    v_cos_f32 v4, v4
    v_cos_f32 v5, v5
    s_nop 0
    v_cvt_pk_bf16_f32 v6, v4, v5
    v_accvgpr_write_b32 a5, v6
    v_fmamk_f32 v4, v11, 0x41900000, v12
    v_fmamk_f32 v5, v11, 0x41980000, v12
    v_fract_f32 v4, v4
    v_fract_f32 v5, v5
    v_sin_f32 v4, v4
    v_sin_f32 v5, v5
    s_nop 0
    v_cvt_pk_bf16_f32 v6, v4, v5
    v_accvgpr_write_b32 a37, v6
    v_xor_b32 v6, 0x80008000, v6
    v_accvgpr_write_b32 a69, v6
    v_fmamk_f32 v4, v11, 0x41c00000, v12
    v_fmamk_f32 v5, v11, 0x41c80000, v12
    v_fract_f32 v4, v4
    v_fract_f32 v5, v5
    v_cos_f32 v4, v4
    v_cos_f32 v5, v5
    s_nop 0
    v_cvt_pk_bf16_f32 v6, v4, v5
    v_accvgpr_write_b32 a6, v6
    v_fmamk_f32 v4, v11, 0x41c00000, v12
    v_fmamk_f32 v5, v11, 0x41c80000, v12
    v_fract_f32 v4, v4
    v_fract_f32 v5, v5
    v_sin_f32 v4, v4
    v_sin_f32 v5, v5
    s_nop 0
    v_cvt_pk_bf16_f32 v6, v4, v5
    v_accvgpr_write_b32 a38, v6
    v_xor_b32 v6, 0x80008000, v6
    v_accvgpr_write_b32 a70, v6
    v_fmamk_f32 v4, v11, 0x41d00000, v12
    v_fmamk_f32 v5, v11, 0x41d80000, v12
    v_fract_f32 v4, v4
    v_fract_f32 v5, v5
    v_cos_f32 v4, v4
    v_cos_f32 v5, v5
    s_nop 0
    v_cvt_pk_bf16_f32 v6, v4, v5
    v_accvgpr_write_b32 a7, v6
    v_fmamk_f32 v4, v11, 0x41d00000, v12
    v_fmamk_f32 v5, v11, 0x41d80000, v12
    v_fract_f32 v4, v4
    v_fract_f32 v5, v5
    v_sin_f32 v4, v4
    v_sin_f32 v5, v5
    s_nop 0
    v_cvt_pk_bf16_f32 v6, v4, v5
    v_accvgpr_write_b32 a39, v6
    v_xor_b32 v6, 0x80008000, v6
    v_accvgpr_write_b32 a71, v6
    v_fmamk_f32 v4, v11, 0x42000000, v12
    v_fmamk_f32 v5, v11, 0x42040000, v12
    v_fract_f32 v4, v4
    v_fract_f32 v5, v5
    v_cos_f32 v4, v4
    v_cos_f32 v5, v5
    s_nop 0
    v_cvt_pk_bf16_f32 v6, v4, v5
    v_accvgpr_write_b32 a8, v6
    v_fmamk_f32 v4, v11, 0x42000000, v12
    v_fmamk_f32 v5, v11, 0x42040000, v12
    v_fract_f32 v4, v4
    v_fract_f32 v5, v5
    v_sin_f32 v4, v4
    v_sin_f32 v5, v5
    s_nop 0
    v_cvt_pk_bf16_f32 v6, v4, v5
    v_accvgpr_write_b32 a40, v6
    v_xor_b32 v6, 0x80008000, v6
    v_accvgpr_write_b32 a72, v6
    v_fmamk_f32 v4, v11, 0x42080000, v12
    v_fmamk_f32 v5, v11, 0x420c0000, v12
    v_fract_f32 v4, v4
    v_fract_f32 v5, v5
    v_cos_f32 v4, v4
    v_cos_f32 v5, v5
    s_nop 0
    v_cvt_pk_bf16_f32 v6, v4, v5
    v_accvgpr_write_b32 a9, v6
    v_fmamk_f32 v4, v11, 0x42080000, v12
    v_fmamk_f32 v5, v11, 0x420c0000, v12
    v_fract_f32 v4, v4
    v_fract_f32 v5, v5
    v_sin_f32 v4, v4
    v_sin_f32 v5, v5
    s_nop 0
    v_cvt_pk_bf16_f32 v6, v4, v5
    v_accvgpr_write_b32 a41, v6
    v_xor_b32 v6, 0x80008000, v6
    v_accvgpr_write_b32 a73, v6
    v_fmamk_f32 v4, v11, 0x42200000, v12
    v_fmamk_f32 v5, v11, 0x42240000, v12
    v_fract_f32 v4, v4
    v_fract_f32 v5, v5
    v_cos_f32 v4, v4
    v_cos_f32 v5, v5
    s_nop 0
    v_cvt_pk_bf16_f32 v6, v4, v5
    v_accvgpr_write_b32 a10, v6
    v_fmamk_f32 v4, v11, 0x42200000, v12
    v_fmamk_f32 v5, v11, 0x42240000, v12
    v_fract_f32 v4, v4
    v_fract_f32 v5, v5
    v_sin_f32 v4, v4
    v_sin_f32 v5, v5
    s_nop 0
    v_cvt_pk_bf16_f32 v6, v4, v5
    v_accvgpr_write_b32 a42, v6
    v_xor_b32 v6, 0x80008000, v6
    v_accvgpr_write_b32 a74, v6
    v_fmamk_f32 v4, v11, 0x42280000, v12
    v_fmamk_f32 v5, v11, 0x422c0000, v12
    v_fract_f32 v4, v4
    v_fract_f32 v5, v5
    v_cos_f32 v4, v4
    v_cos_f32 v5, v5
    s_nop 0
    v_cvt_pk_bf16_f32 v6, v4, v5
    v_accvgpr_write_b32 a11, v6
    v_fmamk_f32 v4, v11, 0x42280000, v12
    v_fmamk_f32 v5, v11, 0x422c0000, v12
    v_fract_f32 v4, v4
    v_fract_f32 v5, v5
    v_sin_f32 v4, v4
    v_sin_f32 v5, v5
    s_nop 0
    v_cvt_pk_bf16_f32 v6, v4, v5
    v_accvgpr_write_b32 a43, v6
    v_xor_b32 v6, 0x80008000, v6
    v_accvgpr_write_b32 a75, v6
    v_fmamk_f32 v4, v11, 0x42400000, v12
    v_fmamk_f32 v5, v11, 0x42440000, v12
    v_fract_f32 v4, v4
    v_fract_f32 v5, v5
    v_cos_f32 v4, v4
    v_cos_f32 v5, v5
    s_nop 0
    v_cvt_pk_bf16_f32 v6, v4, v5
    v_accvgpr_write_b32 a12, v6
    v_fmamk_f32 v4, v11, 0x42400000, v12
    v_fmamk_f32 v5, v11, 0x42440000, v12
    v_fract_f32 v4, v4
    v_fract_f32 v5, v5
    v_sin_f32 v4, v4
    v_sin_f32 v5, v5
    s_nop 0
    v_cvt_pk_bf16_f32 v6, v4, v5
    v_accvgpr_write_b32 a44, v6
    v_xor_b32 v6, 0x80008000, v6
    v_accvgpr_write_b32 a76, v6
    v_fmamk_f32 v4, v11, 0x42480000, v12
    v_fmamk_f32 v5, v11, 0x424c0000, v12
    v_fract_f32 v4, v4
    v_fract_f32 v5, v5
    v_cos_f32 v4, v4
    v_cos_f32 v5, v5
    s_nop 0
    v_cvt_pk_bf16_f32 v6, v4, v5
    v_accvgpr_write_b32 a13, v6
    v_fmamk_f32 v4, v11, 0x42480000, v12
    v_fmamk_f32 v5, v11, 0x424c0000, v12
    v_fract_f32 v4, v4
    v_fract_f32 v5, v5
    v_sin_f32 v4, v4
    v_sin_f32 v5, v5
    s_nop 0
    v_cvt_pk_bf16_f32 v6, v4, v5
    v_accvgpr_write_b32 a45, v6
    v_xor_b32 v6, 0x80008000, v6
    v_accvgpr_write_b32 a77, v6
    v_fmamk_f32 v4, v11, 0x42600000, v12
    v_fmamk_f32 v5, v11, 0x42640000, v12
    v_fract_f32 v4, v4
    v_fract_f32 v5, v5
    v_cos_f32 v4, v4
    v_cos_f32 v5, v5
    s_nop 0
    v_cvt_pk_bf16_f32 v6, v4, v5
    v_accvgpr_write_b32 a14, v6
    v_fmamk_f32 v4, v11, 0x42600000, v12
    v_fmamk_f32 v5, v11, 0x42640000, v12
    v_fract_f32 v4, v4
    v_fract_f32 v5, v5
    v_sin_f32 v4, v4
    v_sin_f32 v5, v5
    s_nop 0
    v_cvt_pk_bf16_f32 v6, v4, v5
    v_accvgpr_write_b32 a46, v6
    v_xor_b32 v6, 0x80008000, v6
    v_accvgpr_write_b32 a78, v6
    v_fmamk_f32 v4, v11, 0x42680000, v12
    v_fmamk_f32 v5, v11, 0x426c0000, v12
    v_fract_f32 v4, v4
    v_fract_f32 v5, v5
    v_cos_f32 v4, v4
    v_cos_f32 v5, v5
    s_nop 0
    v_cvt_pk_bf16_f32 v6, v4, v5
    v_accvgpr_write_b32 a15, v6
    v_fmamk_f32 v4, v11, 0x42680000, v12
    v_fmamk_f32 v5, v11, 0x426c0000, v12
    v_fract_f32 v4, v4
    v_fract_f32 v5, v5
    v_sin_f32 v4, v4
    v_sin_f32 v5, v5
    s_nop 0
    v_cvt_pk_bf16_f32 v6, v4, v5
    v_accvgpr_write_b32 a47, v6
    v_xor_b32 v6, 0x80008000, v6
    v_accvgpr_write_b32 a79, v6
    v_add_f32 v11, 0x42000000, v7
    v_mul_f32 v11, 0x3c800000, v11
    v_mul_f32 v12, v13, v11
    v_fmamk_f32 v4, v11, 0x00000000, v12
    v_fmamk_f32 v5, v11, 0x3f800000, v12
    v_fract_f32 v4, v4
    v_fract_f32 v5, v5
    v_cos_f32 v4, v4
    v_cos_f32 v5, v5
    s_nop 0
    v_cvt_pk_bf16_f32 v6, v4, v5
    v_accvgpr_write_b32 a16, v6
    v_fmamk_f32 v4, v11, 0x00000000, v12
    v_fmamk_f32 v5, v11, 0x3f800000, v12
    v_fract_f32 v4, v4
    v_fract_f32 v5, v5
    v_sin_f32 v4, v4
    v_sin_f32 v5, v5
    s_nop 0
    v_cvt_pk_bf16_f32 v6, v4, v5
    v_accvgpr_write_b32 a48, v6
    v_xor_b32 v6, 0x80008000, v6
    v_accvgpr_write_b32 a80, v6
    v_fmamk_f32 v4, v11, 0x40000000, v12
    v_fmamk_f32 v5, v11, 0x40400000, v12
    v_fract_f32 v4, v4
    v_fract_f32 v5, v5
    v_cos_f32 v4, v4
    v_cos_f32 v5, v5
    s_nop 0
    v_cvt_pk_bf16_f32 v6, v4, v5
    v_accvgpr_write_b32 a17, v6
    v_fmamk_f32 v4, v11, 0x40000000, v12
    v_fmamk_f32 v5, v11, 0x40400000, v12
    v_fract_f32 v4, v4
    v_fract_f32 v5, v5
    v_sin_f32 v4, v4
    v_sin_f32 v5, v5
    s_nop 0
    v_cvt_pk_bf16_f32 v6, v4, v5
    v_accvgpr_write_b32 a49, v6
    v_xor_b32 v6, 0x80008000, v6
    v_accvgpr_write_b32 a81, v6
    v_fmamk_f32 v4, v11, 0x41000000, v12
    v_fmamk_f32 v5, v11, 0x41100000, v12
    v_fract_f32 v4, v4
    v_fract_f32 v5, v5
    v_cos_f32 v4, v4
    v_cos_f32 v5, v5
    s_nop 0
    v_cvt_pk_bf16_f32 v6, v4, v5
    v_accvgpr_write_b32 a18, v6
    v_fmamk_f32 v4, v11, 0x41000000, v12
    v_fmamk_f32 v5, v11, 0x41100000, v12
    v_fract_f32 v4, v4
    v_fract_f32 v5, v5
    v_sin_f32 v4, v4
    v_sin_f32 v5, v5
    s_nop 0
    v_cvt_pk_bf16_f32 v6, v4, v5
    v_accvgpr_write_b32 a50, v6
    v_xor_b32 v6, 0x80008000, v6
    v_accvgpr_write_b32 a82, v6
    v_fmamk_f32 v4, v11, 0x41200000, v12
    v_fmamk_f32 v5, v11, 0x41300000, v12
    v_fract_f32 v4, v4
    v_fract_f32 v5, v5
    v_cos_f32 v4, v4
    v_cos_f32 v5, v5
    s_nop 0
    v_cvt_pk_bf16_f32 v6, v4, v5
    v_accvgpr_write_b32 a19, v6
    v_fmamk_f32 v4, v11, 0x41200000, v12
    v_fmamk_f32 v5, v11, 0x41300000, v12
    v_fract_f32 v4, v4
    v_fract_f32 v5, v5
    v_sin_f32 v4, v4
    v_sin_f32 v5, v5
    s_nop 0
    v_cvt_pk_bf16_f32 v6, v4, v5
    v_accvgpr_write_b32 a51, v6
    v_xor_b32 v6, 0x80008000, v6
    v_accvgpr_write_b32 a83, v6
    v_fmamk_f32 v4, v11, 0x41800000, v12
    v_fmamk_f32 v5, v11, 0x41880000, v12
    v_fract_f32 v4, v4
    v_fract_f32 v5, v5
    v_cos_f32 v4, v4
    v_cos_f32 v5, v5
    s_nop 0
    v_cvt_pk_bf16_f32 v6, v4, v5
    v_accvgpr_write_b32 a20, v6
    v_fmamk_f32 v4, v11, 0x41800000, v12
    v_fmamk_f32 v5, v11, 0x41880000, v12
    v_fract_f32 v4, v4
    v_fract_f32 v5, v5
    v_sin_f32 v4, v4
    v_sin_f32 v5, v5
    s_nop 0
    v_cvt_pk_bf16_f32 v6, v4, v5
    v_accvgpr_write_b32 a52, v6
    v_xor_b32 v6, 0x80008000, v6
    v_accvgpr_write_b32 a84, v6
    v_fmamk_f32 v4, v11, 0x41900000, v12
    v_fmamk_f32 v5, v11, 0x41980000, v12
    v_fract_f32 v4, v4
    v_fract_f32 v5, v5
    v_cos_f32 v4, v4
    v_cos_f32 v5, v5
    s_nop 0
    v_cvt_pk_bf16_f32 v6, v4, v5
    v_accvgpr_write_b32 a21, v6
    v_fmamk_f32 v4, v11, 0x41900000, v12
    v_fmamk_f32 v5, v11, 0x41980000, v12
    v_fract_f32 v4, v4
    v_fract_f32 v5, v5
    v_sin_f32 v4, v4
    v_sin_f32 v5, v5
    s_nop 0
    v_cvt_pk_bf16_f32 v6, v4, v5
    v_accvgpr_write_b32 a53, v6
    v_xor_b32 v6, 0x80008000, v6
    v_accvgpr_write_b32 a85, v6
    v_fmamk_f32 v4, v11, 0x41c00000, v12
    v_fmamk_f32 v5, v11, 0x41c80000, v12
    v_fract_f32 v4, v4
    v_fract_f32 v5, v5
    v_cos_f32 v4, v4
    v_cos_f32 v5, v5
    s_nop 0
    v_cvt_pk_bf16_f32 v6, v4, v5
    v_accvgpr_write_b32 a22, v6
    v_fmamk_f32 v4, v11, 0x41c00000, v12
    v_fmamk_f32 v5, v11, 0x41c80000, v12
    v_fract_f32 v4, v4
    v_fract_f32 v5, v5
    v_sin_f32 v4, v4
    v_sin_f32 v5, v5
    s_nop 0
    v_cvt_pk_bf16_f32 v6, v4, v5
    v_accvgpr_write_b32 a54, v6
    v_xor_b32 v6, 0x80008000, v6
    v_accvgpr_write_b32 a86, v6
    v_fmamk_f32 v4, v11, 0x41d00000, v12
    v_fmamk_f32 v5, v11, 0x41d80000, v12
    v_fract_f32 v4, v4
    v_fract_f32 v5, v5
    v_cos_f32 v4, v4
    v_cos_f32 v5, v5
    s_nop 0
    v_cvt_pk_bf16_f32 v6, v4, v5
    v_accvgpr_write_b32 a23, v6
    v_fmamk_f32 v4, v11, 0x41d00000, v12
    v_fmamk_f32 v5, v11, 0x41d80000, v12
    v_fract_f32 v4, v4
    v_fract_f32 v5, v5
    v_sin_f32 v4, v4
    v_sin_f32 v5, v5
    s_nop 0
    v_cvt_pk_bf16_f32 v6, v4, v5
    v_accvgpr_write_b32 a55, v6
    v_xor_b32 v6, 0x80008000, v6
    v_accvgpr_write_b32 a87, v6
    v_fmamk_f32 v4, v11, 0x42000000, v12
    v_fmamk_f32 v5, v11, 0x42040000, v12
    v_fract_f32 v4, v4
    v_fract_f32 v5, v5
    v_cos_f32 v4, v4
    v_cos_f32 v5, v5
    s_nop 0
    v_cvt_pk_bf16_f32 v6, v4, v5
    v_accvgpr_write_b32 a24, v6
    v_fmamk_f32 v4, v11, 0x42000000, v12
    v_fmamk_f32 v5, v11, 0x42040000, v12
    v_fract_f32 v4, v4
    v_fract_f32 v5, v5
    v_sin_f32 v4, v4
    v_sin_f32 v5, v5
    s_nop 0
    v_cvt_pk_bf16_f32 v6, v4, v5
    v_accvgpr_write_b32 a56, v6
    v_xor_b32 v6, 0x80008000, v6
    v_accvgpr_write_b32 a88, v6
    v_fmamk_f32 v4, v11, 0x42080000, v12
    v_fmamk_f32 v5, v11, 0x420c0000, v12
    v_fract_f32 v4, v4
    v_fract_f32 v5, v5
    v_cos_f32 v4, v4
    v_cos_f32 v5, v5
    s_nop 0
    v_cvt_pk_bf16_f32 v6, v4, v5
    v_accvgpr_write_b32 a25, v6
    v_fmamk_f32 v4, v11, 0x42080000, v12
    v_fmamk_f32 v5, v11, 0x420c0000, v12
    v_fract_f32 v4, v4
    v_fract_f32 v5, v5
    v_sin_f32 v4, v4
    v_sin_f32 v5, v5
    s_nop 0
    v_cvt_pk_bf16_f32 v6, v4, v5
    v_accvgpr_write_b32 a57, v6
    v_xor_b32 v6, 0x80008000, v6
    v_accvgpr_write_b32 a89, v6
    v_fmamk_f32 v4, v11, 0x42200000, v12
    v_fmamk_f32 v5, v11, 0x42240000, v12
    v_fract_f32 v4, v4
    v_fract_f32 v5, v5
    v_cos_f32 v4, v4
    v_cos_f32 v5, v5
    s_nop 0
    v_cvt_pk_bf16_f32 v6, v4, v5
    v_accvgpr_write_b32 a26, v6
    v_fmamk_f32 v4, v11, 0x42200000, v12
    v_fmamk_f32 v5, v11, 0x42240000, v12
    v_fract_f32 v4, v4
    v_fract_f32 v5, v5
    v_sin_f32 v4, v4
    v_sin_f32 v5, v5
    s_nop 0
    v_cvt_pk_bf16_f32 v6, v4, v5
    v_accvgpr_write_b32 a58, v6
    v_xor_b32 v6, 0x80008000, v6
    v_accvgpr_write_b32 a90, v6
    v_fmamk_f32 v4, v11, 0x42280000, v12
    v_fmamk_f32 v5, v11, 0x422c0000, v12
    v_fract_f32 v4, v4
    v_fract_f32 v5, v5
    v_cos_f32 v4, v4
    v_cos_f32 v5, v5
    s_nop 0
    v_cvt_pk_bf16_f32 v6, v4, v5
    v_accvgpr_write_b32 a27, v6
    v_fmamk_f32 v4, v11, 0x42280000, v12
    v_fmamk_f32 v5, v11, 0x422c0000, v12
    v_fract_f32 v4, v4
    v_fract_f32 v5, v5
    v_sin_f32 v4, v4
    v_sin_f32 v5, v5
    s_nop 0
    v_cvt_pk_bf16_f32 v6, v4, v5
    v_accvgpr_write_b32 a59, v6
    v_xor_b32 v6, 0x80008000, v6
    v_accvgpr_write_b32 a91, v6
    v_fmamk_f32 v4, v11, 0x42400000, v12
    v_fmamk_f32 v5, v11, 0x42440000, v12
    v_fract_f32 v4, v4
    v_fract_f32 v5, v5
    v_cos_f32 v4, v4
    v_cos_f32 v5, v5
    s_nop 0
    v_cvt_pk_bf16_f32 v6, v4, v5
    v_accvgpr_write_b32 a28, v6
    v_fmamk_f32 v4, v11, 0x42400000, v12
    v_fmamk_f32 v5, v11, 0x42440000, v12
    v_fract_f32 v4, v4
    v_fract_f32 v5, v5
    v_sin_f32 v4, v4
    v_sin_f32 v5, v5
    s_nop 0
    v_cvt_pk_bf16_f32 v6, v4, v5
    v_accvgpr_write_b32 a60, v6
    v_xor_b32 v6, 0x80008000, v6
    v_accvgpr_write_b32 a92, v6
    v_fmamk_f32 v4, v11, 0x42480000, v12
    v_fmamk_f32 v5, v11, 0x424c0000, v12
    v_fract_f32 v4, v4
    v_fract_f32 v5, v5
    v_cos_f32 v4, v4
    v_cos_f32 v5, v5
    s_nop 0
    v_cvt_pk_bf16_f32 v6, v4, v5
    v_accvgpr_write_b32 a29, v6
    v_fmamk_f32 v4, v11, 0x42480000, v12
    v_fmamk_f32 v5, v11, 0x424c0000, v12
    v_fract_f32 v4, v4
    v_fract_f32 v5, v5
    v_sin_f32 v4, v4
    v_sin_f32 v5, v5
    s_nop 0
    v_cvt_pk_bf16_f32 v6, v4, v5
    v_accvgpr_write_b32 a61, v6
    v_xor_b32 v6, 0x80008000, v6
    v_accvgpr_write_b32 a93, v6
    v_fmamk_f32 v4, v11, 0x42600000, v12
    v_fmamk_f32 v5, v11, 0x42640000, v12
    v_fract_f32 v4, v4
    v_fract_f32 v5, v5
    v_cos_f32 v4, v4
    v_cos_f32 v5, v5
    s_nop 0
    v_cvt_pk_bf16_f32 v6, v4, v5
    v_accvgpr_write_b32 a30, v6
    v_fmamk_f32 v4, v11, 0x42600000, v12
    v_fmamk_f32 v5, v11, 0x42640000, v12
    v_fract_f32 v4, v4
    v_fract_f32 v5, v5
    v_sin_f32 v4, v4
    v_sin_f32 v5, v5
    s_nop 0
    v_cvt_pk_bf16_f32 v6, v4, v5
    v_accvgpr_write_b32 a62, v6
    v_xor_b32 v6, 0x80008000, v6
    v_accvgpr_write_b32 a94, v6
    v_fmamk_f32 v4, v11, 0x42680000, v12
    v_fmamk_f32 v5, v11, 0x426c0000, v12
    v_fract_f32 v4, v4
    v_fract_f32 v5, v5
    v_cos_f32 v4, v4
    v_cos_f32 v5, v5
    s_nop 0
    v_cvt_pk_bf16_f32 v6, v4, v5
    v_accvgpr_write_b32 a31, v6
    v_fmamk_f32 v4, v11, 0x42680000, v12
    v_fmamk_f32 v5, v11, 0x426c0000, v12
    v_fract_f32 v4, v4
    v_fract_f32 v5, v5
    v_sin_f32 v4, v4
    v_sin_f32 v5, v5
    s_nop 0
    v_cvt_pk_bf16_f32 v6, v4, v5
    v_accvgpr_write_b32 a63, v6
    v_xor_b32 v6, 0x80008000, v6
    v_accvgpr_write_b32 a95, v6
    s_mul_i32 s13, s21, 3641
    s_lshr_b32 s22, s13, 16
    s_mul_i32 s13, s22, 18
    s_sub_u32 s23, s21, s13
    v_bfe_u32 v4, v3, 2, 1
    v_lshlrev_b32 v4, 4, v4
    v_lshrrev_b32 v5, 3, v3
    v_lshl_add_u32 v4, v5, 2, v4
    v_and_b32 v5, 3, v3
    v_add_u32 v4, v4, v5
    s_lshl_b32 s13, s23, 5
    v_add_u32 v4, s13, v4
    v_cvt_f32_u32 v4, v4
    v_mul_f32 v11, 0x3ae38e39, v4
    v_mul_f32 v12, v13, v11
    v_add_f32 v9, 0.25, v12
    v_cmp_eq_u32 vcc, 0, v2
    v_mov_b32 v4, 1.0
    s_nop 0
    v_cndmask_b32 v8, v4, 0.5, vcc
    v_cndmask_b32 v10, 0, 0.5, vcc
    v_fmamk_f32 v4, v11, 0x00000000, v12
    v_fmamk_f32 v5, v11, 0x00000000, v9
    v_fract_f32 v4, v4
    v_fract_f32 v5, v5
    v_cos_f32 v4, v4
    v_cos_f32 v5, v5
    v_mul_f32 v4, v8, v4
    v_mul_f32 v5, v8, v5
    v_cvt_pk_bf16_f32 v6, v4, v5
    v_accvgpr_write_b32 a96, v6
    v_fmamk_f32 v4, v11, 0x3f800000, v12
    v_fmamk_f32 v5, v11, 0x3f800000, v9
    v_fract_f32 v4, v4
    v_fract_f32 v5, v5
    v_cos_f32 v4, v4
    v_cos_f32 v5, v5
    s_nop 0
    v_cvt_pk_bf16_f32 v6, v4, v5
    v_accvgpr_write_b32 a97, v6
    v_fmamk_f32 v4, v11, 0x40000000, v12
    v_fmamk_f32 v5, v11, 0x40000000, v9
    v_fract_f32 v4, v4
    v_fract_f32 v5, v5
    v_cos_f32 v4, v4
    v_cos_f32 v5, v5
    s_nop 0
    v_cvt_pk_bf16_f32 v6, v4, v5
    v_accvgpr_write_b32 a98, v6
    v_fmamk_f32 v4, v11, 0x40400000, v12
    v_fmamk_f32 v5, v11, 0x40400000, v9
    v_fract_f32 v4, v4
    v_fract_f32 v5, v5
    v_cos_f32 v4, v4
    v_cos_f32 v5, v5
    s_nop 0
    v_cvt_pk_bf16_f32 v6, v4, v5
    v_accvgpr_write_b32 a99, v6
    v_fmamk_f32 v4, v11, 0x41000000, v12
    v_fmamk_f32 v5, v11, 0x41000000, v9
    v_fract_f32 v4, v4
    v_fract_f32 v5, v5
    v_cos_f32 v4, v4
    v_cos_f32 v5, v5
    s_nop 0
    v_cvt_pk_bf16_f32 v6, v4, v5
    v_accvgpr_write_b32 a100, v6
    v_fmamk_f32 v4, v11, 0x41100000, v12
    v_fmamk_f32 v5, v11, 0x41100000, v9
    v_fract_f32 v4, v4
    v_fract_f32 v5, v5
    v_cos_f32 v4, v4
    v_cos_f32 v5, v5
    s_nop 0
    v_cvt_pk_bf16_f32 v6, v4, v5
    v_accvgpr_write_b32 a101, v6
    v_fmamk_f32 v4, v11, 0x41200000, v12
    v_fmamk_f32 v5, v11, 0x41200000, v9
    v_fract_f32 v4, v4
    v_fract_f32 v5, v5
    v_cos_f32 v4, v4
    v_cos_f32 v5, v5
    s_nop 0
    v_cvt_pk_bf16_f32 v6, v4, v5
    v_accvgpr_write_b32 a102, v6
    v_fmamk_f32 v4, v11, 0x41300000, v12
    v_fmamk_f32 v5, v11, 0x41300000, v9
    v_fract_f32 v4, v4
    v_fract_f32 v5, v5
    v_cos_f32 v4, v4
    v_cos_f32 v5, v5
    s_nop 0
    v_cvt_pk_bf16_f32 v6, v4, v5
    v_accvgpr_write_b32 a103, v6
    v_fmamk_f32 v4, v11, 0x41800000, v12
    v_fmamk_f32 v5, v11, 0x41800000, v9
    v_fract_f32 v4, v4
    v_fract_f32 v5, v5
    v_cos_f32 v4, v4
    v_cos_f32 v5, v5
    s_nop 0
    v_cvt_pk_bf16_f32 v6, v4, v5
    v_accvgpr_write_b32 a104, v6
    v_fmamk_f32 v4, v11, 0x41880000, v12
    v_fmamk_f32 v5, v11, 0x41880000, v9
    v_fract_f32 v4, v4
    v_fract_f32 v5, v5
    v_cos_f32 v4, v4
    v_cos_f32 v5, v5
    s_nop 0
    v_cvt_pk_bf16_f32 v6, v4, v5
    v_accvgpr_write_b32 a105, v6
    v_fmamk_f32 v4, v11, 0x41900000, v12
    v_fmamk_f32 v5, v11, 0x41900000, v9
    v_fract_f32 v4, v4
    v_fract_f32 v5, v5
    v_cos_f32 v4, v4
    v_cos_f32 v5, v5
    s_nop 0
    v_cvt_pk_bf16_f32 v6, v4, v5
    v_accvgpr_write_b32 a106, v6
    v_fmamk_f32 v4, v11, 0x41980000, v12
    v_fmamk_f32 v5, v11, 0x41980000, v9
    v_fract_f32 v4, v4
    v_fract_f32 v5, v5
    v_cos_f32 v4, v4
    v_cos_f32 v5, v5
    s_nop 0
    v_cvt_pk_bf16_f32 v6, v4, v5
    v_accvgpr_write_b32 a107, v6
    v_fmamk_f32 v4, v11, 0x41c00000, v12
    v_fmamk_f32 v5, v11, 0x41c00000, v9
    v_fract_f32 v4, v4
    v_fract_f32 v5, v5
    v_cos_f32 v4, v4
    v_cos_f32 v5, v5
    s_nop 0
    v_cvt_pk_bf16_f32 v6, v4, v5
    v_accvgpr_write_b32 a108, v6
    v_fmamk_f32 v4, v11, 0x41c80000, v12
    v_fmamk_f32 v5, v11, 0x41c80000, v9
    v_fract_f32 v4, v4
    v_fract_f32 v5, v5
    v_cos_f32 v4, v4
    v_cos_f32 v5, v5
    s_nop 0
    v_cvt_pk_bf16_f32 v6, v4, v5
    v_accvgpr_write_b32 a109, v6
    v_fmamk_f32 v4, v11, 0x41d00000, v12
    v_fmamk_f32 v5, v11, 0x41d00000, v9
    v_fract_f32 v4, v4
    v_fract_f32 v5, v5
    v_cos_f32 v4, v4
    v_cos_f32 v5, v5
    s_nop 0
    v_cvt_pk_bf16_f32 v6, v4, v5
    v_accvgpr_write_b32 a110, v6
    v_fmamk_f32 v4, v11, 0x41d80000, v12
    v_fmamk_f32 v5, v11, 0x41d80000, v9
    v_fract_f32 v4, v4
    v_fract_f32 v5, v5
    v_cos_f32 v4, v4
    v_cos_f32 v5, v5
    s_nop 0
    v_cvt_pk_bf16_f32 v6, v4, v5
    v_accvgpr_write_b32 a111, v6
    v_fmamk_f32 v4, v11, 0x42000000, v12
    v_fmamk_f32 v5, v11, 0x42000000, v9
    v_fract_f32 v4, v4
    v_fract_f32 v5, v5
    v_cos_f32 v4, v4
    v_cos_f32 v5, v5
    s_nop 0
    v_cvt_pk_bf16_f32 v6, v4, v5
    v_accvgpr_write_b32 a112, v6
    v_fmamk_f32 v4, v11, 0x42040000, v12
    v_fmamk_f32 v5, v11, 0x42040000, v9
    v_fract_f32 v4, v4
    v_fract_f32 v5, v5
    v_cos_f32 v4, v4
    v_cos_f32 v5, v5
    s_nop 0
    v_cvt_pk_bf16_f32 v6, v4, v5
    v_accvgpr_write_b32 a113, v6
    v_fmamk_f32 v4, v11, 0x42080000, v12
    v_fmamk_f32 v5, v11, 0x42080000, v9
    v_fract_f32 v4, v4
    v_fract_f32 v5, v5
    v_cos_f32 v4, v4
    v_cos_f32 v5, v5
    s_nop 0
    v_cvt_pk_bf16_f32 v6, v4, v5
    v_accvgpr_write_b32 a114, v6
    v_fmamk_f32 v4, v11, 0x420c0000, v12
    v_fmamk_f32 v5, v11, 0x420c0000, v9
    v_fract_f32 v4, v4
    v_fract_f32 v5, v5
    v_cos_f32 v4, v4
    v_cos_f32 v5, v5
    s_nop 0
    v_cvt_pk_bf16_f32 v6, v4, v5
    v_accvgpr_write_b32 a115, v6
    v_fmamk_f32 v4, v11, 0x42200000, v12
    v_fmamk_f32 v5, v11, 0x42200000, v9
    v_fract_f32 v4, v4
    v_fract_f32 v5, v5
    v_cos_f32 v4, v4
    v_cos_f32 v5, v5
    s_nop 0
    v_cvt_pk_bf16_f32 v6, v4, v5
    v_accvgpr_write_b32 a116, v6
    v_fmamk_f32 v4, v11, 0x42240000, v12
    v_fmamk_f32 v5, v11, 0x42240000, v9
    v_fract_f32 v4, v4
    v_fract_f32 v5, v5
    v_cos_f32 v4, v4
    v_cos_f32 v5, v5
    s_nop 0
    v_cvt_pk_bf16_f32 v6, v4, v5
    v_accvgpr_write_b32 a117, v6
    v_fmamk_f32 v4, v11, 0x42280000, v12
    v_fmamk_f32 v5, v11, 0x42280000, v9
    v_fract_f32 v4, v4
    v_fract_f32 v5, v5
    v_cos_f32 v4, v4
    v_cos_f32 v5, v5
    s_nop 0
    v_cvt_pk_bf16_f32 v6, v4, v5
    v_accvgpr_write_b32 a118, v6
    v_fmamk_f32 v4, v11, 0x422c0000, v12
    v_fmamk_f32 v5, v11, 0x422c0000, v9
    v_fract_f32 v4, v4
    v_fract_f32 v5, v5
    v_cos_f32 v4, v4
    v_cos_f32 v5, v5
    s_nop 0
    v_cvt_pk_bf16_f32 v6, v4, v5
    v_accvgpr_write_b32 a119, v6
    v_fmamk_f32 v4, v11, 0x42400000, v12
    v_fmamk_f32 v5, v11, 0x42400000, v9
    v_fract_f32 v4, v4
    v_fract_f32 v5, v5
    v_cos_f32 v4, v4
    v_cos_f32 v5, v5
    s_nop 0
    v_cvt_pk_bf16_f32 v6, v4, v5
    v_accvgpr_write_b32 a120, v6
    v_fmamk_f32 v4, v11, 0x42440000, v12
    v_fmamk_f32 v5, v11, 0x42440000, v9
    v_fract_f32 v4, v4
    v_fract_f32 v5, v5
    v_cos_f32 v4, v4
    v_cos_f32 v5, v5
    s_nop 0
    v_cvt_pk_bf16_f32 v6, v4, v5
    v_accvgpr_write_b32 a121, v6
    v_fmamk_f32 v4, v11, 0x42480000, v12
    v_fmamk_f32 v5, v11, 0x42480000, v9
    v_fract_f32 v4, v4
    v_fract_f32 v5, v5
    v_cos_f32 v4, v4
    v_cos_f32 v5, v5
    s_nop 0
    v_cvt_pk_bf16_f32 v6, v4, v5
    v_accvgpr_write_b32 a122, v6
    v_fmamk_f32 v4, v11, 0x424c0000, v12
    v_fmamk_f32 v5, v11, 0x424c0000, v9
    v_fract_f32 v4, v4
    v_fract_f32 v5, v5
    v_cos_f32 v4, v4
    v_cos_f32 v5, v5
    s_nop 0
    v_cvt_pk_bf16_f32 v6, v4, v5
    v_accvgpr_write_b32 a123, v6
    v_fmamk_f32 v4, v11, 0x42600000, v12
    v_fmamk_f32 v5, v11, 0x42600000, v9
    v_fract_f32 v4, v4
    v_fract_f32 v5, v5
    v_cos_f32 v4, v4
    v_cos_f32 v5, v5
    s_nop 0
    v_cvt_pk_bf16_f32 v6, v4, v5
    v_accvgpr_write_b32 a124, v6
    v_fmamk_f32 v4, v11, 0x42640000, v12
    v_fmamk_f32 v5, v11, 0x42640000, v9
    v_fract_f32 v4, v4
    v_fract_f32 v5, v5
    v_cos_f32 v4, v4
    v_cos_f32 v5, v5
    s_nop 0
    v_cvt_pk_bf16_f32 v6, v4, v5
    v_accvgpr_write_b32 a125, v6
    v_fmamk_f32 v4, v11, 0x42680000, v12
    v_fmamk_f32 v5, v11, 0x42680000, v9
    v_fract_f32 v4, v4
    v_fract_f32 v5, v5
    v_cos_f32 v4, v4
    v_cos_f32 v5, v5
    s_nop 0
    v_cvt_pk_bf16_f32 v6, v4, v5
    v_accvgpr_write_b32 a126, v6
    v_fmamk_f32 v4, v11, 0x426c0000, v12
    v_fmamk_f32 v5, v11, 0x426c0000, v9
    v_fract_f32 v4, v4
    v_fract_f32 v5, v5
    v_cos_f32 v4, v4
    v_cos_f32 v5, v5
    s_nop 0
    v_cvt_pk_bf16_f32 v6, v4, v5
    v_accvgpr_write_b32 a127, v6
    v_fmamk_f32 v4, v11, 0x42800000, v12
    v_fmamk_f32 v5, v11, 0x42800000, v9
    v_fract_f32 v4, v4
    v_fract_f32 v5, v5
    v_cos_f32 v4, v4
    v_cos_f32 v5, v5
    s_nop 0
    v_cvt_pk_bf16_f32 v6, v4, v5
    v_accvgpr_write_b32 a128, v6
    v_fmamk_f32 v4, v11, 0x42820000, v12
    v_fmamk_f32 v5, v11, 0x42820000, v9
    v_fract_f32 v4, v4
    v_fract_f32 v5, v5
    v_cos_f32 v4, v4
    v_cos_f32 v5, v5
    s_nop 0
    v_cvt_pk_bf16_f32 v6, v4, v5
    v_accvgpr_write_b32 a129, v6
    v_fmamk_f32 v4, v11, 0x42840000, v12
    v_fmamk_f32 v5, v11, 0x42840000, v9
    v_fract_f32 v4, v4
    v_fract_f32 v5, v5
    v_cos_f32 v4, v4
    v_cos_f32 v5, v5
    s_nop 0
    v_cvt_pk_bf16_f32 v6, v4, v5
    v_accvgpr_write_b32 a130, v6
    v_fmamk_f32 v4, v11, 0x42860000, v12
    v_fmamk_f32 v5, v11, 0x42860000, v9
    v_fract_f32 v4, v4
    v_fract_f32 v5, v5
    v_cos_f32 v4, v4
    v_cos_f32 v5, v5
    s_nop 0
    v_cvt_pk_bf16_f32 v6, v4, v5
    v_accvgpr_write_b32 a131, v6
    v_fmamk_f32 v4, v11, 0x42900000, v12
    v_fmamk_f32 v5, v11, 0x42900000, v9
    v_fract_f32 v4, v4
    v_fract_f32 v5, v5
    v_cos_f32 v4, v4
    v_cos_f32 v5, v5
    s_nop 0
    v_cvt_pk_bf16_f32 v6, v4, v5
    v_accvgpr_write_b32 a132, v6
    v_fmamk_f32 v4, v11, 0x42920000, v12
    v_fmamk_f32 v5, v11, 0x42920000, v9
    v_fract_f32 v4, v4
    v_fract_f32 v5, v5
    v_cos_f32 v4, v4
    v_cos_f32 v5, v5
    s_nop 0
    v_cvt_pk_bf16_f32 v6, v4, v5
    v_accvgpr_write_b32 a133, v6
    v_fmamk_f32 v4, v11, 0x42940000, v12
    v_fmamk_f32 v5, v11, 0x42940000, v9
    v_fract_f32 v4, v4
    v_fract_f32 v5, v5
    v_cos_f32 v4, v4
    v_cos_f32 v5, v5
    s_nop 0
    v_cvt_pk_bf16_f32 v6, v4, v5
    v_accvgpr_write_b32 a134, v6
    v_fmamk_f32 v4, v11, 0x42960000, v12
    v_fmamk_f32 v5, v11, 0x42960000, v9
    v_fract_f32 v4, v4
    v_fract_f32 v5, v5
    v_cos_f32 v4, v4
    v_cos_f32 v5, v5
    s_nop 0
    v_cvt_pk_bf16_f32 v6, v4, v5
    v_accvgpr_write_b32 a135, v6
    v_fmamk_f32 v4, v11, 0x42a00000, v12
    v_fmamk_f32 v5, v11, 0x42a00000, v9
    v_fract_f32 v4, v4
    v_fract_f32 v5, v5
    v_cos_f32 v4, v4
    v_cos_f32 v5, v5
    s_nop 0
    v_cvt_pk_bf16_f32 v6, v4, v5
    v_accvgpr_write_b32 a136, v6
    v_fmamk_f32 v4, v11, 0x42a20000, v12
    v_fmamk_f32 v5, v11, 0x42a20000, v9
    v_fract_f32 v4, v4
    v_fract_f32 v5, v5
    v_cos_f32 v4, v4
    v_cos_f32 v5, v5
    s_nop 0
    v_cvt_pk_bf16_f32 v6, v4, v5
    v_accvgpr_write_b32 a137, v6
    v_fmamk_f32 v4, v11, 0x42a40000, v12
    v_fmamk_f32 v5, v11, 0x42a40000, v9
    v_fract_f32 v4, v4
    v_fract_f32 v5, v5
    v_cos_f32 v4, v4
    v_cos_f32 v5, v5
    s_nop 0
    v_cvt_pk_bf16_f32 v6, v4, v5
    v_accvgpr_write_b32 a138, v6
    v_fmamk_f32 v4, v11, 0x42a60000, v12
    v_fmamk_f32 v5, v11, 0x42a60000, v9
    v_fract_f32 v4, v4
    v_fract_f32 v5, v5
    v_cos_f32 v4, v4
    v_cos_f32 v5, v5
    s_nop 0
    v_cvt_pk_bf16_f32 v6, v4, v5
    v_accvgpr_write_b32 a139, v6
    v_fmamk_f32 v4, v11, 0x42b00000, v12
    v_fmamk_f32 v5, v11, 0x42b00000, v9
    v_fract_f32 v4, v4
    v_fract_f32 v5, v5
    v_cos_f32 v4, v4
    v_cos_f32 v5, v5
    s_nop 0
    v_cvt_pk_bf16_f32 v6, v4, v5
    v_accvgpr_write_b32 a140, v6
    v_fmamk_f32 v4, v11, 0x42b20000, v12
    v_fmamk_f32 v5, v11, 0x42b20000, v9
    v_fract_f32 v4, v4
    v_fract_f32 v5, v5
    v_cos_f32 v4, v4
    v_cos_f32 v5, v5
    s_nop 0
    v_cvt_pk_bf16_f32 v6, v4, v5
    v_accvgpr_write_b32 a141, v6
    v_fmamk_f32 v4, v11, 0x42b40000, v12
    v_fmamk_f32 v5, v11, 0x42b40000, v9
    v_fract_f32 v4, v4
    v_fract_f32 v5, v5
    v_cos_f32 v4, v4
    v_cos_f32 v5, v5
    s_nop 0
    v_cvt_pk_bf16_f32 v6, v4, v5
    v_accvgpr_write_b32 a142, v6
    v_fmamk_f32 v4, v11, 0x42b60000, v12
    v_fmamk_f32 v5, v11, 0x42b60000, v9
    v_fract_f32 v4, v4
    v_fract_f32 v5, v5
    v_cos_f32 v4, v4
    v_cos_f32 v5, v5
    s_nop 0
    v_cvt_pk_bf16_f32 v6, v4, v5
    v_accvgpr_write_b32 a143, v6
    v_fmamk_f32 v4, v11, 0x42c00000, v12
    v_fmamk_f32 v5, v11, 0x42c00000, v9
    v_fract_f32 v4, v4
    v_fract_f32 v5, v5
    v_cos_f32 v4, v4
    v_cos_f32 v5, v5
    s_nop 0
    v_cvt_pk_bf16_f32 v6, v4, v5
    v_accvgpr_write_b32 a144, v6
    v_fmamk_f32 v4, v11, 0x42c20000, v12
    v_fmamk_f32 v5, v11, 0x42c20000, v9
    v_fract_f32 v4, v4
    v_fract_f32 v5, v5
    v_cos_f32 v4, v4
    v_cos_f32 v5, v5
    s_nop 0
    v_cvt_pk_bf16_f32 v6, v4, v5
    v_accvgpr_write_b32 a145, v6
    v_fmamk_f32 v4, v11, 0x42c40000, v12
    v_fmamk_f32 v5, v11, 0x42c40000, v9
    v_fract_f32 v4, v4
    v_fract_f32 v5, v5
    v_cos_f32 v4, v4
    v_cos_f32 v5, v5
    s_nop 0
    v_cvt_pk_bf16_f32 v6, v4, v5
    v_accvgpr_write_b32 a146, v6
    v_fmamk_f32 v4, v11, 0x42c60000, v12
    v_fmamk_f32 v5, v11, 0x42c60000, v9
    v_fract_f32 v4, v4
    v_fract_f32 v5, v5
    v_cos_f32 v4, v4
    v_cos_f32 v5, v5
    s_nop 0
    v_cvt_pk_bf16_f32 v6, v4, v5
    v_accvgpr_write_b32 a147, v6
    v_fmamk_f32 v4, v11, 0x42d00000, v12
    v_fmamk_f32 v5, v11, 0x42d00000, v9
    v_fract_f32 v4, v4
    v_fract_f32 v5, v5
    v_cos_f32 v4, v4
    v_cos_f32 v5, v5
    s_nop 0
    v_cvt_pk_bf16_f32 v6, v4, v5
    v_accvgpr_write_b32 a148, v6
    v_fmamk_f32 v4, v11, 0x42d20000, v12
    v_fmamk_f32 v5, v11, 0x42d20000, v9
    v_fract_f32 v4, v4
    v_fract_f32 v5, v5
    v_cos_f32 v4, v4
    v_cos_f32 v5, v5
    s_nop 0
    v_cvt_pk_bf16_f32 v6, v4, v5
    v_accvgpr_write_b32 a149, v6
    v_fmamk_f32 v4, v11, 0x42d40000, v12
    v_fmamk_f32 v5, v11, 0x42d40000, v9
    v_fract_f32 v4, v4
    v_fract_f32 v5, v5
    v_cos_f32 v4, v4
    v_cos_f32 v5, v5
    s_nop 0
    v_cvt_pk_bf16_f32 v6, v4, v5
    v_accvgpr_write_b32 a150, v6
    v_fmamk_f32 v4, v11, 0x42d60000, v12
    v_fmamk_f32 v5, v11, 0x42d60000, v9
    v_fract_f32 v4, v4
    v_fract_f32 v5, v5
    v_cos_f32 v4, v4
    v_cos_f32 v5, v5
    s_nop 0
    v_cvt_pk_bf16_f32 v6, v4, v5
    v_accvgpr_write_b32 a151, v6
    v_fmamk_f32 v4, v11, 0x42e00000, v12
    v_fmamk_f32 v5, v11, 0x42e00000, v9
    v_fract_f32 v4, v4
    v_fract_f32 v5, v5
    v_cos_f32 v4, v4
    v_cos_f32 v5, v5
    s_nop 0
    v_cvt_pk_bf16_f32 v6, v4, v5
    v_accvgpr_write_b32 a152, v6
    v_fmamk_f32 v4, v11, 0x42e20000, v12
    v_fmamk_f32 v5, v11, 0x42e20000, v9
    v_fract_f32 v4, v4
    v_fract_f32 v5, v5
    v_cos_f32 v4, v4
    v_cos_f32 v5, v5
    s_nop 0
    v_cvt_pk_bf16_f32 v6, v4, v5
    v_accvgpr_write_b32 a153, v6
    v_fmamk_f32 v4, v11, 0x42e40000, v12
    v_fmamk_f32 v5, v11, 0x42e40000, v9
    v_fract_f32 v4, v4
    v_fract_f32 v5, v5
    v_cos_f32 v4, v4
    v_cos_f32 v5, v5
    s_nop 0
    v_cvt_pk_bf16_f32 v6, v4, v5
    v_accvgpr_write_b32 a154, v6
    v_fmamk_f32 v4, v11, 0x42e60000, v12
    v_fmamk_f32 v5, v11, 0x42e60000, v9
    v_fract_f32 v4, v4
    v_fract_f32 v5, v5
    v_cos_f32 v4, v4
    v_cos_f32 v5, v5
    s_nop 0
    v_cvt_pk_bf16_f32 v6, v4, v5
    v_accvgpr_write_b32 a155, v6
    v_fmamk_f32 v4, v11, 0x42f00000, v12
    v_fmamk_f32 v5, v11, 0x42f00000, v9
    v_fract_f32 v4, v4
    v_fract_f32 v5, v5
    v_cos_f32 v4, v4
    v_cos_f32 v5, v5
    s_nop 0
    v_cvt_pk_bf16_f32 v6, v4, v5
    v_accvgpr_write_b32 a156, v6
    v_fmamk_f32 v4, v11, 0x42f20000, v12
    v_fmamk_f32 v5, v11, 0x42f20000, v9
    v_fract_f32 v4, v4
    v_fract_f32 v5, v5
    v_cos_f32 v4, v4
    v_cos_f32 v5, v5
    s_nop 0
    v_cvt_pk_bf16_f32 v6, v4, v5
    v_accvgpr_write_b32 a157, v6
    v_fmamk_f32 v4, v11, 0x42f40000, v12
    v_fmamk_f32 v5, v11, 0x42f40000, v9
    v_fract_f32 v4, v4
    v_fract_f32 v5, v5
    v_cos_f32 v4, v4
    v_cos_f32 v5, v5
    s_nop 0
    v_cvt_pk_bf16_f32 v6, v4, v5
    v_accvgpr_write_b32 a158, v6
    v_fmamk_f32 v4, v11, 0x42f60000, v12
    v_fmamk_f32 v5, v11, 0x42f60000, v9
    v_fract_f32 v4, v4
    v_fract_f32 v5, v5
    v_cos_f32 v4, v4
    v_cos_f32 v5, v5
    s_nop 0
    v_cvt_pk_bf16_f32 v6, v4, v5
    v_accvgpr_write_b32 a159, v6
    v_fmamk_f32 v4, v11, 0x43000000, v12
    v_fmamk_f32 v5, v11, 0x43000000, v9
    v_fract_f32 v4, v4
    v_fract_f32 v5, v5
    v_cos_f32 v4, v4
    v_cos_f32 v5, v5
    s_nop 0
    v_cvt_pk_bf16_f32 v6, v4, v5
    v_accvgpr_write_b32 a160, v6
    v_fmamk_f32 v4, v11, 0x43010000, v12
    v_fmamk_f32 v5, v11, 0x43010000, v9
    v_fract_f32 v4, v4
    v_fract_f32 v5, v5
    v_cos_f32 v4, v4
    v_cos_f32 v5, v5
    s_nop 0
    v_cvt_pk_bf16_f32 v6, v4, v5
    v_accvgpr_write_b32 a161, v6
    v_fmamk_f32 v4, v11, 0x43020000, v12
    v_fmamk_f32 v5, v11, 0x43020000, v9
    v_fract_f32 v4, v4
    v_fract_f32 v5, v5
    v_cos_f32 v4, v4
    v_cos_f32 v5, v5
    s_nop 0
    v_cvt_pk_bf16_f32 v6, v4, v5
    v_accvgpr_write_b32 a162, v6
    v_fmamk_f32 v4, v11, 0x43030000, v12
    v_fmamk_f32 v5, v11, 0x43030000, v9
    v_fract_f32 v4, v4
    v_fract_f32 v5, v5
    v_cos_f32 v4, v4
    v_cos_f32 v5, v5
    s_nop 0
    v_cvt_pk_bf16_f32 v6, v4, v5
    v_accvgpr_write_b32 a163, v6
    v_fmamk_f32 v4, v11, 0x43080000, v12
    v_fmamk_f32 v5, v11, 0x43080000, v9
    v_fract_f32 v4, v4
    v_fract_f32 v5, v5
    v_cos_f32 v4, v4
    v_cos_f32 v5, v5
    s_nop 0
    v_cvt_pk_bf16_f32 v6, v4, v5
    v_accvgpr_write_b32 a164, v6
    v_fmamk_f32 v4, v11, 0x43090000, v12
    v_fmamk_f32 v5, v11, 0x43090000, v9
    v_fract_f32 v4, v4
    v_fract_f32 v5, v5
    v_cos_f32 v4, v4
    v_cos_f32 v5, v5
    s_nop 0
    v_cvt_pk_bf16_f32 v6, v4, v5
    v_accvgpr_write_b32 a165, v6
    v_fmamk_f32 v4, v11, 0x430a0000, v12
    v_fmamk_f32 v5, v11, 0x430a0000, v9
    v_fract_f32 v4, v4
    v_fract_f32 v5, v5
    v_cos_f32 v4, v4
    v_cos_f32 v5, v5
    s_nop 0
    v_cvt_pk_bf16_f32 v6, v4, v5
    v_accvgpr_write_b32 a166, v6
    v_fmamk_f32 v4, v11, 0x430b0000, v12
    v_fmamk_f32 v5, v11, 0x430b0000, v9
    v_fract_f32 v4, v4
    v_fract_f32 v5, v5
    v_cos_f32 v4, v4
    v_cos_f32 v5, v5
    s_nop 0
    v_cvt_pk_bf16_f32 v6, v4, v5
    v_accvgpr_write_b32 a167, v6
    v_fmamk_f32 v4, v11, 0x43100000, v12
    v_fmamk_f32 v5, v11, 0x43100000, v9
    v_fract_f32 v4, v4
    v_fract_f32 v5, v5
    v_cos_f32 v4, v4
    v_cos_f32 v5, v5
    s_nop 0
    v_cvt_pk_bf16_f32 v6, v4, v5
    v_accvgpr_write_b32 a168, v6
    v_fmamk_f32 v4, v11, 0x43110000, v12
    v_fmamk_f32 v5, v11, 0x43110000, v9
    v_fract_f32 v4, v4
    v_fract_f32 v5, v5
    v_cos_f32 v4, v4
    v_cos_f32 v5, v5
    s_nop 0
    v_cvt_pk_bf16_f32 v6, v4, v5
    v_accvgpr_write_b32 a169, v6
    v_fmamk_f32 v4, v11, 0x43120000, v12
    v_fmamk_f32 v5, v11, 0x43120000, v9
    v_fract_f32 v4, v4
    v_fract_f32 v5, v5
    v_cos_f32 v4, v4
    v_cos_f32 v5, v5
    s_nop 0
    v_cvt_pk_bf16_f32 v6, v4, v5
    v_accvgpr_write_b32 a170, v6
    v_fmamk_f32 v4, v11, 0x43130000, v12
    v_fmamk_f32 v5, v11, 0x43130000, v9
    v_fract_f32 v4, v4
    v_fract_f32 v5, v5
    v_cos_f32 v4, v4
    v_cos_f32 v5, v5
    s_nop 0
    v_cvt_pk_bf16_f32 v6, v4, v5
    v_accvgpr_write_b32 a171, v6
    v_fmamk_f32 v4, v11, 0x43180000, v12
    v_fmamk_f32 v5, v11, 0x43180000, v9
    v_fract_f32 v4, v4
    v_fract_f32 v5, v5
    v_cos_f32 v4, v4
    v_cos_f32 v5, v5
    s_nop 0
    v_cvt_pk_bf16_f32 v6, v4, v5
    v_accvgpr_write_b32 a172, v6
    v_fmamk_f32 v4, v11, 0x43190000, v12
    v_fmamk_f32 v5, v11, 0x43190000, v9
    v_fract_f32 v4, v4
    v_fract_f32 v5, v5
    v_cos_f32 v4, v4
    v_cos_f32 v5, v5
    s_nop 0
    v_cvt_pk_bf16_f32 v6, v4, v5
    v_accvgpr_write_b32 a173, v6
    v_fmamk_f32 v4, v11, 0x431a0000, v12
    v_fmamk_f32 v5, v11, 0x431a0000, v9
    v_fract_f32 v4, v4
    v_fract_f32 v5, v5
    v_cos_f32 v4, v4
    v_cos_f32 v5, v5
    s_nop 0
    v_cvt_pk_bf16_f32 v6, v4, v5
    v_accvgpr_write_b32 a174, v6
    v_fmamk_f32 v4, v11, 0x431b0000, v12
    v_fmamk_f32 v5, v11, 0x431b0000, v9
    v_fract_f32 v4, v4
    v_fract_f32 v5, v5
    v_cos_f32 v4, v4
    v_cos_f32 v5, v5
    s_nop 0
    v_cvt_pk_bf16_f32 v6, v4, v5
    v_accvgpr_write_b32 a175, v6
    v_fmamk_f32 v4, v11, 0x43200000, v12
    v_fmamk_f32 v5, v11, 0x43200000, v9
    v_fract_f32 v4, v4
    v_fract_f32 v5, v5
    v_cos_f32 v4, v4
    v_cos_f32 v5, v5
    s_nop 0
    v_cvt_pk_bf16_f32 v6, v4, v5
    v_accvgpr_write_b32 a176, v6
    v_fmamk_f32 v4, v11, 0x43210000, v12
    v_fmamk_f32 v5, v11, 0x43210000, v9
    v_fract_f32 v4, v4
    v_fract_f32 v5, v5
    v_cos_f32 v4, v4
    v_cos_f32 v5, v5
    s_nop 0
    v_cvt_pk_bf16_f32 v6, v4, v5
    v_accvgpr_write_b32 a177, v6
    v_fmamk_f32 v4, v11, 0x43220000, v12
    v_fmamk_f32 v5, v11, 0x43220000, v9
    v_fract_f32 v4, v4
    v_fract_f32 v5, v5
    v_cos_f32 v4, v4
    v_cos_f32 v5, v5
    s_nop 0
    v_cvt_pk_bf16_f32 v6, v4, v5
    v_accvgpr_write_b32 a178, v6
    v_fmamk_f32 v4, v11, 0x43230000, v12
    v_fmamk_f32 v5, v11, 0x43230000, v9
    v_fract_f32 v4, v4
    v_fract_f32 v5, v5
    v_cos_f32 v4, v4
    v_cos_f32 v5, v5
    s_nop 0
    v_cvt_pk_bf16_f32 v6, v4, v5
    v_accvgpr_write_b32 a179, v6
    v_fmamk_f32 v4, v11, 0x43280000, v12
    v_fmamk_f32 v5, v11, 0x43280000, v9
    v_fract_f32 v4, v4
    v_fract_f32 v5, v5
    v_cos_f32 v4, v4
    v_cos_f32 v5, v5
    s_nop 0
    v_cvt_pk_bf16_f32 v6, v4, v5
    v_accvgpr_write_b32 a180, v6
    v_fmamk_f32 v4, v11, 0x43290000, v12
    v_fmamk_f32 v5, v11, 0x43290000, v9
    v_fract_f32 v4, v4
    v_fract_f32 v5, v5
    v_cos_f32 v4, v4
    v_cos_f32 v5, v5
    s_nop 0
    v_cvt_pk_bf16_f32 v6, v4, v5
    v_accvgpr_write_b32 a181, v6
    v_fmamk_f32 v4, v11, 0x432a0000, v12
    v_fmamk_f32 v5, v11, 0x432a0000, v9
    v_fract_f32 v4, v4
    v_fract_f32 v5, v5
    v_cos_f32 v4, v4
    v_cos_f32 v5, v5
    s_nop 0
    v_cvt_pk_bf16_f32 v6, v4, v5
    v_accvgpr_write_b32 a182, v6
    v_fmamk_f32 v4, v11, 0x432b0000, v12
    v_fmamk_f32 v5, v11, 0x432b0000, v9
    v_fract_f32 v4, v4
    v_fract_f32 v5, v5
    v_cos_f32 v4, v4
    v_cos_f32 v5, v5
    s_nop 0
    v_cvt_pk_bf16_f32 v6, v4, v5
    v_accvgpr_write_b32 a183, v6
    v_fmamk_f32 v4, v11, 0x43300000, v12
    v_fmamk_f32 v5, v11, 0x43300000, v9
    v_fract_f32 v4, v4
    v_fract_f32 v5, v5
    v_cos_f32 v4, v4
    v_cos_f32 v5, v5
    s_nop 0
    v_cvt_pk_bf16_f32 v6, v4, v5
    v_accvgpr_write_b32 a184, v6
    v_fmamk_f32 v4, v11, 0x43310000, v12
    v_fmamk_f32 v5, v11, 0x43310000, v9
    v_fract_f32 v4, v4
    v_fract_f32 v5, v5
    v_cos_f32 v4, v4
    v_cos_f32 v5, v5
    s_nop 0
    v_cvt_pk_bf16_f32 v6, v4, v5
    v_accvgpr_write_b32 a185, v6
    v_fmamk_f32 v4, v11, 0x43320000, v12
    v_fmamk_f32 v5, v11, 0x43320000, v9
    v_fract_f32 v4, v4
    v_fract_f32 v5, v5
    v_cos_f32 v4, v4
    v_cos_f32 v5, v5
    s_nop 0
    v_cvt_pk_bf16_f32 v6, v4, v5
    v_accvgpr_write_b32 a186, v6
    v_fmamk_f32 v4, v11, 0x43330000, v12
    v_fmamk_f32 v5, v11, 0x43330000, v9
    v_fract_f32 v4, v4
    v_fract_f32 v5, v5
    v_cos_f32 v4, v4
    v_cos_f32 v5, v5
    s_nop 0
    v_cvt_pk_bf16_f32 v6, v4, v5
    v_accvgpr_write_b32 a187, v6
    v_fmamk_f32 v4, v11, 0x43380000, v12
    v_fmamk_f32 v5, v11, 0x43380000, v9
    v_fract_f32 v4, v4
    v_fract_f32 v5, v5
    v_cos_f32 v4, v4
    v_cos_f32 v5, v5
    s_nop 0
    v_cvt_pk_bf16_f32 v6, v4, v5
    v_accvgpr_write_b32 a188, v6
    v_fmamk_f32 v4, v11, 0x43390000, v12
    v_fmamk_f32 v5, v11, 0x43390000, v9
    v_fract_f32 v4, v4
    v_fract_f32 v5, v5
    v_cos_f32 v4, v4
    v_cos_f32 v5, v5
    s_nop 0
    v_cvt_pk_bf16_f32 v6, v4, v5
    v_accvgpr_write_b32 a189, v6
    v_fmamk_f32 v4, v11, 0x433a0000, v12
    v_fmamk_f32 v5, v11, 0x433a0000, v9
    v_fract_f32 v4, v4
    v_fract_f32 v5, v5
    v_cos_f32 v4, v4
    v_cos_f32 v5, v5
    s_nop 0
    v_cvt_pk_bf16_f32 v6, v4, v5
    v_accvgpr_write_b32 a190, v6
    v_fmamk_f32 v4, v11, 0x433b0000, v12
    v_fmamk_f32 v5, v11, 0x433b0000, v9
    v_fract_f32 v4, v4
    v_fract_f32 v5, v5
    v_cos_f32 v4, v4
    v_cos_f32 v5, v5
    s_nop 0
    v_cvt_pk_bf16_f32 v6, v4, v5
    v_accvgpr_write_b32 a191, v6
    v_fmamk_f32 v4, v11, 0x43400000, v12
    v_fmamk_f32 v5, v11, 0x43400000, v9
    v_fract_f32 v4, v4
    v_fract_f32 v5, v5
    v_cos_f32 v4, v4
    v_cos_f32 v5, v5
    s_nop 0
    v_cvt_pk_bf16_f32 v6, v4, v5
    v_accvgpr_write_b32 a192, v6
    v_fmamk_f32 v4, v11, 0x43410000, v12
    v_fmamk_f32 v5, v11, 0x43410000, v9
    v_fract_f32 v4, v4
    v_fract_f32 v5, v5
    v_cos_f32 v4, v4
    v_cos_f32 v5, v5
    s_nop 0
    v_cvt_pk_bf16_f32 v6, v4, v5
    v_accvgpr_write_b32 a193, v6
    v_fmamk_f32 v4, v11, 0x43420000, v12
    v_fmamk_f32 v5, v11, 0x43420000, v9
    v_fract_f32 v4, v4
    v_fract_f32 v5, v5
    v_cos_f32 v4, v4
    v_cos_f32 v5, v5
    s_nop 0
    v_cvt_pk_bf16_f32 v6, v4, v5
    v_accvgpr_write_b32 a194, v6
    v_fmamk_f32 v4, v11, 0x43430000, v12
    v_fmamk_f32 v5, v11, 0x43430000, v9
    v_fract_f32 v4, v4
    v_fract_f32 v5, v5
    v_cos_f32 v4, v4
    v_cos_f32 v5, v5
    s_nop 0
    v_cvt_pk_bf16_f32 v6, v4, v5
    v_accvgpr_write_b32 a195, v6
    v_fmamk_f32 v4, v11, 0x43480000, v12
    v_fmamk_f32 v5, v11, 0x43480000, v9
    v_fract_f32 v4, v4
    v_fract_f32 v5, v5
    v_cos_f32 v4, v4
    v_cos_f32 v5, v5
    s_nop 0
    v_cvt_pk_bf16_f32 v6, v4, v5
    v_accvgpr_write_b32 a196, v6
    v_fmamk_f32 v4, v11, 0x43490000, v12
    v_fmamk_f32 v5, v11, 0x43490000, v9
    v_fract_f32 v4, v4
    v_fract_f32 v5, v5
    v_cos_f32 v4, v4
    v_cos_f32 v5, v5
    s_nop 0
    v_cvt_pk_bf16_f32 v6, v4, v5
    v_accvgpr_write_b32 a197, v6
    v_fmamk_f32 v4, v11, 0x434a0000, v12
    v_fmamk_f32 v5, v11, 0x434a0000, v9
    v_fract_f32 v4, v4
    v_fract_f32 v5, v5
    v_cos_f32 v4, v4
    v_cos_f32 v5, v5
    s_nop 0
    v_cvt_pk_bf16_f32 v6, v4, v5
    v_accvgpr_write_b32 a198, v6
    v_fmamk_f32 v4, v11, 0x434b0000, v12
    v_fmamk_f32 v5, v11, 0x434b0000, v9
    v_fract_f32 v4, v4
    v_fract_f32 v5, v5
    v_cos_f32 v4, v4
    v_cos_f32 v5, v5
    s_nop 0
    v_cvt_pk_bf16_f32 v6, v4, v5
    v_accvgpr_write_b32 a199, v6
    v_fmamk_f32 v4, v11, 0x43500000, v12
    v_fmamk_f32 v5, v11, 0x43500000, v9
    v_fract_f32 v4, v4
    v_fract_f32 v5, v5
    v_cos_f32 v4, v4
    v_cos_f32 v5, v5
    s_nop 0
    v_cvt_pk_bf16_f32 v6, v4, v5
    v_accvgpr_write_b32 a200, v6
    v_fmamk_f32 v4, v11, 0x43510000, v12
    v_fmamk_f32 v5, v11, 0x43510000, v9
    v_fract_f32 v4, v4
    v_fract_f32 v5, v5
    v_cos_f32 v4, v4
    v_cos_f32 v5, v5
    s_nop 0
    v_cvt_pk_bf16_f32 v6, v4, v5
    v_accvgpr_write_b32 a201, v6
    v_fmamk_f32 v4, v11, 0x43520000, v12
    v_fmamk_f32 v5, v11, 0x43520000, v9
    v_fract_f32 v4, v4
    v_fract_f32 v5, v5
    v_cos_f32 v4, v4
    v_cos_f32 v5, v5
    s_nop 0
    v_cvt_pk_bf16_f32 v6, v4, v5
    v_accvgpr_write_b32 a202, v6
    v_fmamk_f32 v4, v11, 0x43530000, v12
    v_fmamk_f32 v5, v11, 0x43530000, v9
    v_fract_f32 v4, v4
    v_fract_f32 v5, v5
    v_cos_f32 v4, v4
    v_cos_f32 v5, v5
    s_nop 0
    v_cvt_pk_bf16_f32 v6, v4, v5
    v_accvgpr_write_b32 a203, v6
    v_fmamk_f32 v4, v11, 0x43580000, v12
    v_fmamk_f32 v5, v11, 0x43580000, v9
    v_fract_f32 v4, v4
    v_fract_f32 v5, v5
    v_cos_f32 v4, v4
    v_cos_f32 v5, v5
    s_nop 0
    v_cvt_pk_bf16_f32 v6, v4, v5
    v_accvgpr_write_b32 a204, v6
    v_fmamk_f32 v4, v11, 0x43590000, v12
    v_fmamk_f32 v5, v11, 0x43590000, v9
    v_fract_f32 v4, v4
    v_fract_f32 v5, v5
    v_cos_f32 v4, v4
    v_cos_f32 v5, v5
    s_nop 0
    v_cvt_pk_bf16_f32 v6, v4, v5
    v_accvgpr_write_b32 a205, v6
    v_fmamk_f32 v4, v11, 0x435a0000, v12
    v_fmamk_f32 v5, v11, 0x435a0000, v9
    v_fract_f32 v4, v4
    v_fract_f32 v5, v5
    v_cos_f32 v4, v4
    v_cos_f32 v5, v5
    s_nop 0
    v_cvt_pk_bf16_f32 v6, v4, v5
    v_accvgpr_write_b32 a206, v6
    v_fmamk_f32 v4, v11, 0x435b0000, v12
    v_fmamk_f32 v5, v11, 0x435b0000, v9
    v_fract_f32 v4, v4
    v_fract_f32 v5, v5
    v_cos_f32 v4, v4
    v_cos_f32 v5, v5
    s_nop 0
    v_cvt_pk_bf16_f32 v6, v4, v5
    v_accvgpr_write_b32 a207, v6
    v_fmamk_f32 v4, v11, 0x43600000, v12
    v_fmamk_f32 v5, v11, 0x43600000, v9
    v_fract_f32 v4, v4
    v_fract_f32 v5, v5
    v_cos_f32 v4, v4
    v_cos_f32 v5, v5
    s_nop 0
    v_cvt_pk_bf16_f32 v6, v4, v5
    v_accvgpr_write_b32 a208, v6
    v_fmamk_f32 v4, v11, 0x43610000, v12
    v_fmamk_f32 v5, v11, 0x43610000, v9
    v_fract_f32 v4, v4
    v_fract_f32 v5, v5
    v_cos_f32 v4, v4
    v_cos_f32 v5, v5
    s_nop 0
    v_cvt_pk_bf16_f32 v6, v4, v5
    v_accvgpr_write_b32 a209, v6
    v_fmamk_f32 v4, v11, 0x43620000, v12
    v_fmamk_f32 v5, v11, 0x43620000, v9
    v_fract_f32 v4, v4
    v_fract_f32 v5, v5
    v_cos_f32 v4, v4
    v_cos_f32 v5, v5
    s_nop 0
    v_cvt_pk_bf16_f32 v6, v4, v5
    v_accvgpr_write_b32 a210, v6
    v_fmamk_f32 v4, v11, 0x43630000, v12
    v_fmamk_f32 v5, v11, 0x43630000, v9
    v_fract_f32 v4, v4
    v_fract_f32 v5, v5
    v_cos_f32 v4, v4
    v_cos_f32 v5, v5
    s_nop 0
    v_cvt_pk_bf16_f32 v6, v4, v5
    v_accvgpr_write_b32 a211, v6
    v_fmamk_f32 v4, v11, 0x43680000, v12
    v_fmamk_f32 v5, v11, 0x43680000, v9
    v_fract_f32 v4, v4
    v_fract_f32 v5, v5
    v_cos_f32 v4, v4
    v_cos_f32 v5, v5
    s_nop 0
    v_cvt_pk_bf16_f32 v6, v4, v5
    v_accvgpr_write_b32 a212, v6
    v_fmamk_f32 v4, v11, 0x43690000, v12
    v_fmamk_f32 v5, v11, 0x43690000, v9
    v_fract_f32 v4, v4
    v_fract_f32 v5, v5
    v_cos_f32 v4, v4
    v_cos_f32 v5, v5
    s_nop 0
    v_cvt_pk_bf16_f32 v6, v4, v5
    v_accvgpr_write_b32 a213, v6
    v_fmamk_f32 v4, v11, 0x436a0000, v12
    v_fmamk_f32 v5, v11, 0x436a0000, v9
    v_fract_f32 v4, v4
    v_fract_f32 v5, v5
    v_cos_f32 v4, v4
    v_cos_f32 v5, v5
    s_nop 0
    v_cvt_pk_bf16_f32 v6, v4, v5
    v_accvgpr_write_b32 a214, v6
    v_fmamk_f32 v4, v11, 0x436b0000, v12
    v_fmamk_f32 v5, v11, 0x436b0000, v9
    v_fract_f32 v4, v4
    v_fract_f32 v5, v5
    v_cos_f32 v4, v4
    v_cos_f32 v5, v5
    s_nop 0
    v_cvt_pk_bf16_f32 v6, v4, v5
    v_accvgpr_write_b32 a215, v6
    v_fmamk_f32 v4, v11, 0x43700000, v12
    v_fmamk_f32 v5, v11, 0x43700000, v9
    v_fract_f32 v4, v4
    v_fract_f32 v5, v5
    v_cos_f32 v4, v4
    v_cos_f32 v5, v5
    s_nop 0
    v_cvt_pk_bf16_f32 v6, v4, v5
    v_accvgpr_write_b32 a216, v6
    v_fmamk_f32 v4, v11, 0x43710000, v12
    v_fmamk_f32 v5, v11, 0x43710000, v9
    v_fract_f32 v4, v4
    v_fract_f32 v5, v5
    v_cos_f32 v4, v4
    v_cos_f32 v5, v5
    s_nop 0
    v_cvt_pk_bf16_f32 v6, v4, v5
    v_accvgpr_write_b32 a217, v6
    v_fmamk_f32 v4, v11, 0x43720000, v12
    v_fmamk_f32 v5, v11, 0x43720000, v9
    v_fract_f32 v4, v4
    v_fract_f32 v5, v5
    v_cos_f32 v4, v4
    v_cos_f32 v5, v5
    s_nop 0
    v_cvt_pk_bf16_f32 v6, v4, v5
    v_accvgpr_write_b32 a218, v6
    v_fmamk_f32 v4, v11, 0x43730000, v12
    v_fmamk_f32 v5, v11, 0x43730000, v9
    v_fract_f32 v4, v4
    v_fract_f32 v5, v5
    v_cos_f32 v4, v4
    v_cos_f32 v5, v5
    s_nop 0
    v_cvt_pk_bf16_f32 v6, v4, v5
    v_accvgpr_write_b32 a219, v6
    v_fmamk_f32 v4, v11, 0x43780000, v12
    v_fmamk_f32 v5, v11, 0x43780000, v9
    v_fract_f32 v4, v4
    v_fract_f32 v5, v5
    v_cos_f32 v4, v4
    v_cos_f32 v5, v5
    s_nop 0
    v_cvt_pk_bf16_f32 v6, v4, v5
    v_accvgpr_write_b32 a220, v6
    v_fmamk_f32 v4, v11, 0x43790000, v12
    v_fmamk_f32 v5, v11, 0x43790000, v9
    v_fract_f32 v4, v4
    v_fract_f32 v5, v5
    v_cos_f32 v4, v4
    v_cos_f32 v5, v5
    s_nop 0
    v_cvt_pk_bf16_f32 v6, v4, v5
    v_accvgpr_write_b32 a221, v6
    v_fmamk_f32 v4, v11, 0x437a0000, v12
    v_fmamk_f32 v5, v11, 0x437a0000, v9
    v_fract_f32 v4, v4
    v_fract_f32 v5, v5
    v_cos_f32 v4, v4
    v_cos_f32 v5, v5
    s_nop 0
    v_cvt_pk_bf16_f32 v6, v4, v5
    v_accvgpr_write_b32 a222, v6
    v_fmamk_f32 v4, v11, 0x437b0000, v12
    v_fmamk_f32 v5, v11, 0x437b0000, v9
    v_fract_f32 v4, v4
    v_fract_f32 v5, v5
    v_cos_f32 v4, v4
    v_cos_f32 v5, v5
    s_nop 0
    v_cvt_pk_bf16_f32 v6, v4, v5
    v_accvgpr_write_b32 a223, v6
    v_fmamk_f32 v4, v11, 0x43800000, v12
    v_fmamk_f32 v5, v11, 0x43800000, v9
    v_fract_f32 v4, v4
    v_fract_f32 v5, v5
    v_cos_f32 v4, v4
    v_cos_f32 v5, v5
    s_nop 0
    v_cvt_pk_bf16_f32 v6, v4, v5
    v_accvgpr_write_b32 a224, v6
    v_fmamk_f32 v4, v11, 0x43808000, v12
    v_fmamk_f32 v5, v11, 0x43808000, v9
    v_fract_f32 v4, v4
    v_fract_f32 v5, v5
    v_cos_f32 v4, v4
    v_cos_f32 v5, v5
    s_nop 0
    v_cvt_pk_bf16_f32 v6, v4, v5
    v_accvgpr_write_b32 a225, v6
    v_fmamk_f32 v4, v11, 0x43810000, v12
    v_fmamk_f32 v5, v11, 0x43810000, v9
    v_fract_f32 v4, v4
    v_fract_f32 v5, v5
    v_cos_f32 v4, v4
    v_cos_f32 v5, v5
    s_nop 0
    v_cvt_pk_bf16_f32 v6, v4, v5
    v_accvgpr_write_b32 a226, v6
    v_fmamk_f32 v4, v11, 0x43818000, v12
    v_fmamk_f32 v5, v11, 0x43818000, v9
    v_fract_f32 v4, v4
    v_fract_f32 v5, v5
    v_cos_f32 v4, v4
    v_cos_f32 v5, v5
    s_nop 0
    v_cvt_pk_bf16_f32 v6, v4, v5
    v_accvgpr_write_b32 a227, v6
    v_fmamk_f32 v4, v11, 0x43840000, v12
    v_fmamk_f32 v5, v11, 0x43840000, v9
    v_fract_f32 v4, v4
    v_fract_f32 v5, v5
    v_cos_f32 v4, v4
    v_cos_f32 v5, v5
    s_nop 0
    v_cvt_pk_bf16_f32 v6, v4, v5
    v_accvgpr_write_b32 a228, v6
    v_fmamk_f32 v4, v11, 0x43848000, v12
    v_fmamk_f32 v5, v11, 0x43848000, v9
    v_fract_f32 v4, v4
    v_fract_f32 v5, v5
    v_cos_f32 v4, v4
    v_cos_f32 v5, v5
    s_nop 0
    v_cvt_pk_bf16_f32 v6, v4, v5
    v_accvgpr_write_b32 a229, v6
    v_fmamk_f32 v4, v11, 0x43850000, v12
    v_fmamk_f32 v5, v11, 0x43850000, v9
    v_fract_f32 v4, v4
    v_fract_f32 v5, v5
    v_cos_f32 v4, v4
    v_cos_f32 v5, v5
    s_nop 0
    v_cvt_pk_bf16_f32 v6, v4, v5
    v_accvgpr_write_b32 a230, v6
    v_fmamk_f32 v4, v11, 0x43858000, v12
    v_fmamk_f32 v5, v11, 0x43858000, v9
    v_fract_f32 v4, v4
    v_fract_f32 v5, v5
    v_cos_f32 v4, v4
    v_cos_f32 v5, v5
    s_nop 0
    v_cvt_pk_bf16_f32 v6, v4, v5
    v_accvgpr_write_b32 a231, v6
    v_fmamk_f32 v4, v11, 0x43880000, v12
    v_fmamk_f32 v5, v11, 0x43880000, v9
    v_fract_f32 v4, v4
    v_fract_f32 v5, v5
    v_cos_f32 v4, v4
    v_cos_f32 v5, v5
    s_nop 0
    v_cvt_pk_bf16_f32 v6, v4, v5
    v_accvgpr_write_b32 a232, v6
    v_fmamk_f32 v4, v11, 0x43888000, v12
    v_fmamk_f32 v5, v11, 0x43888000, v9
    v_fract_f32 v4, v4
    v_fract_f32 v5, v5
    v_cos_f32 v4, v4
    v_cos_f32 v5, v5
    s_nop 0
    v_cvt_pk_bf16_f32 v6, v4, v5
    v_accvgpr_write_b32 a233, v6
    v_fmamk_f32 v4, v11, 0x43890000, v12
    v_fmamk_f32 v5, v11, 0x43890000, v9
    v_fract_f32 v4, v4
    v_fract_f32 v5, v5
    v_cos_f32 v4, v4
    v_cos_f32 v5, v5
    s_nop 0
    v_cvt_pk_bf16_f32 v6, v4, v5
    v_accvgpr_write_b32 a234, v6
    v_fmamk_f32 v4, v11, 0x43898000, v12
    v_fmamk_f32 v5, v11, 0x43898000, v9
    v_fract_f32 v4, v4
    v_fract_f32 v5, v5
    v_cos_f32 v4, v4
    v_cos_f32 v5, v5
    s_nop 0
    v_cvt_pk_bf16_f32 v6, v4, v5
    v_accvgpr_write_b32 a235, v6
    v_fmamk_f32 v4, v11, 0x438c0000, v12
    v_fmamk_f32 v5, v11, 0x438c0000, v9
    v_fract_f32 v4, v4
    v_fract_f32 v5, v5
    v_cos_f32 v4, v4
    v_cos_f32 v5, v5
    s_nop 0
    v_cvt_pk_bf16_f32 v6, v4, v5
    v_accvgpr_write_b32 a236, v6
    v_fmamk_f32 v4, v11, 0x438c8000, v12
    v_fmamk_f32 v5, v11, 0x438c8000, v9
    v_fract_f32 v4, v4
    v_fract_f32 v5, v5
    v_cos_f32 v4, v4
    v_cos_f32 v5, v5
    s_nop 0
    v_cvt_pk_bf16_f32 v6, v4, v5
    v_accvgpr_write_b32 a237, v6
    v_fmamk_f32 v4, v11, 0x438d0000, v12
    v_fmamk_f32 v5, v11, 0x438d0000, v9
    v_fract_f32 v4, v4
    v_fract_f32 v5, v5
    v_cos_f32 v4, v4
    v_cos_f32 v5, v5
    s_nop 0
    v_cvt_pk_bf16_f32 v6, v4, v5
    v_accvgpr_write_b32 a238, v6
    v_fmamk_f32 v4, v11, 0x438d8000, v12
    v_fmamk_f32 v5, v11, 0x438d8000, v9
    v_fract_f32 v4, v4
    v_fract_f32 v5, v5
    v_cos_f32 v4, v4
    v_cos_f32 v5, v5
    s_nop 0
    v_cvt_pk_bf16_f32 v6, v4, v5
    v_accvgpr_write_b32 a239, v6
    v_fmamk_f32 v4, v11, 0x43900000, v12
    v_fmamk_f32 v5, v11, 0x43900000, v9
    v_fract_f32 v4, v4
    v_fract_f32 v5, v5
    v_cos_f32 v4, v4
    v_cos_f32 v5, v5
    v_mul_f32 v4, v10, v4
    v_mul_f32 v5, v10, v5
    v_cvt_pk_bf16_f32 v6, v4, v5
    v_accvgpr_write_b32 a240, v6
    v_accvgpr_write_b32 a241, 0
    v_accvgpr_write_b32 a242, 0
    v_accvgpr_write_b32 a243, 0
    v_mov_b32 v4, 68
FB_w68:
    s_mov_b64 exec, 1
    global_load_dword v5, v4, s[40:41] sc1
    s_waitcnt vmcnt(0)
    v_readfirstlane_b32 s13, v5
    s_mov_b64 exec, -1
    s_add_u32 s19, s19, 1
    s_cmp_gt_u32 s19, 0x80000
    s_cbranch_scc1 FB_d68
    s_cmp_ge_u32 s13, 96
    s_cbranch_scc1 FB_d68
    s_sleep 8
    s_branch FB_w68
FB_d68:
    s_cmp_ge_u32 s12, 73
    s_cbranch_scc1 F_a2done
    v_lshlrev_b32 v10, 4, v3
    v_lshl_add_u32 v10, v2, 12, v10
    s_lshl_b32 s13, s6, 2
    v_add_u32 v10, s13, v10
    s_cmp_gt_u32 s21, 288
    s_cbranch_scc1 F_a2zero
    v_lshlrev_b32 v7, 4, v3
    v_lshl_add_u32 v7, v2, 10, v7
    s_lshl_b32 s13, s21, 13
    s_add_u32 s13, s13, 102760448
    s_add_u32 s14, s13, 4096
    buffer_load_dwordx4 v[16:19], v7, s[8:11], s13 offen offset:0 sc1
    buffer_load_dwordx4 v[20:23], v7, s[8:11], s13 offen offset:2048 sc1
    buffer_load_dwordx4 v[24:27], v7, s[8:11], s14 offen offset:0 sc1
    buffer_load_dwordx4 v[28:31], v7, s[8:11], s14 offen offset:2048 sc1
    buffer_load_dwordx4 v[32:35], v7, s[8:11], s13 offen offset:512 sc1
    buffer_load_dwordx4 v[36:39], v7, s[8:11], s13 offen offset:2560 sc1
    buffer_load_dwordx4 v[40:43], v7, s[8:11], s14 offen offset:512 sc1
    buffer_load_dwordx4 v[44:47], v7, s[8:11], s14 offen offset:2560 sc1
    v_cvt_f32_u32 v7, v3
    v_mul_f32 v11, 0x3a000000, v7
    v_mul_f32 v12, v13, v11
    s_waitcnt vmcnt(4)
    v_mfma_f32_32x32x16_bf16 v[100:115], v[16:19], v[224:227], 0
    v_mfma_f32_32x32x16_bf16 v[100:115], v[20:23], v[228:231], v[100:115]
    v_mfma_f32_32x32x16_bf16 v[116:131], v[24:27], v[224:227], 0
    v_mfma_f32_32x32x16_bf16 v[116:131], v[28:31], v[228:231], v[116:131]
    v_mfma_f32_32x32x16_bf16 v[100:115], v[24:27], v[232:235], v[100:115]
    v_mfma_f32_32x32x16_bf16 v[100:115], v[28:31], v[236:239], v[100:115]
    v_mfma_f32_32x32x16_bf16 v[116:131], v[16:19], v[240:243], v[116:131]
    v_mfma_f32_32x32x16_bf16 v[116:131], v[20:23], v[244:247], v[116:131]
    s_waitcnt vmcnt(0)
    v_mfma_f32_32x32x16_bf16 v[132:147], v[32:35], v[224:227], 0
    v_mfma_f32_32x32x16_bf16 v[132:147], v[36:39], v[228:231], v[132:147]
    v_mfma_f32_32x32x16_bf16 v[148:163], v[40:43], v[224:227], 0
    v_mfma_f32_32x32x16_bf16 v[148:163], v[44:47], v[228:231], v[148:163]
    v_mfma_f32_32x32x16_bf16 v[132:147], v[40:43], v[232:235], v[132:147]
    v_mfma_f32_32x32x16_bf16 v[132:147], v[44:47], v[236:239], v[132:147]
    v_mfma_f32_32x32x16_bf16 v[148:163], v[32:35], v[240:243], v[148:163]
    v_mfma_f32_32x32x16_bf16 v[148:163], v[36:39], v[244:247], v[148:163]
    v_fmamk_f32 v48, v11, 0x00000000, v12
    v_sin_f32 v49, v48
    v_cos_f32 v48, v48
    v_fmamk_f32 v50, v11, 0x3f800000, v12
    v_sin_f32 v51, v50
    v_cos_f32 v50, v50
    v_mul_f32 v52, v100, v48
    v_mul_f32 v54, v116, v48
    v_fma_f32 v52, v116, v49, v52
    v_fma_f32 v54, -v100, v49, v54
    v_mul_f32 v53, v101, v50
    v_mul_f32 v55, v117, v50
    v_fma_f32 v53, v117, v51, v53
    v_fma_f32 v55, -v101, v51, v55
    v_cvt_pk_bf16_f32 v164, v52, v53
    v_cvt_pk_bf16_f32 v172, v54, v55
    v_fmamk_f32 v48, v11, 0x40000000, v12
    v_sin_f32 v49, v48
    v_cos_f32 v48, v48
    v_fmamk_f32 v50, v11, 0x40400000, v12
    v_sin_f32 v51, v50
    v_cos_f32 v50, v50
    v_mul_f32 v52, v102, v48
    v_mul_f32 v54, v118, v48
    v_fma_f32 v52, v118, v49, v52
    v_fma_f32 v54, -v102, v49, v54
    v_mul_f32 v53, v103, v50
    v_mul_f32 v55, v119, v50
    v_fma_f32 v53, v119, v51, v53
    v_fma_f32 v55, -v103, v51, v55
    v_cvt_pk_bf16_f32 v165, v52, v53
    v_cvt_pk_bf16_f32 v173, v54, v55
    v_fmamk_f32 v48, v11, 0x41000000, v12
    v_sin_f32 v49, v48
    v_cos_f32 v48, v48
    v_fmamk_f32 v50, v11, 0x41100000, v12
    v_sin_f32 v51, v50
    v_cos_f32 v50, v50
    v_mul_f32 v52, v104, v48
    v_mul_f32 v54, v120, v48
    v_fma_f32 v52, v120, v49, v52
    v_fma_f32 v54, -v104, v49, v54
    v_mul_f32 v53, v105, v50
    v_mul_f32 v55, v121, v50
    v_fma_f32 v53, v121, v51, v53
    v_fma_f32 v55, -v105, v51, v55
    v_cvt_pk_bf16_f32 v166, v52, v53
    v_cvt_pk_bf16_f32 v174, v54, v55
    v_fmamk_f32 v48, v11, 0x41200000, v12
    v_sin_f32 v49, v48
    v_cos_f32 v48, v48
    v_fmamk_f32 v50, v11, 0x41300000, v12
    v_sin_f32 v51, v50
    v_cos_f32 v50, v50
    v_mul_f32 v52, v106, v48
    v_mul_f32 v54, v122, v48
    v_fma_f32 v52, v122, v49, v52
    v_fma_f32 v54, -v106, v49, v54
    v_mul_f32 v53, v107, v50
    v_mul_f32 v55, v123, v50
    v_fma_f32 v53, v123, v51, v53
    v_fma_f32 v55, -v107, v51, v55
    v_cvt_pk_bf16_f32 v167, v52, v53
    v_cvt_pk_bf16_f32 v175, v54, v55
    v_fmamk_f32 v48, v11, 0x41800000, v12
    v_sin_f32 v49, v48
    v_cos_f32 v48, v48
    v_fmamk_f32 v50, v11, 0x41880000, v12
    v_sin_f32 v51, v50
    v_cos_f32 v50, v50
    v_mul_f32 v52, v108, v48
    v_mul_f32 v54, v124, v48
    v_fma_f32 v52, v124, v49, v52
    v_fma_f32 v54, -v108, v49, v54
    v_mul_f32 v53, v109, v50
    v_mul_f32 v55, v125, v50
    v_fma_f32 v53, v125, v51, v53
    v_fma_f32 v55, -v109, v51, v55
    v_cvt_pk_bf16_f32 v168, v52, v53
    v_cvt_pk_bf16_f32 v176, v54, v55
    v_fmamk_f32 v48, v11, 0x41900000, v12
    v_sin_f32 v49, v48
    v_cos_f32 v48, v48
    v_fmamk_f32 v50, v11, 0x41980000, v12
    v_sin_f32 v51, v50
    v_cos_f32 v50, v50
    v_mul_f32 v52, v110, v48
    v_mul_f32 v54, v126, v48
    v_fma_f32 v52, v126, v49, v52
    v_fma_f32 v54, -v110, v49, v54
    v_mul_f32 v53, v111, v50
    v_mul_f32 v55, v127, v50
    v_fma_f32 v53, v127, v51, v53
    v_fma_f32 v55, -v111, v51, v55
    v_cvt_pk_bf16_f32 v169, v52, v53
    v_cvt_pk_bf16_f32 v177, v54, v55
    v_fmamk_f32 v48, v11, 0x41c00000, v12
    v_sin_f32 v49, v48
    v_cos_f32 v48, v48
    v_fmamk_f32 v50, v11, 0x41c80000, v12
    v_sin_f32 v51, v50
    v_cos_f32 v50, v50
    v_mul_f32 v52, v112, v48
    v_mul_f32 v54, v128, v48
    v_fma_f32 v52, v128, v49, v52
    v_fma_f32 v54, -v112, v49, v54
    v_mul_f32 v53, v113, v50
    v_mul_f32 v55, v129, v50
    v_fma_f32 v53, v129, v51, v53
    v_fma_f32 v55, -v113, v51, v55
    v_cvt_pk_bf16_f32 v170, v52, v53
    v_cvt_pk_bf16_f32 v178, v54, v55
    v_fmamk_f32 v48, v11, 0x41d00000, v12
    v_sin_f32 v49, v48
    v_cos_f32 v48, v48
    v_fmamk_f32 v50, v11, 0x41d80000, v12
    v_sin_f32 v51, v50
    v_cos_f32 v50, v50
    v_mul_f32 v52, v114, v48
    v_mul_f32 v54, v130, v48
    v_fma_f32 v52, v130, v49, v52
    v_fma_f32 v54, -v114, v49, v54
    v_mul_f32 v53, v115, v50
    v_mul_f32 v55, v131, v50
    v_fma_f32 v53, v131, v51, v53
    v_fma_f32 v55, -v115, v51, v55
    v_cvt_pk_bf16_f32 v171, v52, v53
    v_cvt_pk_bf16_f32 v179, v54, v55
    v_fmamk_f32 v48, v11, 0x42000000, v12
    v_sin_f32 v49, v48
    v_cos_f32 v48, v48
    v_fmamk_f32 v50, v11, 0x42040000, v12
    v_sin_f32 v51, v50
    v_cos_f32 v50, v50
    v_mul_f32 v52, v132, v48
    v_mul_f32 v54, v148, v48
    v_fma_f32 v52, v148, v49, v52
    v_fma_f32 v54, -v132, v49, v54
    v_mul_f32 v53, v133, v50
    v_mul_f32 v55, v149, v50
    v_fma_f32 v53, v149, v51, v53
    v_fma_f32 v55, -v133, v51, v55
    v_cvt_pk_bf16_f32 v180, v52, v53
    v_cvt_pk_bf16_f32 v188, v54, v55
    v_fmamk_f32 v48, v11, 0x42080000, v12
    v_sin_f32 v49, v48
    v_cos_f32 v48, v48
    v_fmamk_f32 v50, v11, 0x420c0000, v12
    v_sin_f32 v51, v50
    v_cos_f32 v50, v50
    v_mul_f32 v52, v134, v48
    v_mul_f32 v54, v150, v48
    v_fma_f32 v52, v150, v49, v52
    v_fma_f32 v54, -v134, v49, v54
    v_mul_f32 v53, v135, v50
    v_mul_f32 v55, v151, v50
    v_fma_f32 v53, v151, v51, v53
    v_fma_f32 v55, -v135, v51, v55
    v_cvt_pk_bf16_f32 v181, v52, v53
    v_cvt_pk_bf16_f32 v189, v54, v55
    v_fmamk_f32 v48, v11, 0x42200000, v12
    v_sin_f32 v49, v48
    v_cos_f32 v48, v48
    v_fmamk_f32 v50, v11, 0x42240000, v12
    v_sin_f32 v51, v50
    v_cos_f32 v50, v50
    v_mul_f32 v52, v136, v48
    v_mul_f32 v54, v152, v48
    v_fma_f32 v52, v152, v49, v52
    v_fma_f32 v54, -v136, v49, v54
    v_mul_f32 v53, v137, v50
    v_mul_f32 v55, v153, v50
    v_fma_f32 v53, v153, v51, v53
    v_fma_f32 v55, -v137, v51, v55
    v_cvt_pk_bf16_f32 v182, v52, v53
    v_cvt_pk_bf16_f32 v190, v54, v55
    v_fmamk_f32 v48, v11, 0x42280000, v12
    v_sin_f32 v49, v48
    v_cos_f32 v48, v48
    v_fmamk_f32 v50, v11, 0x422c0000, v12
    v_sin_f32 v51, v50
    v_cos_f32 v50, v50
    v_mul_f32 v52, v138, v48
    v_mul_f32 v54, v154, v48
    v_fma_f32 v52, v154, v49, v52
    v_fma_f32 v54, -v138, v49, v54
    v_mul_f32 v53, v139, v50
    v_mul_f32 v55, v155, v50
    v_fma_f32 v53, v155, v51, v53
    v_fma_f32 v55, -v139, v51, v55
    v_cvt_pk_bf16_f32 v183, v52, v53
    v_cvt_pk_bf16_f32 v191, v54, v55
    v_fmamk_f32 v48, v11, 0x42400000, v12
    v_sin_f32 v49, v48
    v_cos_f32 v48, v48
    v_fmamk_f32 v50, v11, 0x42440000, v12
    v_sin_f32 v51, v50
    v_cos_f32 v50, v50
    v_mul_f32 v52, v140, v48
    v_mul_f32 v54, v156, v48
    v_fma_f32 v52, v156, v49, v52
    v_fma_f32 v54, -v140, v49, v54
    v_mul_f32 v53, v141, v50
    v_mul_f32 v55, v157, v50
    v_fma_f32 v53, v157, v51, v53
    v_fma_f32 v55, -v141, v51, v55
    v_cvt_pk_bf16_f32 v184, v52, v53
    v_cvt_pk_bf16_f32 v192, v54, v55
    v_fmamk_f32 v48, v11, 0x42480000, v12
    v_sin_f32 v49, v48
    v_cos_f32 v48, v48
    v_fmamk_f32 v50, v11, 0x424c0000, v12
    v_sin_f32 v51, v50
    v_cos_f32 v50, v50
    v_mul_f32 v52, v142, v48
    v_mul_f32 v54, v158, v48
    v_fma_f32 v52, v158, v49, v52
    v_fma_f32 v54, -v142, v49, v54
    v_mul_f32 v53, v143, v50
    v_mul_f32 v55, v159, v50
    v_fma_f32 v53, v159, v51, v53
    v_fma_f32 v55, -v143, v51, v55
    v_cvt_pk_bf16_f32 v185, v52, v53
    v_cvt_pk_bf16_f32 v193, v54, v55
    v_fmamk_f32 v48, v11, 0x42600000, v12
    v_sin_f32 v49, v48
    v_cos_f32 v48, v48
    v_fmamk_f32 v50, v11, 0x42640000, v12
    v_sin_f32 v51, v50
    v_cos_f32 v50, v50
    v_mul_f32 v52, v144, v48
    v_mul_f32 v54, v160, v48
    v_fma_f32 v52, v160, v49, v52
    v_fma_f32 v54, -v144, v49, v54
    v_mul_f32 v53, v145, v50
    v_mul_f32 v55, v161, v50
    v_fma_f32 v53, v161, v51, v53
    v_fma_f32 v55, -v145, v51, v55
    v_cvt_pk_bf16_f32 v186, v52, v53
    v_cvt_pk_bf16_f32 v194, v54, v55
    v_fmamk_f32 v48, v11, 0x42680000, v12
    v_sin_f32 v49, v48
    v_cos_f32 v48, v48
    v_fmamk_f32 v50, v11, 0x426c0000, v12
    v_sin_f32 v51, v50
    v_cos_f32 v50, v50
    v_mul_f32 v52, v146, v48
    v_mul_f32 v54, v162, v48
    v_fma_f32 v52, v162, v49, v52
    v_fma_f32 v54, -v146, v49, v54
    v_mul_f32 v53, v147, v50
    v_mul_f32 v55, v163, v50
    v_fma_f32 v53, v163, v51, v53
    v_fma_f32 v55, -v147, v51, v55
    v_cvt_pk_bf16_f32 v187, v52, v53
    v_cvt_pk_bf16_f32 v195, v54, v55
    v_mfma_f32_32x32x16_bf16 v[100:115], a[0:3], v[164:167], 0
    v_mfma_f32_32x32x16_bf16 v[100:115], a[4:7], v[168:171], v[100:115]
    v_mfma_f32_32x32x16_bf16 v[100:115], a[8:11], v[180:183], v[100:115]
    v_mfma_f32_32x32x16_bf16 v[100:115], a[12:15], v[184:187], v[100:115]
    v_mfma_f32_32x32x16_bf16 v[116:131], a[0:3], v[172:175], 0
    v_mfma_f32_32x32x16_bf16 v[116:131], a[4:7], v[176:179], v[116:131]
    v_mfma_f32_32x32x16_bf16 v[116:131], a[8:11], v[188:191], v[116:131]
    v_mfma_f32_32x32x16_bf16 v[116:131], a[12:15], v[192:195], v[116:131]
    v_mfma_f32_32x32x16_bf16 v[100:115], a[32:35], v[172:175], v[100:115]
    v_mfma_f32_32x32x16_bf16 v[100:115], a[36:39], v[176:179], v[100:115]
    v_mfma_f32_32x32x16_bf16 v[100:115], a[40:43], v[188:191], v[100:115]
    v_mfma_f32_32x32x16_bf16 v[100:115], a[44:47], v[192:195], v[100:115]
    v_mfma_f32_32x32x16_bf16 v[116:131], a[64:67], v[164:167], v[116:131]
    v_mfma_f32_32x32x16_bf16 v[116:131], a[68:71], v[168:171], v[116:131]
    v_mfma_f32_32x32x16_bf16 v[116:131], a[72:75], v[180:183], v[116:131]
    v_mfma_f32_32x32x16_bf16 v[116:131], a[76:79], v[184:187], v[116:131]
    v_mfma_f32_32x32x16_bf16 v[132:147], a[16:19], v[164:167], 0
    v_mfma_f32_32x32x16_bf16 v[132:147], a[20:23], v[168:171], v[132:147]
    v_mfma_f32_32x32x16_bf16 v[132:147], a[24:27], v[180:183], v[132:147]
    v_mfma_f32_32x32x16_bf16 v[132:147], a[28:31], v[184:187], v[132:147]
    v_mfma_f32_32x32x16_bf16 v[148:163], a[16:19], v[172:175], 0
    v_mfma_f32_32x32x16_bf16 v[148:163], a[20:23], v[176:179], v[148:163]
    v_mfma_f32_32x32x16_bf16 v[148:163], a[24:27], v[188:191], v[148:163]
    v_mfma_f32_32x32x16_bf16 v[148:163], a[28:31], v[192:195], v[148:163]
    v_mfma_f32_32x32x16_bf16 v[132:147], a[48:51], v[172:175], v[132:147]
    v_mfma_f32_32x32x16_bf16 v[132:147], a[52:55], v[176:179], v[132:147]
    v_mfma_f32_32x32x16_bf16 v[132:147], a[56:59], v[188:191], v[132:147]
    v_mfma_f32_32x32x16_bf16 v[132:147], a[60:63], v[192:195], v[132:147]
    v_mfma_f32_32x32x16_bf16 v[148:163], a[80:83], v[164:167], v[148:163]
    v_mfma_f32_32x32x16_bf16 v[148:163], a[84:87], v[168:171], v[148:163]
    v_mfma_f32_32x32x16_bf16 v[148:163], a[88:91], v[180:183], v[148:163]
    v_mfma_f32_32x32x16_bf16 v[148:163], a[92:95], v[184:187], v[148:163]
    v_lshlrev_b32 v48, 16, v64
    v_and_b32 v49, 0xffff0000, v64
    v_lshlrev_b32 v50, 16, v65
    v_and_b32 v51, 0xffff0000, v65
    v_mul_f32 v52, v100, v48
    v_mul_f32 v54, v116, v48
    v_fma_f32 v52, -v116, v49, v52
    v_fma_f32 v54, v100, v49, v54
    v_mul_f32 v53, v101, v50
    v_mul_f32 v55, v117, v50
    v_fma_f32 v53, -v117, v51, v53
    v_fma_f32 v55, v101, v51, v55
    v_cvt_pk_bf16_f32 v164, v52, v53
    v_cvt_pk_bf16_f32 v172, v54, v55
    v_lshlrev_b32 v48, 16, v66
    v_and_b32 v49, 0xffff0000, v66
    v_lshlrev_b32 v50, 16, v67
    v_and_b32 v51, 0xffff0000, v67
    v_mul_f32 v52, v102, v48
    v_mul_f32 v54, v118, v48
    v_fma_f32 v52, -v118, v49, v52
    v_fma_f32 v54, v102, v49, v54
    v_mul_f32 v53, v103, v50
    v_mul_f32 v55, v119, v50
    v_fma_f32 v53, -v119, v51, v53
    v_fma_f32 v55, v103, v51, v55
    v_cvt_pk_bf16_f32 v165, v52, v53
    v_cvt_pk_bf16_f32 v173, v54, v55
    v_lshlrev_b32 v48, 16, v68
    v_and_b32 v49, 0xffff0000, v68
    v_lshlrev_b32 v50, 16, v69
    v_and_b32 v51, 0xffff0000, v69
    v_mul_f32 v52, v104, v48
    v_mul_f32 v54, v120, v48
    v_fma_f32 v52, -v120, v49, v52
    v_fma_f32 v54, v104, v49, v54
    v_mul_f32 v53, v105, v50
    v_mul_f32 v55, v121, v50
    v_fma_f32 v53, -v121, v51, v53
    v_fma_f32 v55, v105, v51, v55
    v_cvt_pk_bf16_f32 v166, v52, v53
    v_cvt_pk_bf16_f32 v174, v54, v55
    v_lshlrev_b32 v48, 16, v70
    v_and_b32 v49, 0xffff0000, v70
    v_lshlrev_b32 v50, 16, v71
    v_and_b32 v51, 0xffff0000, v71
    v_mul_f32 v52, v106, v48
    v_mul_f32 v54, v122, v48
    v_fma_f32 v52, -v122, v49, v52
    v_fma_f32 v54, v106, v49, v54
    v_mul_f32 v53, v107, v50
    v_mul_f32 v55, v123, v50
    v_fma_f32 v53, -v123, v51, v53
    v_fma_f32 v55, v107, v51, v55
    v_cvt_pk_bf16_f32 v167, v52, v53
    v_cvt_pk_bf16_f32 v175, v54, v55
    v_lshlrev_b32 v48, 16, v72
    v_and_b32 v49, 0xffff0000, v72
    v_lshlrev_b32 v50, 16, v73
    v_and_b32 v51, 0xffff0000, v73
    v_mul_f32 v52, v108, v48
    v_mul_f32 v54, v124, v48
    v_fma_f32 v52, -v124, v49, v52
    v_fma_f32 v54, v108, v49, v54
    v_mul_f32 v53, v109, v50
    v_mul_f32 v55, v125, v50
    v_fma_f32 v53, -v125, v51, v53
    v_fma_f32 v55, v109, v51, v55
    v_cvt_pk_bf16_f32 v168, v52, v53
    v_cvt_pk_bf16_f32 v176, v54, v55
    v_lshlrev_b32 v48, 16, v74
    v_and_b32 v49, 0xffff0000, v74
    v_lshlrev_b32 v50, 16, v75
    v_and_b32 v51, 0xffff0000, v75
    v_mul_f32 v52, v110, v48
    v_mul_f32 v54, v126, v48
    v_fma_f32 v52, -v126, v49, v52
    v_fma_f32 v54, v110, v49, v54
    v_mul_f32 v53, v111, v50
    v_mul_f32 v55, v127, v50
    v_fma_f32 v53, -v127, v51, v53
    v_fma_f32 v55, v111, v51, v55
    v_cvt_pk_bf16_f32 v169, v52, v53
    v_cvt_pk_bf16_f32 v177, v54, v55
    v_lshlrev_b32 v48, 16, v76
    v_and_b32 v49, 0xffff0000, v76
    v_lshlrev_b32 v50, 16, v77
    v_and_b32 v51, 0xffff0000, v77
    v_mul_f32 v52, v112, v48
    v_mul_f32 v54, v128, v48
    v_fma_f32 v52, -v128, v49, v52
    v_fma_f32 v54, v112, v49, v54
    v_mul_f32 v53, v113, v50
    v_mul_f32 v55, v129, v50
    v_fma_f32 v53, -v129, v51, v53
    v_fma_f32 v55, v113, v51, v55
    v_cvt_pk_bf16_f32 v170, v52, v53
    v_cvt_pk_bf16_f32 v178, v54, v55
    v_lshlrev_b32 v48, 16, v78
    v_and_b32 v49, 0xffff0000, v78
    v_lshlrev_b32 v50, 16, v79
    v_and_b32 v51, 0xffff0000, v79
    v_mul_f32 v52, v114, v48
    v_mul_f32 v54, v130, v48
    v_fma_f32 v52, -v130, v49, v52
    v_fma_f32 v54, v114, v49, v54
    v_mul_f32 v53, v115, v50
    v_mul_f32 v55, v131, v50
    v_fma_f32 v53, -v131, v51, v53
    v_fma_f32 v55, v115, v51, v55
    v_cvt_pk_bf16_f32 v171, v52, v53
    v_cvt_pk_bf16_f32 v179, v54, v55
    v_lshlrev_b32 v48, 16, v80
    v_and_b32 v49, 0xffff0000, v80
    v_lshlrev_b32 v50, 16, v81
    v_and_b32 v51, 0xffff0000, v81
    v_mul_f32 v52, v132, v48
    v_mul_f32 v54, v148, v48
    v_fma_f32 v52, -v148, v49, v52
    v_fma_f32 v54, v132, v49, v54
    v_mul_f32 v53, v133, v50
    v_mul_f32 v55, v149, v50
    v_fma_f32 v53, -v149, v51, v53
    v_fma_f32 v55, v133, v51, v55
    v_cvt_pk_bf16_f32 v180, v52, v53
    v_cvt_pk_bf16_f32 v188, v54, v55
    v_lshlrev_b32 v48, 16, v82
    v_and_b32 v49, 0xffff0000, v82
    v_lshlrev_b32 v50, 16, v83
    v_and_b32 v51, 0xffff0000, v83
    v_mul_f32 v52, v134, v48
    v_mul_f32 v54, v150, v48
    v_fma_f32 v52, -v150, v49, v52
    v_fma_f32 v54, v134, v49, v54
    v_mul_f32 v53, v135, v50
    v_mul_f32 v55, v151, v50
    v_fma_f32 v53, -v151, v51, v53
    v_fma_f32 v55, v135, v51, v55
    v_cvt_pk_bf16_f32 v181, v52, v53
    v_cvt_pk_bf16_f32 v189, v54, v55
    v_lshlrev_b32 v48, 16, v84
    v_and_b32 v49, 0xffff0000, v84
    v_lshlrev_b32 v50, 16, v85
    v_and_b32 v51, 0xffff0000, v85
    v_mul_f32 v52, v136, v48
    v_mul_f32 v54, v152, v48
    v_fma_f32 v52, -v152, v49, v52
    v_fma_f32 v54, v136, v49, v54
    v_mul_f32 v53, v137, v50
    v_mul_f32 v55, v153, v50
    v_fma_f32 v53, -v153, v51, v53
    v_fma_f32 v55, v137, v51, v55
    v_cvt_pk_bf16_f32 v182, v52, v53
    v_cvt_pk_bf16_f32 v190, v54, v55
    v_lshlrev_b32 v48, 16, v86
    v_and_b32 v49, 0xffff0000, v86
    v_lshlrev_b32 v50, 16, v87
    v_and_b32 v51, 0xffff0000, v87
    v_mul_f32 v52, v138, v48
    v_mul_f32 v54, v154, v48
    v_fma_f32 v52, -v154, v49, v52
    v_fma_f32 v54, v138, v49, v54
    v_mul_f32 v53, v139, v50
    v_mul_f32 v55, v155, v50
    v_fma_f32 v53, -v155, v51, v53
    v_fma_f32 v55, v139, v51, v55
    v_cvt_pk_bf16_f32 v183, v52, v53
    v_cvt_pk_bf16_f32 v191, v54, v55
    v_lshlrev_b32 v48, 16, v88
    v_and_b32 v49, 0xffff0000, v88
    v_lshlrev_b32 v50, 16, v89
    v_and_b32 v51, 0xffff0000, v89
    v_mul_f32 v52, v140, v48
    v_mul_f32 v54, v156, v48
    v_fma_f32 v52, -v156, v49, v52
    v_fma_f32 v54, v140, v49, v54
    v_mul_f32 v53, v141, v50
    v_mul_f32 v55, v157, v50
    v_fma_f32 v53, -v157, v51, v53
    v_fma_f32 v55, v141, v51, v55
    v_cvt_pk_bf16_f32 v184, v52, v53
    v_cvt_pk_bf16_f32 v192, v54, v55
    v_lshlrev_b32 v48, 16, v90
    v_and_b32 v49, 0xffff0000, v90
    v_lshlrev_b32 v50, 16, v91
    v_and_b32 v51, 0xffff0000, v91
    v_mul_f32 v52, v142, v48
    v_mul_f32 v54, v158, v48
    v_fma_f32 v52, -v158, v49, v52
    v_fma_f32 v54, v142, v49, v54
    v_mul_f32 v53, v143, v50
    v_mul_f32 v55, v159, v50
    v_fma_f32 v53, -v159, v51, v53
    v_fma_f32 v55, v143, v51, v55
    v_cvt_pk_bf16_f32 v185, v52, v53
    v_cvt_pk_bf16_f32 v193, v54, v55
    v_lshlrev_b32 v48, 16, v92
    v_and_b32 v49, 0xffff0000, v92
    v_lshlrev_b32 v50, 16, v93
    v_and_b32 v51, 0xffff0000, v93
    v_mul_f32 v52, v144, v48
    v_mul_f32 v54, v160, v48
    v_fma_f32 v52, -v160, v49, v52
    v_fma_f32 v54, v144, v49, v54
    v_mul_f32 v53, v145, v50
    v_mul_f32 v55, v161, v50
    v_fma_f32 v53, -v161, v51, v53
    v_fma_f32 v55, v145, v51, v55
    v_cvt_pk_bf16_f32 v186, v52, v53
    v_cvt_pk_bf16_f32 v194, v54, v55
    v_lshlrev_b32 v48, 16, v94
    v_and_b32 v49, 0xffff0000, v94
    v_lshlrev_b32 v50, 16, v95
    v_and_b32 v51, 0xffff0000, v95
    v_mul_f32 v52, v146, v48
    v_mul_f32 v54, v162, v48
    v_fma_f32 v52, -v162, v49, v52
    v_fma_f32 v54, v146, v49, v54
    v_mul_f32 v53, v147, v50
    v_mul_f32 v55, v163, v50
    v_fma_f32 v53, -v163, v51, v53
    v_fma_f32 v55, v147, v51, v55
    v_cvt_pk_bf16_f32 v187, v52, v53
    v_cvt_pk_bf16_f32 v195, v54, v55
    v_mfma_f32_32x32x16_bf16 v[100:115], v[164:167], a[0:3], 0
    v_mfma_f32_32x32x16_bf16 v[100:115], v[168:171], a[4:7], v[100:115]
    v_mfma_f32_32x32x16_bf16 v[100:115], v[180:183], a[8:11], v[100:115]
    v_mfma_f32_32x32x16_bf16 v[100:115], v[184:187], a[12:15], v[100:115]
    v_mfma_f32_32x32x16_bf16 v[116:131], v[172:175], a[0:3], 0
    v_mfma_f32_32x32x16_bf16 v[116:131], v[176:179], a[4:7], v[116:131]
    v_mfma_f32_32x32x16_bf16 v[116:131], v[188:191], a[8:11], v[116:131]
    v_mfma_f32_32x32x16_bf16 v[116:131], v[192:195], a[12:15], v[116:131]
    v_mfma_f32_32x32x16_bf16 v[100:115], v[172:175], a[64:67], v[100:115]
    v_mfma_f32_32x32x16_bf16 v[100:115], v[176:179], a[68:71], v[100:115]
    v_mfma_f32_32x32x16_bf16 v[100:115], v[188:191], a[72:75], v[100:115]
    v_mfma_f32_32x32x16_bf16 v[100:115], v[192:195], a[76:79], v[100:115]
    v_mfma_f32_32x32x16_bf16 v[116:131], v[164:167], a[32:35], v[116:131]
    v_mfma_f32_32x32x16_bf16 v[116:131], v[168:171], a[36:39], v[116:131]
    v_mfma_f32_32x32x16_bf16 v[116:131], v[180:183], a[40:43], v[116:131]
    v_mfma_f32_32x32x16_bf16 v[116:131], v[184:187], a[44:47], v[116:131]
    v_mfma_f32_32x32x16_bf16 v[132:147], v[164:167], a[16:19], 0
    v_mfma_f32_32x32x16_bf16 v[132:147], v[168:171], a[20:23], v[132:147]
    v_mfma_f32_32x32x16_bf16 v[132:147], v[180:183], a[24:27], v[132:147]
    v_mfma_f32_32x32x16_bf16 v[132:147], v[184:187], a[28:31], v[132:147]
    v_mfma_f32_32x32x16_bf16 v[148:163], v[172:175], a[16:19], 0
    v_mfma_f32_32x32x16_bf16 v[148:163], v[176:179], a[20:23], v[148:163]
    v_mfma_f32_32x32x16_bf16 v[148:163], v[188:191], a[24:27], v[148:163]
    v_mfma_f32_32x32x16_bf16 v[148:163], v[192:195], a[28:31], v[148:163]
    v_mfma_f32_32x32x16_bf16 v[132:147], v[172:175], a[80:83], v[132:147]
    v_mfma_f32_32x32x16_bf16 v[132:147], v[176:179], a[84:87], v[132:147]
    v_mfma_f32_32x32x16_bf16 v[132:147], v[188:191], a[88:91], v[132:147]
    v_mfma_f32_32x32x16_bf16 v[132:147], v[192:195], a[92:95], v[132:147]
    v_mfma_f32_32x32x16_bf16 v[148:163], v[164:167], a[48:51], v[148:163]
    v_mfma_f32_32x32x16_bf16 v[148:163], v[168:171], a[52:55], v[148:163]
    v_mfma_f32_32x32x16_bf16 v[148:163], v[180:183], a[56:59], v[148:163]
    v_mfma_f32_32x32x16_bf16 v[148:163], v[184:187], a[60:63], v[148:163]
    v_add_f32 v11, 0x00000000, v7
    v_mul_f32 v11, 0x3a000000, v11
    v_mul_f32 v12, v13, v11
    v_fmamk_f32 v48, v11, 0x00000000, v12
    v_sin_f32 v49, v48
    v_cos_f32 v48, v48
    v_fmamk_f32 v50, v11, 0x3f800000, v12
    v_sin_f32 v51, v50
    v_cos_f32 v50, v50
    v_mul_f32 v52, v100, v48
    v_mul_f32 v54, v116, v48
    v_fma_f32 v52, -v116, v49, v52
    v_fma_f32 v54, v100, v49, v54
    v_mul_f32 v53, v101, v50
    v_mul_f32 v55, v117, v50
    v_fma_f32 v53, -v117, v51, v53
    v_fma_f32 v55, v101, v51, v55
    v_cvt_pk_bf16_f32 v164, v52, v53
    v_cvt_pk_bf16_f32 v172, v54, v55
    v_fmamk_f32 v48, v11, 0x40000000, v12
    v_sin_f32 v49, v48
    v_cos_f32 v48, v48
    v_fmamk_f32 v50, v11, 0x40400000, v12
    v_sin_f32 v51, v50
    v_cos_f32 v50, v50
    v_mul_f32 v52, v102, v48
    v_mul_f32 v54, v118, v48
    v_fma_f32 v52, -v118, v49, v52
    v_fma_f32 v54, v102, v49, v54
    v_mul_f32 v53, v103, v50
    v_mul_f32 v55, v119, v50
    v_fma_f32 v53, -v119, v51, v53
    v_fma_f32 v55, v103, v51, v55
    v_cvt_pk_bf16_f32 v165, v52, v53
    v_cvt_pk_bf16_f32 v173, v54, v55
    v_fmamk_f32 v48, v11, 0x41000000, v12
    v_sin_f32 v49, v48
    v_cos_f32 v48, v48
    v_fmamk_f32 v50, v11, 0x41100000, v12
    v_sin_f32 v51, v50
    v_cos_f32 v50, v50
    v_mul_f32 v52, v104, v48
    v_mul_f32 v54, v120, v48
    v_fma_f32 v52, -v120, v49, v52
    v_fma_f32 v54, v104, v49, v54
    v_mul_f32 v53, v105, v50
    v_mul_f32 v55, v121, v50
    v_fma_f32 v53, -v121, v51, v53
    v_fma_f32 v55, v105, v51, v55
    v_cvt_pk_bf16_f32 v166, v52, v53
    v_cvt_pk_bf16_f32 v174, v54, v55
    v_fmamk_f32 v48, v11, 0x41200000, v12
    v_sin_f32 v49, v48
    v_cos_f32 v48, v48
    v_fmamk_f32 v50, v11, 0x41300000, v12
    v_sin_f32 v51, v50
    v_cos_f32 v50, v50
    v_mul_f32 v52, v106, v48
    v_mul_f32 v54, v122, v48
    v_fma_f32 v52, -v122, v49, v52
    v_fma_f32 v54, v106, v49, v54
    v_mul_f32 v53, v107, v50
    v_mul_f32 v55, v123, v50
    v_fma_f32 v53, -v123, v51, v53
    v_fma_f32 v55, v107, v51, v55
    v_cvt_pk_bf16_f32 v167, v52, v53
    v_cvt_pk_bf16_f32 v175, v54, v55
    v_fmamk_f32 v48, v11, 0x41800000, v12
    v_sin_f32 v49, v48
    v_cos_f32 v48, v48
    v_fmamk_f32 v50, v11, 0x41880000, v12
    v_sin_f32 v51, v50
    v_cos_f32 v50, v50
    v_mul_f32 v52, v108, v48
    v_mul_f32 v54, v124, v48
    v_fma_f32 v52, -v124, v49, v52
    v_fma_f32 v54, v108, v49, v54
    v_mul_f32 v53, v109, v50
    v_mul_f32 v55, v125, v50
    v_fma_f32 v53, -v125, v51, v53
    v_fma_f32 v55, v109, v51, v55
    v_cvt_pk_bf16_f32 v168, v52, v53
    v_cvt_pk_bf16_f32 v176, v54, v55
    v_fmamk_f32 v48, v11, 0x41900000, v12
    v_sin_f32 v49, v48
    v_cos_f32 v48, v48
    v_fmamk_f32 v50, v11, 0x41980000, v12
    v_sin_f32 v51, v50
    v_cos_f32 v50, v50
    v_mul_f32 v52, v110, v48
    v_mul_f32 v54, v126, v48
    v_fma_f32 v52, -v126, v49, v52
    v_fma_f32 v54, v110, v49, v54
    v_mul_f32 v53, v111, v50
    v_mul_f32 v55, v127, v50
    v_fma_f32 v53, -v127, v51, v53
    v_fma_f32 v55, v111, v51, v55
    v_cvt_pk_bf16_f32 v169, v52, v53
    v_cvt_pk_bf16_f32 v177, v54, v55
    v_fmamk_f32 v48, v11, 0x41c00000, v12
    v_sin_f32 v49, v48
    v_cos_f32 v48, v48
    v_fmamk_f32 v50, v11, 0x41c80000, v12
    v_sin_f32 v51, v50
    v_cos_f32 v50, v50
    v_mul_f32 v52, v112, v48
    v_mul_f32 v54, v128, v48
    v_fma_f32 v52, -v128, v49, v52
    v_fma_f32 v54, v112, v49, v54
    v_mul_f32 v53, v113, v50
    v_mul_f32 v55, v129, v50
    v_fma_f32 v53, -v129, v51, v53
    v_fma_f32 v55, v113, v51, v55
    v_cvt_pk_bf16_f32 v170, v52, v53
    v_cvt_pk_bf16_f32 v178, v54, v55
    v_fmamk_f32 v48, v11, 0x41d00000, v12
    v_sin_f32 v49, v48
    v_cos_f32 v48, v48
    v_fmamk_f32 v50, v11, 0x41d80000, v12
    v_sin_f32 v51, v50
    v_cos_f32 v50, v50
    v_mul_f32 v52, v114, v48
    v_mul_f32 v54, v130, v48
    v_fma_f32 v52, -v130, v49, v52
    v_fma_f32 v54, v114, v49, v54
    v_mul_f32 v53, v115, v50
    v_mul_f32 v55, v131, v50
    v_fma_f32 v53, -v131, v51, v53
    v_fma_f32 v55, v115, v51, v55
    v_cvt_pk_bf16_f32 v171, v52, v53
    v_cvt_pk_bf16_f32 v179, v54, v55
    v_add_f32 v11, 0x42000000, v7
    v_mul_f32 v11, 0x3a000000, v11
    v_mul_f32 v12, v13, v11
    v_fmamk_f32 v48, v11, 0x00000000, v12
    v_sin_f32 v49, v48
    v_cos_f32 v48, v48
    v_fmamk_f32 v50, v11, 0x3f800000, v12
    v_sin_f32 v51, v50
    v_cos_f32 v50, v50
    v_mul_f32 v52, v132, v48
    v_mul_f32 v54, v148, v48
    v_fma_f32 v52, -v148, v49, v52
    v_fma_f32 v54, v132, v49, v54
    v_mul_f32 v53, v133, v50
    v_mul_f32 v55, v149, v50
    v_fma_f32 v53, -v149, v51, v53
    v_fma_f32 v55, v133, v51, v55
    v_cvt_pk_bf16_f32 v180, v52, v53
    v_cvt_pk_bf16_f32 v188, v54, v55
    v_fmamk_f32 v48, v11, 0x40000000, v12
    v_sin_f32 v49, v48
    v_cos_f32 v48, v48
    v_fmamk_f32 v50, v11, 0x40400000, v12
    v_sin_f32 v51, v50
    v_cos_f32 v50, v50
    v_mul_f32 v52, v134, v48
    v_mul_f32 v54, v150, v48
    v_fma_f32 v52, -v150, v49, v52
    v_fma_f32 v54, v134, v49, v54
    v_mul_f32 v53, v135, v50
    v_mul_f32 v55, v151, v50
    v_fma_f32 v53, -v151, v51, v53
    v_fma_f32 v55, v135, v51, v55
    v_cvt_pk_bf16_f32 v181, v52, v53
    v_cvt_pk_bf16_f32 v189, v54, v55
    v_fmamk_f32 v48, v11, 0x41000000, v12
    v_sin_f32 v49, v48
    v_cos_f32 v48, v48
    v_fmamk_f32 v50, v11, 0x41100000, v12
    v_sin_f32 v51, v50
    v_cos_f32 v50, v50
    v_mul_f32 v52, v136, v48
    v_mul_f32 v54, v152, v48
    v_fma_f32 v52, -v152, v49, v52
    v_fma_f32 v54, v136, v49, v54
    v_mul_f32 v53, v137, v50
    v_mul_f32 v55, v153, v50
    v_fma_f32 v53, -v153, v51, v53
    v_fma_f32 v55, v137, v51, v55
    v_cvt_pk_bf16_f32 v182, v52, v53
    v_cvt_pk_bf16_f32 v190, v54, v55
    v_fmamk_f32 v48, v11, 0x41200000, v12
    v_sin_f32 v49, v48
    v_cos_f32 v48, v48
    v_fmamk_f32 v50, v11, 0x41300000, v12
    v_sin_f32 v51, v50
    v_cos_f32 v50, v50
    v_mul_f32 v52, v138, v48
    v_mul_f32 v54, v154, v48
    v_fma_f32 v52, -v154, v49, v52
    v_fma_f32 v54, v138, v49, v54
    v_mul_f32 v53, v139, v50
    v_mul_f32 v55, v155, v50
    v_fma_f32 v53, -v155, v51, v53
    v_fma_f32 v55, v139, v51, v55
    v_cvt_pk_bf16_f32 v183, v52, v53
    v_cvt_pk_bf16_f32 v191, v54, v55
    v_fmamk_f32 v48, v11, 0x41800000, v12
    v_sin_f32 v49, v48
    v_cos_f32 v48, v48
    v_fmamk_f32 v50, v11, 0x41880000, v12
    v_sin_f32 v51, v50
    v_cos_f32 v50, v50
    v_mul_f32 v52, v140, v48
    v_mul_f32 v54, v156, v48
    v_fma_f32 v52, -v156, v49, v52
    v_fma_f32 v54, v140, v49, v54
    v_mul_f32 v53, v141, v50
    v_mul_f32 v55, v157, v50
    v_fma_f32 v53, -v157, v51, v53
    v_fma_f32 v55, v141, v51, v55
    v_cvt_pk_bf16_f32 v184, v52, v53
    v_cvt_pk_bf16_f32 v192, v54, v55
    v_fmamk_f32 v48, v11, 0x41900000, v12
    v_sin_f32 v49, v48
    v_cos_f32 v48, v48
    v_fmamk_f32 v50, v11, 0x41980000, v12
    v_sin_f32 v51, v50
    v_cos_f32 v50, v50
    v_mul_f32 v52, v142, v48
    v_mul_f32 v54, v158, v48
    v_fma_f32 v52, -v158, v49, v52
    v_fma_f32 v54, v142, v49, v54
    v_mul_f32 v53, v143, v50
    v_mul_f32 v55, v159, v50
    v_fma_f32 v53, -v159, v51, v53
    v_fma_f32 v55, v143, v51, v55
    v_cvt_pk_bf16_f32 v185, v52, v53
    v_cvt_pk_bf16_f32 v193, v54, v55
    v_fmamk_f32 v48, v11, 0x41c00000, v12
    v_sin_f32 v49, v48
    v_cos_f32 v48, v48
    v_fmamk_f32 v50, v11, 0x41c80000, v12
    v_sin_f32 v51, v50
    v_cos_f32 v50, v50
    v_mul_f32 v52, v144, v48
    v_mul_f32 v54, v160, v48
    v_fma_f32 v52, -v160, v49, v52
    v_fma_f32 v54, v144, v49, v54
    v_mul_f32 v53, v145, v50
    v_mul_f32 v55, v161, v50
    v_fma_f32 v53, -v161, v51, v53
    v_fma_f32 v55, v145, v51, v55
    v_cvt_pk_bf16_f32 v186, v52, v53
    v_cvt_pk_bf16_f32 v194, v54, v55
    v_fmamk_f32 v48, v11, 0x41d00000, v12
    v_sin_f32 v49, v48
    v_cos_f32 v48, v48
    v_fmamk_f32 v50, v11, 0x41d80000, v12
    v_sin_f32 v51, v50
    v_cos_f32 v50, v50
    v_mul_f32 v52, v146, v48
    v_mul_f32 v54, v162, v48
    v_fma_f32 v52, -v162, v49, v52
    v_fma_f32 v54, v146, v49, v54
    v_mul_f32 v53, v147, v50
    v_mul_f32 v55, v163, v50
    v_fma_f32 v53, -v163, v51, v53
    v_fma_f32 v55, v147, v51, v55
    v_cvt_pk_bf16_f32 v187, v52, v53
    v_cvt_pk_bf16_f32 v195, v54, v55
    v_mfma_f32_32x32x16_bf16 v[100:115], v[224:227], v[164:167], 0
    v_mfma_f32_32x32x16_bf16 v[100:115], v[228:231], v[168:171], v[100:115]
    v_mfma_f32_32x32x16_bf16 v[116:131], v[224:227], v[172:175], 0
    v_mfma_f32_32x32x16_bf16 v[116:131], v[228:231], v[176:179], v[116:131]
    v_mfma_f32_32x32x16_bf16 v[100:115], v[240:243], v[172:175], v[100:115]
    v_mfma_f32_32x32x16_bf16 v[100:115], v[244:247], v[176:179], v[100:115]
    v_mfma_f32_32x32x16_bf16 v[116:131], v[232:235], v[164:167], v[116:131]
    v_mfma_f32_32x32x16_bf16 v[116:131], v[236:239], v[168:171], v[116:131]
    v_mfma_f32_32x32x16_bf16 v[132:147], v[224:227], v[180:183], 0
    v_mfma_f32_32x32x16_bf16 v[132:147], v[228:231], v[184:187], v[132:147]
    v_mfma_f32_32x32x16_bf16 v[148:163], v[224:227], v[188:191], 0
    v_mfma_f32_32x32x16_bf16 v[148:163], v[228:231], v[192:195], v[148:163]
    v_mfma_f32_32x32x16_bf16 v[132:147], v[240:243], v[188:191], v[132:147]
    v_mfma_f32_32x32x16_bf16 v[132:147], v[244:247], v[192:195], v[132:147]
    v_mfma_f32_32x32x16_bf16 v[148:163], v[232:235], v[180:183], v[148:163]
    v_mfma_f32_32x32x16_bf16 v[148:163], v[236:239], v[184:187], v[148:163]
    v_cvt_pk_bf16_f32 v100, v100, v116
    ds_write_b32 v10, v100 offset:0
    v_cvt_pk_bf16_f32 v101, v101, v117
    ds_write_b32 v10, v101 offset:1024
    v_cvt_pk_bf16_f32 v102, v102, v118
    ds_write_b32 v10, v102 offset:2048
    v_cvt_pk_bf16_f32 v103, v103, v119
    ds_write_b32 v10, v103 offset:3072
    v_cvt_pk_bf16_f32 v104, v104, v120
    ds_write_b32 v10, v104 offset:8192
    v_cvt_pk_bf16_f32 v105, v105, v121
    ds_write_b32 v10, v105 offset:9216
    v_cvt_pk_bf16_f32 v106, v106, v122
    ds_write_b32 v10, v106 offset:10240
    v_cvt_pk_bf16_f32 v107, v107, v123
    ds_write_b32 v10, v107 offset:11264
    v_cvt_pk_bf16_f32 v108, v108, v124
    ds_write_b32 v10, v108 offset:16384
    v_cvt_pk_bf16_f32 v109, v109, v125
    ds_write_b32 v10, v109 offset:17408
    v_cvt_pk_bf16_f32 v110, v110, v126
    ds_write_b32 v10, v110 offset:18432
    v_cvt_pk_bf16_f32 v111, v111, v127
    ds_write_b32 v10, v111 offset:19456
    v_cvt_pk_bf16_f32 v112, v112, v128
    ds_write_b32 v10, v112 offset:24576
    v_cvt_pk_bf16_f32 v113, v113, v129
    ds_write_b32 v10, v113 offset:25600
    v_cvt_pk_bf16_f32 v114, v114, v130
    ds_write_b32 v10, v114 offset:26624
    v_cvt_pk_bf16_f32 v115, v115, v131
    ds_write_b32 v10, v115 offset:27648
    v_cvt_pk_bf16_f32 v132, v132, v148
    ds_write_b32 v10, v132 offset:512
    v_cvt_pk_bf16_f32 v133, v133, v149
    ds_write_b32 v10, v133 offset:1536
    v_cvt_pk_bf16_f32 v134, v134, v150
    ds_write_b32 v10, v134 offset:2560
    v_cvt_pk_bf16_f32 v135, v135, v151
    ds_write_b32 v10, v135 offset:3584
    v_cvt_pk_bf16_f32 v136, v136, v152
    ds_write_b32 v10, v136 offset:8704
    v_cvt_pk_bf16_f32 v137, v137, v153
    ds_write_b32 v10, v137 offset:9728
    v_cvt_pk_bf16_f32 v138, v138, v154
    ds_write_b32 v10, v138 offset:10752
    v_cvt_pk_bf16_f32 v139, v139, v155
    ds_write_b32 v10, v139 offset:11776
    v_cvt_pk_bf16_f32 v140, v140, v156
    ds_write_b32 v10, v140 offset:16896
    v_cvt_pk_bf16_f32 v141, v141, v157
    ds_write_b32 v10, v141 offset:17920
    v_cvt_pk_bf16_f32 v142, v142, v158
    ds_write_b32 v10, v142 offset:18944
    v_cvt_pk_bf16_f32 v143, v143, v159
    ds_write_b32 v10, v143 offset:19968
    v_cvt_pk_bf16_f32 v144, v144, v160
    ds_write_b32 v10, v144 offset:25088
    v_cvt_pk_bf16_f32 v145, v145, v161
    ds_write_b32 v10, v145 offset:26112
    v_cvt_pk_bf16_f32 v146, v146, v162
    ds_write_b32 v10, v146 offset:27136
    v_cvt_pk_bf16_f32 v147, v147, v163
    ds_write_b32 v10, v147 offset:28160
    s_branch F_a2st
F_a2zero:
    v_mov_b32 v4, 0
    ds_write_b32 v10, v4 offset:0
    ds_write_b32 v10, v4 offset:1024
    ds_write_b32 v10, v4 offset:2048
    ds_write_b32 v10, v4 offset:3072
    ds_write_b32 v10, v4 offset:8192
    ds_write_b32 v10, v4 offset:9216
    ds_write_b32 v10, v4 offset:10240
    ds_write_b32 v10, v4 offset:11264
    ds_write_b32 v10, v4 offset:16384
    ds_write_b32 v10, v4 offset:17408
    ds_write_b32 v10, v4 offset:18432
    ds_write_b32 v10, v4 offset:19456
    ds_write_b32 v10, v4 offset:24576
    ds_write_b32 v10, v4 offset:25600
    ds_write_b32 v10, v4 offset:26624
    ds_write_b32 v10, v4 offset:27648
    ds_write_b32 v10, v4 offset:512
    ds_write_b32 v10, v4 offset:1536
    ds_write_b32 v10, v4 offset:2560
    ds_write_b32 v10, v4 offset:3584
    ds_write_b32 v10, v4 offset:8704
    ds_write_b32 v10, v4 offset:9728
    ds_write_b32 v10, v4 offset:10752
    ds_write_b32 v10, v4 offset:11776
    ds_write_b32 v10, v4 offset:16896
    ds_write_b32 v10, v4 offset:17920
    ds_write_b32 v10, v4 offset:18944
    ds_write_b32 v10, v4 offset:19968
    ds_write_b32 v10, v4 offset:25088
    ds_write_b32 v10, v4 offset:26112
    ds_write_b32 v10, v4 offset:27136
    ds_write_b32 v10, v4 offset:28160
F_a2st:
    s_waitcnt lgkmcnt(0)
    s_barrier
    v_lshlrev_b32 v7, 4, v0
    s_lshl_b32 s13, s12, 15
    s_add_u32 s13, s13, 106954752
    ds_read_b128 v[16:19], v7 offset:0
    ds_read_b128 v[20:23], v7 offset:4096
    ds_read_b128 v[24:27], v7 offset:8192
    ds_read_b128 v[28:31], v7 offset:12288
    ds_read_b128 v[32:35], v7 offset:16384
    ds_read_b128 v[36:39], v7 offset:20480
    ds_read_b128 v[40:43], v7 offset:24576
    ds_read_b128 v[44:47], v7 offset:28672
    s_waitcnt lgkmcnt(7)
    buffer_store_dwordx4 v[16:19], v7, s[8:11], s13 offen sc1
    s_add_u32 s13, s13, 4096
    s_waitcnt lgkmcnt(6)
    buffer_store_dwordx4 v[20:23], v7, s[8:11], s13 offen sc1
    s_add_u32 s13, s13, 4096
    s_waitcnt lgkmcnt(5)
    buffer_store_dwordx4 v[24:27], v7, s[8:11], s13 offen sc1
    s_add_u32 s13, s13, 4096
    s_waitcnt lgkmcnt(4)
    buffer_store_dwordx4 v[28:31], v7, s[8:11], s13 offen sc1
    s_add_u32 s13, s13, 4096
    s_waitcnt lgkmcnt(3)
    buffer_store_dwordx4 v[32:35], v7, s[8:11], s13 offen sc1
    s_add_u32 s13, s13, 4096
    s_waitcnt lgkmcnt(2)
    buffer_store_dwordx4 v[36:39], v7, s[8:11], s13 offen sc1
    s_add_u32 s13, s13, 4096
    s_waitcnt lgkmcnt(1)
    buffer_store_dwordx4 v[40:43], v7, s[8:11], s13 offen sc1
    s_add_u32 s13, s13, 4096
    s_waitcnt lgkmcnt(0)
    buffer_store_dwordx4 v[44:47], v7, s[8:11], s13 offen sc1
    s_add_u32 s13, s13, 4096
F_a2done:
    s_waitcnt vmcnt(0)
    s_barrier
    s_cmp_lg_u32 s6, 0
    s_cbranch_scc1 FB_na72
    s_mov_b64 exec, 1
    v_mov_b32 v4, 72
    v_mov_b32 v5, 1
    global_atomic_add v4, v5, s[40:41]
    s_mov_b64 exec, -1
FB_na72:
    v_mov_b32 v4, 72
FB_w72:
    s_mov_b64 exec, 1
    global_load_dword v5, v4, s[40:41] sc1
    s_waitcnt vmcnt(0)
    v_readfirstlane_b32 s13, v5
    s_mov_b64 exec, -1
    s_add_u32 s19, s19, 1
    s_cmp_gt_u32 s19, 0x80000
    s_cbranch_scc1 FB_d72
    s_cmp_ge_u32 s13, 96
    s_cbranch_scc1 FB_d72
    s_sleep 8
    s_branch FB_w72
FB_d72:
    s_cmp_ge_u32 s22, 21
    s_cbranch_scc1 F_a3done
    v_lshlrev_b32 v7, 4, v3
    v_mov_b32 v9, v7
    v_lshl_add_u32 v7, v2, 15, v7
    v_mul_u32_u24 v10, 2304, v3
    v_lshl_add_u32 v10, v2, 5, v10
    s_mov_b32 s16, s22
    s_mov_b32 s42, 0x35e38e39
    s_mov_b32 s43, 0x35e38e39
F_a3loop:
    s_lshl_b32 s13, s16, 9
    s_add_u32 s13, s13, 106954752
    s_mul_i32 s20, s16, 73728
    s_lshl_b32 s14, s23, 6
    s_add_u32 s20, s20, s14
    buffer_load_dwordx4 v[100:103], v7, s[8:11], s13 offen sc1
    s_add_u32 s13, s13, 65536
    buffer_load_dwordx4 v[104:107], v7, s[8:11], s13 offen sc1
    s_add_u32 s13, s13, 65536
    buffer_load_dwordx4 v[108:111], v7, s[8:11], s13 offen sc1
    s_add_u32 s13, s13, 65536
    buffer_load_dwordx4 v[112:115], v7, s[8:11], s13 offen sc1
    s_add_u32 s13, s13, 65536
    buffer_load_dwordx4 v[116:119], v7, s[8:11], s13 offen sc1
    s_add_u32 s13, s13, 65536
    buffer_load_dwordx4 v[120:123], v7, s[8:11], s13 offen sc1
    s_add_u32 s13, s13, 65536
    buffer_load_dwordx4 v[124:127], v7, s[8:11], s13 offen sc1
    s_add_u32 s13, s13, 65536
    buffer_load_dwordx4 v[128:131], v7, s[8:11], s13 offen sc1
    s_add_u32 s13, s13, 65536
    buffer_load_dwordx4 v[132:135], v7, s[8:11], s13 offen sc1
    s_add_u32 s13, s13, 65536
    buffer_load_dwordx4 v[136:139], v7, s[8:11], s13 offen sc1
    s_add_u32 s13, s13, 65536
    buffer_load_dwordx4 v[140:143], v7, s[8:11], s13 offen sc1
    s_add_u32 s13, s13, 65536
    buffer_load_dwordx4 v[144:147], v7, s[8:11], s13 offen sc1
    s_add_u32 s13, s13, 65536
    buffer_load_dwordx4 v[148:151], v7, s[8:11], s13 offen sc1
    s_add_u32 s13, s13, 65536
    buffer_load_dwordx4 v[152:155], v7, s[8:11], s13 offen sc1
    s_add_u32 s13, s13, 65536
    buffer_load_dwordx4 v[156:159], v7, s[8:11], s13 offen sc1
    s_add_u32 s13, s13, 65536
    buffer_load_dwordx4 v[160:163], v7, s[8:11], s13 offen sc1
    s_add_u32 s13, s13, 65536
    buffer_load_dwordx4 v[164:167], v7, s[8:11], s13 offen sc1
    s_add_u32 s13, s13, 65536
    buffer_load_dwordx4 v[168:171], v7, s[8:11], s13 offen sc1
    s_add_u32 s13, s13, 65536
    buffer_load_dwordx4 v[172:175], v7, s[8:11], s13 offen sc1
    s_add_u32 s13, s13, 65536
    buffer_load_dwordx4 v[176:179], v7, s[8:11], s13 offen sc1
    s_add_u32 s13, s13, 65536
    buffer_load_dwordx4 v[180:183], v7, s[8:11], s13 offen sc1
    s_add_u32 s13, s13, 65536
    buffer_load_dwordx4 v[184:187], v7, s[8:11], s13 offen sc1
    s_add_u32 s13, s13, 65536
    buffer_load_dwordx4 v[188:191], v7, s[8:11], s13 offen sc1
    s_add_u32 s13, s13, 65536
    buffer_load_dwordx4 v[192:195], v7, s[8:11], s13 offen sc1
    s_add_u32 s13, s13, 65536
    buffer_load_dwordx4 v[196:199], v7, s[8:11], s13 offen sc1
    s_add_u32 s13, s13, 65536
    buffer_load_dwordx4 v[200:203], v7, s[8:11], s13 offen sc1
    s_add_u32 s13, s13, 65536
    buffer_load_dwordx4 v[204:207], v7, s[8:11], s13 offen sc1
    s_add_u32 s13, s13, 65536
    buffer_load_dwordx4 v[208:211], v7, s[8:11], s13 offen sc1
    s_add_u32 s13, s13, 65536
    buffer_load_dwordx4 v[212:215], v7, s[8:11], s13 offen sc1
    s_add_u32 s13, s13, 65536
    buffer_load_dwordx4 v[216:219], v7, s[8:11], s13 offen sc1
    s_add_u32 s13, s13, 65536
    buffer_load_dwordx4 v[220:223], v7, s[8:11], s13 offen sc1
    s_add_u32 s13, s13, 65536
    buffer_load_dwordx4 v[224:227], v7, s[8:11], s13 offen sc1
    s_add_u32 s13, s13, 65536
    buffer_load_dwordx4 v[228:231], v7, s[8:11], s13 offen sc1
    s_add_u32 s13, s13, 65536
    buffer_load_dwordx4 v[232:235], v7, s[8:11], s13 offen sc1
    s_add_u32 s13, s13, 65536
    buffer_load_dwordx4 v[236:239], v7, s[8:11], s13 offen sc1
    s_add_u32 s13, s13, 65536
    buffer_load_dwordx4 v[240:243], v7, s[8:11], s13 offen sc1
    s_add_u32 s13, s13, 65536
    buffer_load_dwordx4 v[244:247], v9, s[8:11], s13 offen sc1
    s_add_u32 s13, s13, 65536
    s_waitcnt vmcnt(36)
    v_mfma_f32_32x32x16_bf16 v[16:31], a[96:99], v[100:103], 0
    s_waitcnt vmcnt(35)
    v_mfma_f32_32x32x16_bf16 v[16:31], a[100:103], v[104:107], v[16:31]
    s_waitcnt vmcnt(34)
    v_mfma_f32_32x32x16_bf16 v[16:31], a[104:107], v[108:111], v[16:31]
    s_waitcnt vmcnt(33)
    v_mfma_f32_32x32x16_bf16 v[16:31], a[108:111], v[112:115], v[16:31]
    s_waitcnt vmcnt(32)
    v_mfma_f32_32x32x16_bf16 v[16:31], a[112:115], v[116:119], v[16:31]
    s_waitcnt vmcnt(31)
    v_mfma_f32_32x32x16_bf16 v[16:31], a[116:119], v[120:123], v[16:31]
    s_waitcnt vmcnt(30)
    v_mfma_f32_32x32x16_bf16 v[16:31], a[120:123], v[124:127], v[16:31]
    s_waitcnt vmcnt(29)
    v_mfma_f32_32x32x16_bf16 v[16:31], a[124:127], v[128:131], v[16:31]
    s_waitcnt vmcnt(28)
    v_mfma_f32_32x32x16_bf16 v[16:31], a[128:131], v[132:135], v[16:31]
    s_waitcnt vmcnt(27)
    v_mfma_f32_32x32x16_bf16 v[16:31], a[132:135], v[136:139], v[16:31]
    s_waitcnt vmcnt(26)
    v_mfma_f32_32x32x16_bf16 v[16:31], a[136:139], v[140:143], v[16:31]
    s_waitcnt vmcnt(25)
    v_mfma_f32_32x32x16_bf16 v[16:31], a[140:143], v[144:147], v[16:31]
    s_waitcnt vmcnt(24)
    v_mfma_f32_32x32x16_bf16 v[16:31], a[144:147], v[148:151], v[16:31]
    s_waitcnt vmcnt(23)
    v_mfma_f32_32x32x16_bf16 v[16:31], a[148:151], v[152:155], v[16:31]
    s_waitcnt vmcnt(22)
    v_mfma_f32_32x32x16_bf16 v[16:31], a[152:155], v[156:159], v[16:31]
    s_waitcnt vmcnt(21)
    v_mfma_f32_32x32x16_bf16 v[16:31], a[156:159], v[160:163], v[16:31]
    s_waitcnt vmcnt(20)
    v_mfma_f32_32x32x16_bf16 v[16:31], a[160:163], v[164:167], v[16:31]
    s_waitcnt vmcnt(19)
    v_mfma_f32_32x32x16_bf16 v[16:31], a[164:167], v[168:171], v[16:31]
    s_waitcnt vmcnt(18)
    v_mfma_f32_32x32x16_bf16 v[16:31], a[168:171], v[172:175], v[16:31]
    s_waitcnt vmcnt(17)
    v_mfma_f32_32x32x16_bf16 v[16:31], a[172:175], v[176:179], v[16:31]
    s_waitcnt vmcnt(16)
    v_mfma_f32_32x32x16_bf16 v[16:31], a[176:179], v[180:183], v[16:31]
    s_waitcnt vmcnt(15)
    v_mfma_f32_32x32x16_bf16 v[16:31], a[180:183], v[184:187], v[16:31]
    s_waitcnt vmcnt(14)
    v_mfma_f32_32x32x16_bf16 v[16:31], a[184:187], v[188:191], v[16:31]
    s_waitcnt vmcnt(13)
    v_mfma_f32_32x32x16_bf16 v[16:31], a[188:191], v[192:195], v[16:31]
    s_waitcnt vmcnt(12)
    v_mfma_f32_32x32x16_bf16 v[16:31], a[192:195], v[196:199], v[16:31]
    s_waitcnt vmcnt(11)
    v_mfma_f32_32x32x16_bf16 v[16:31], a[196:199], v[200:203], v[16:31]
    s_waitcnt vmcnt(10)
    v_mfma_f32_32x32x16_bf16 v[16:31], a[200:203], v[204:207], v[16:31]
    s_waitcnt vmcnt(9)
    v_mfma_f32_32x32x16_bf16 v[16:31], a[204:207], v[208:211], v[16:31]
    s_waitcnt vmcnt(8)
    v_mfma_f32_32x32x16_bf16 v[16:31], a[208:211], v[212:215], v[16:31]
    s_waitcnt vmcnt(7)
    v_mfma_f32_32x32x16_bf16 v[16:31], a[212:215], v[216:219], v[16:31]
    s_waitcnt vmcnt(6)
    v_mfma_f32_32x32x16_bf16 v[16:31], a[216:219], v[220:223], v[16:31]
    s_waitcnt vmcnt(5)
    v_mfma_f32_32x32x16_bf16 v[16:31], a[220:223], v[224:227], v[16:31]
    s_waitcnt vmcnt(4)
    v_mfma_f32_32x32x16_bf16 v[16:31], a[224:227], v[228:231], v[16:31]
    s_waitcnt vmcnt(3)
    v_mfma_f32_32x32x16_bf16 v[16:31], a[228:231], v[232:235], v[16:31]
    s_waitcnt vmcnt(2)
    v_mfma_f32_32x32x16_bf16 v[16:31], a[232:235], v[236:239], v[16:31]
    s_waitcnt vmcnt(1)
    v_mfma_f32_32x32x16_bf16 v[16:31], a[236:239], v[240:243], v[16:31]
    s_waitcnt vmcnt(0)
    v_mfma_f32_32x32x16_bf16 v[16:31], a[240:243], v[244:247], v[16:31]
    s_nop 11
    v_pk_mul_f32 v[16:17], v[16:17], s[42:43]
    v_pk_mul_f32 v[18:19], v[18:19], s[42:43]
    v_pk_mul_f32 v[20:21], v[20:21], s[42:43]
    v_pk_mul_f32 v[22:23], v[22:23], s[42:43]
    v_pk_mul_f32 v[24:25], v[24:25], s[42:43]
    v_pk_mul_f32 v[26:27], v[26:27], s[42:43]
    v_pk_mul_f32 v[28:29], v[28:29], s[42:43]
    v_pk_mul_f32 v[30:31], v[30:31], s[42:43]
    v_cvt_pk_bf16_f32 v16, v16, v17
    v_cvt_pk_bf16_f32 v17, v18, v19
    v_cvt_pk_bf16_f32 v18, v20, v21
    v_cvt_pk_bf16_f32 v19, v22, v23
    v_cvt_pk_bf16_f32 v20, v24, v25
    v_cvt_pk_bf16_f32 v21, v26, v27
    v_cvt_pk_bf16_f32 v22, v28, v29
    v_cvt_pk_bf16_f32 v23, v30, v31
    buffer_store_dwordx4 v[16:19], v10, s[36:39], s20 offen
    buffer_store_dwordx4 v[20:23], v10, s[36:39], s20 offen offset:16
    s_add_u32 s16, s16, 21
    s_cmp_lt_u32 s16, 64
    s_waitcnt vmcnt(0)
    s_cbranch_scc1 F_a3loop
F_a3done:
    s_load_dwordx2 s[24:25], s[0:1], 64
    s_mov_b32 s26, 4718592
    s_mov_b32 s27, 0x00020000
    s_mul_i32 s13, s12, 171
    s_lshr_b32 s13, s13, 11
    s_mul_i32 s14, s13, 12
    s_sub_u32 s44, s12, s14
    s_and_b32 s45, s13, 3
    s_lshr_b32 s53, s13, 2
    v_and_b32 v1, 63, v0
    v_lshlrev_b32 v2, 4, v1
    v_mov_b32 v7, s7
    v_lshrrev_b32 v3, 1, v1
    v_mul_u32_u24 v3, 1152, v3
    v_and_b32 v8, 1, v1
    v_lshl_add_u32 v3, v8, 4, v3
    v_lshrrev_b32 v8, 5, v1
    v_lshlrev_b32 v4, 4, v8
    v_bfe_u32 v8, v1, 2, 3
    v_add_u32 v4, v4, v8
    v_lshlrev_b32 v4, 5, v4
    v_and_b32 v8, 3, v1
    v_lshl_add_u32 v4, v8, 3, v4
    s_mul_i32 s48, s6, 40960
    v_add_u32 v4, s48, v4
    s_mul_i32 s47, s6, 1179648
    s_mul_i32 s13, s44, 96
    s_add_u32 s47, s47, s13
    s_lshl_b32 s13, s6, 11
    v_lshlrev_b32 v5, 6, v1
    v_add_u32 v5, s13, v5
    v_and_b32 v8, 15, v1
    v_mul_u32_u24 v6, 2304, v8
    v_lshrrev_b32 v8, 4, v1
    v_lshl_add_u32 v6, v8, 3, v6
    v_and_b32 v12, 0x370, v2
    s_and_b32 s13, s45, 1
    s_lshl_b32 s13, s13, 7
    v_add_u32 v12, s13, v12
    v_mov_b32 v8, 2146435072
    v_and_b32 v9, 8, v1
    v_cmp_eq_u32 vcc, 0, v9
    s_nop 1
    v_cndmask_b32 v6, v8, v6, vcc
    s_mul_i32 s13, s6, 3072
    v_add_u32 v10, s13, v2
    s_lshl_b32 s13, s6, 10
    v_add_u32 v11, s13, v2
    s_waitcnt lgkmcnt(0)
    s_add_u32 s13, s47, 0
    s_add_u32 m0, s48, 0
    s_nop 0
    buffer_load_dwordx4 v3, s[24:27], s13 offen lds
    s_add_u32 s13, s47, 36864
    s_add_u32 m0, s48, 1024
    s_nop 0
    buffer_load_dwordx4 v3, s[24:27], s13 offen lds
    s_add_u32 s13, s47, 73728
    s_add_u32 m0, s48, 2048
    s_nop 0
    buffer_load_dwordx4 v3, s[24:27], s13 offen lds
    s_add_u32 s13, s47, 110592
    s_add_u32 m0, s48, 3072
    s_nop 0
    buffer_load_dwordx4 v3, s[24:27], s13 offen lds
    s_add_u32 s13, s47, 32
    s_add_u32 m0, s48, 4096
    s_nop 0
    buffer_load_dwordx4 v3, s[24:27], s13 offen lds
    s_add_u32 s13, s47, 36896
    s_add_u32 m0, s48, 5120
    s_nop 0
    buffer_load_dwordx4 v3, s[24:27], s13 offen lds
    s_add_u32 s13, s47, 73760
    s_add_u32 m0, s48, 6144
    s_nop 0
    buffer_load_dwordx4 v3, s[24:27], s13 offen lds
    s_add_u32 s13, s47, 110624
    s_add_u32 m0, s48, 7168
    s_nop 0
    buffer_load_dwordx4 v3, s[24:27], s13 offen lds
    s_add_u32 s13, s47, 64
    s_add_u32 m0, s48, 8192
    s_nop 0
    buffer_load_dwordx4 v3, s[24:27], s13 offen lds
    s_add_u32 s13, s47, 36928
    s_add_u32 m0, s48, 9216
    s_nop 0
    buffer_load_dwordx4 v3, s[24:27], s13 offen lds
    s_add_u32 s13, s47, 73792
    s_add_u32 m0, s48, 10240
    s_nop 0
    buffer_load_dwordx4 v3, s[24:27], s13 offen lds
    s_add_u32 s13, s47, 110656
    s_add_u32 m0, s48, 11264
    s_nop 0
    buffer_load_dwordx4 v3, s[24:27], s13 offen lds
    s_add_u32 s13, s47, 147456
    s_add_u32 m0, s48, 12288
    s_nop 0
    buffer_load_dwordx4 v3, s[24:27], s13 offen lds
    s_add_u32 s13, s47, 184320
    s_add_u32 m0, s48, 13312
    s_nop 0
    buffer_load_dwordx4 v3, s[24:27], s13 offen lds
    s_add_u32 s13, s47, 221184
    s_add_u32 m0, s48, 14336
    s_nop 0
    buffer_load_dwordx4 v3, s[24:27], s13 offen lds
    s_add_u32 s13, s47, 258048
    s_add_u32 m0, s48, 15360
    s_nop 0
    buffer_load_dwordx4 v3, s[24:27], s13 offen lds
    s_add_u32 s13, s47, 147488
    s_add_u32 m0, s48, 16384
    s_nop 0
    buffer_load_dwordx4 v3, s[24:27], s13 offen lds
    s_add_u32 s13, s47, 184352
    s_add_u32 m0, s48, 17408
    s_nop 0
    buffer_load_dwordx4 v3, s[24:27], s13 offen lds
    s_add_u32 s13, s47, 221216
    s_add_u32 m0, s48, 18432
    s_nop 0
    buffer_load_dwordx4 v3, s[24:27], s13 offen lds
    s_add_u32 s13, s47, 258080
    s_add_u32 m0, s48, 19456
    s_nop 0
    buffer_load_dwordx4 v3, s[24:27], s13 offen lds
    s_add_u32 s13, s47, 147520
    s_add_u32 m0, s48, 20480
    s_nop 0
    buffer_load_dwordx4 v3, s[24:27], s13 offen lds
    s_add_u32 s13, s47, 184384
    s_add_u32 m0, s48, 21504
    s_nop 0
    buffer_load_dwordx4 v3, s[24:27], s13 offen lds
    s_add_u32 s13, s47, 221248
    s_add_u32 m0, s48, 22528
    s_nop 0
    buffer_load_dwordx4 v3, s[24:27], s13 offen lds
    s_add_u32 s13, s47, 258112
    s_add_u32 m0, s48, 23552
    s_nop 0
    buffer_load_dwordx4 v3, s[24:27], s13 offen lds
    s_add_u32 s13, s47, 294912
    s_add_u32 m0, s48, 24576
    s_nop 0
    buffer_load_dwordx4 v3, s[24:27], s13 offen lds
    s_add_u32 s13, s47, 331776
    s_add_u32 m0, s48, 25600
    s_nop 0
    buffer_load_dwordx4 v3, s[24:27], s13 offen lds
    s_add_u32 s13, s47, 368640
    s_add_u32 m0, s48, 26624
    s_nop 0
    buffer_load_dwordx4 v3, s[24:27], s13 offen lds
    s_add_u32 s13, s47, 405504
    s_add_u32 m0, s48, 27648
    s_nop 0
    buffer_load_dwordx4 v3, s[24:27], s13 offen lds
    s_add_u32 s13, s47, 294944
    s_add_u32 m0, s48, 28672
    s_nop 0
    buffer_load_dwordx4 v3, s[24:27], s13 offen lds
    s_add_u32 s13, s47, 331808
    s_add_u32 m0, s48, 29696
    s_nop 0
    buffer_load_dwordx4 v3, s[24:27], s13 offen lds
    s_add_u32 s13, s47, 368672
    s_add_u32 m0, s48, 30720
    s_nop 0
    buffer_load_dwordx4 v3, s[24:27], s13 offen lds
    s_add_u32 s13, s47, 405536
    s_add_u32 m0, s48, 31744
    s_nop 0
    buffer_load_dwordx4 v3, s[24:27], s13 offen lds
    s_add_u32 s13, s47, 294976
    s_add_u32 m0, s48, 32768
    s_nop 0
    buffer_load_dwordx4 v3, s[24:27], s13 offen lds
    s_add_u32 s13, s47, 331840
    s_add_u32 m0, s48, 33792
    s_nop 0
    buffer_load_dwordx4 v3, s[24:27], s13 offen lds
    s_add_u32 s13, s47, 368704
    s_add_u32 m0, s48, 34816
    s_nop 0
    buffer_load_dwordx4 v3, s[24:27], s13 offen lds
    s_add_u32 s13, s47, 405568
    s_add_u32 m0, s48, 35840
    s_nop 0
    buffer_load_dwordx4 v3, s[24:27], s13 offen lds
    s_waitcnt vmcnt(24)
    ds_read_b64_tr_b16 a[0:1], v4 offset:0
    ds_read_b64_tr_b16 a[2:3], v4 offset:256
    ds_read_b64_tr_b16 a[4:5], v4 offset:4096
    ds_read_b64_tr_b16 a[6:7], v4 offset:4352
    ds_read_b64_tr_b16 a[8:9], v4 offset:8192
    ds_read_b64_tr_b16 a[10:11], v4 offset:8448
    s_waitcnt lgkmcnt(0)
    ds_read_b64_tr_b16 a[12:13], v4 offset:1024
    ds_read_b64_tr_b16 a[14:15], v4 offset:1280
    ds_read_b64_tr_b16 a[16:17], v4 offset:5120
    ds_read_b64_tr_b16 a[18:19], v4 offset:5376
    ds_read_b64_tr_b16 a[20:21], v4 offset:9216
    ds_read_b64_tr_b16 a[22:23], v4 offset:9472
    s_waitcnt lgkmcnt(0)
    ds_read_b64_tr_b16 a[24:25], v4 offset:2048
    ds_read_b64_tr_b16 a[26:27], v4 offset:2304
    ds_read_b64_tr_b16 a[28:29], v4 offset:6144
    ds_read_b64_tr_b16 a[30:31], v4 offset:6400
    ds_read_b64_tr_b16 a[32:33], v4 offset:10240
    ds_read_b64_tr_b16 a[34:35], v4 offset:10496
    s_waitcnt lgkmcnt(0)
    ds_read_b64_tr_b16 a[36:37], v4 offset:3072
    ds_read_b64_tr_b16 a[38:39], v4 offset:3328
    ds_read_b64_tr_b16 a[40:41], v4 offset:7168
    ds_read_b64_tr_b16 a[42:43], v4 offset:7424
    ds_read_b64_tr_b16 a[44:45], v4 offset:11264
    ds_read_b64_tr_b16 a[46:47], v4 offset:11520
    s_waitcnt lgkmcnt(0)
    s_add_u32 s13, s47, 442368
    s_add_u32 m0, s48, 0
    s_nop 0
    buffer_load_dwordx4 v3, s[24:27], s13 offen lds
    s_add_u32 s13, s47, 479232
    s_add_u32 m0, s48, 1024
    s_nop 0
    buffer_load_dwordx4 v3, s[24:27], s13 offen lds
    s_add_u32 s13, s47, 516096
    s_add_u32 m0, s48, 2048
    s_nop 0
    buffer_load_dwordx4 v3, s[24:27], s13 offen lds
    s_add_u32 s13, s47, 552960
    s_add_u32 m0, s48, 3072
    s_nop 0
    buffer_load_dwordx4 v3, s[24:27], s13 offen lds
    s_add_u32 s13, s47, 442400
    s_add_u32 m0, s48, 4096
    s_nop 0
    buffer_load_dwordx4 v3, s[24:27], s13 offen lds
    s_add_u32 s13, s47, 479264
    s_add_u32 m0, s48, 5120
    s_nop 0
    buffer_load_dwordx4 v3, s[24:27], s13 offen lds
    s_add_u32 s13, s47, 516128
    s_add_u32 m0, s48, 6144
    s_nop 0
    buffer_load_dwordx4 v3, s[24:27], s13 offen lds
    s_add_u32 s13, s47, 552992
    s_add_u32 m0, s48, 7168
    s_nop 0
    buffer_load_dwordx4 v3, s[24:27], s13 offen lds
    s_add_u32 s13, s47, 442432
    s_add_u32 m0, s48, 8192
    s_nop 0
    buffer_load_dwordx4 v3, s[24:27], s13 offen lds
    s_add_u32 s13, s47, 479296
    s_add_u32 m0, s48, 9216
    s_nop 0
    buffer_load_dwordx4 v3, s[24:27], s13 offen lds
    s_add_u32 s13, s47, 516160
    s_add_u32 m0, s48, 10240
    s_nop 0
    buffer_load_dwordx4 v3, s[24:27], s13 offen lds
    s_add_u32 s13, s47, 553024
    s_add_u32 m0, s48, 11264
    s_nop 0
    buffer_load_dwordx4 v3, s[24:27], s13 offen lds
    s_waitcnt vmcnt(24)
    ds_read_b64_tr_b16 a[48:49], v4 offset:12288
    ds_read_b64_tr_b16 a[50:51], v4 offset:12544
    ds_read_b64_tr_b16 a[52:53], v4 offset:16384
    ds_read_b64_tr_b16 a[54:55], v4 offset:16640
    ds_read_b64_tr_b16 a[56:57], v4 offset:20480
    ds_read_b64_tr_b16 a[58:59], v4 offset:20736
    s_waitcnt lgkmcnt(0)
    ds_read_b64_tr_b16 a[60:61], v4 offset:13312
    ds_read_b64_tr_b16 a[62:63], v4 offset:13568
    ds_read_b64_tr_b16 a[64:65], v4 offset:17408
    ds_read_b64_tr_b16 a[66:67], v4 offset:17664
    ds_read_b64_tr_b16 a[68:69], v4 offset:21504
    ds_read_b64_tr_b16 a[70:71], v4 offset:21760
    s_waitcnt lgkmcnt(0)
    ds_read_b64_tr_b16 a[72:73], v4 offset:14336
    ds_read_b64_tr_b16 a[74:75], v4 offset:14592
    ds_read_b64_tr_b16 a[76:77], v4 offset:18432
    ds_read_b64_tr_b16 a[78:79], v4 offset:18688
    ds_read_b64_tr_b16 a[80:81], v4 offset:22528
    ds_read_b64_tr_b16 a[82:83], v4 offset:22784
    s_waitcnt lgkmcnt(0)
    ds_read_b64_tr_b16 a[84:85], v4 offset:15360
    ds_read_b64_tr_b16 a[86:87], v4 offset:15616
    ds_read_b64_tr_b16 a[88:89], v4 offset:19456
    ds_read_b64_tr_b16 a[90:91], v4 offset:19712
    ds_read_b64_tr_b16 a[92:93], v4 offset:23552
    ds_read_b64_tr_b16 a[94:95], v4 offset:23808
    s_waitcnt lgkmcnt(0)
    s_add_u32 s13, s47, 589824
    s_add_u32 m0, s48, 12288
    s_nop 0
    buffer_load_dwordx4 v3, s[24:27], s13 offen lds
    s_add_u32 s13, s47, 626688
    s_add_u32 m0, s48, 13312
    s_nop 0
    buffer_load_dwordx4 v3, s[24:27], s13 offen lds
    s_add_u32 s13, s47, 663552
    s_add_u32 m0, s48, 14336
    s_nop 0
    buffer_load_dwordx4 v3, s[24:27], s13 offen lds
    s_add_u32 s13, s47, 700416
    s_add_u32 m0, s48, 15360
    s_nop 0
    buffer_load_dwordx4 v3, s[24:27], s13 offen lds
    s_add_u32 s13, s47, 589856
    s_add_u32 m0, s48, 16384
    s_nop 0
    buffer_load_dwordx4 v3, s[24:27], s13 offen lds
    s_add_u32 s13, s47, 626720
    s_add_u32 m0, s48, 17408
    s_nop 0
    buffer_load_dwordx4 v3, s[24:27], s13 offen lds
    s_add_u32 s13, s47, 663584
    s_add_u32 m0, s48, 18432
    s_nop 0
    buffer_load_dwordx4 v3, s[24:27], s13 offen lds
    s_add_u32 s13, s47, 700448
    s_add_u32 m0, s48, 19456
    s_nop 0
    buffer_load_dwordx4 v3, s[24:27], s13 offen lds
    s_add_u32 s13, s47, 589888
    s_add_u32 m0, s48, 20480
    s_nop 0
    buffer_load_dwordx4 v3, s[24:27], s13 offen lds
    s_add_u32 s13, s47, 626752
    s_add_u32 m0, s48, 21504
    s_nop 0
    buffer_load_dwordx4 v3, s[24:27], s13 offen lds
    s_add_u32 s13, s47, 663616
    s_add_u32 m0, s48, 22528
    s_nop 0
    buffer_load_dwordx4 v3, s[24:27], s13 offen lds
    s_add_u32 s13, s47, 700480
    s_add_u32 m0, s48, 23552
    s_nop 0
    buffer_load_dwordx4 v3, s[24:27], s13 offen lds
    s_waitcnt vmcnt(24)
    ds_read_b64_tr_b16 a[96:97], v4 offset:24576
    ds_read_b64_tr_b16 a[98:99], v4 offset:24832
    ds_read_b64_tr_b16 a[100:101], v4 offset:28672
    ds_read_b64_tr_b16 a[102:103], v4 offset:28928
    ds_read_b64_tr_b16 a[104:105], v4 offset:32768
    ds_read_b64_tr_b16 a[106:107], v4 offset:33024
    s_waitcnt lgkmcnt(0)
    ds_read_b64_tr_b16 a[108:109], v4 offset:25600
    ds_read_b64_tr_b16 a[110:111], v4 offset:25856
    ds_read_b64_tr_b16 a[112:113], v4 offset:29696
    ds_read_b64_tr_b16 a[114:115], v4 offset:29952
    ds_read_b64_tr_b16 a[116:117], v4 offset:33792
    ds_read_b64_tr_b16 a[118:119], v4 offset:34048
    s_waitcnt lgkmcnt(0)
    ds_read_b64_tr_b16 a[120:121], v4 offset:26624
    ds_read_b64_tr_b16 a[122:123], v4 offset:26880
    ds_read_b64_tr_b16 a[124:125], v4 offset:30720
    ds_read_b64_tr_b16 a[126:127], v4 offset:30976
    ds_read_b64_tr_b16 a[128:129], v4 offset:34816
    ds_read_b64_tr_b16 a[130:131], v4 offset:35072
    s_waitcnt lgkmcnt(0)
    ds_read_b64_tr_b16 a[132:133], v4 offset:27648
    ds_read_b64_tr_b16 a[134:135], v4 offset:27904
    ds_read_b64_tr_b16 a[136:137], v4 offset:31744
    ds_read_b64_tr_b16 a[138:139], v4 offset:32000
    ds_read_b64_tr_b16 a[140:141], v4 offset:35840
    ds_read_b64_tr_b16 a[142:143], v4 offset:36096
    s_waitcnt lgkmcnt(0)
    s_add_u32 s13, s47, 737280
    s_add_u32 m0, s48, 24576
    s_nop 0
    buffer_load_dwordx4 v3, s[24:27], s13 offen lds
    s_add_u32 s13, s47, 774144
    s_add_u32 m0, s48, 25600
    s_nop 0
    buffer_load_dwordx4 v3, s[24:27], s13 offen lds
    s_add_u32 s13, s47, 811008
    s_add_u32 m0, s48, 26624
    s_nop 0
    buffer_load_dwordx4 v3, s[24:27], s13 offen lds
    s_add_u32 s13, s47, 847872
    s_add_u32 m0, s48, 27648
    s_nop 0
    buffer_load_dwordx4 v3, s[24:27], s13 offen lds
    s_add_u32 s13, s47, 737312
    s_add_u32 m0, s48, 28672
    s_nop 0
    buffer_load_dwordx4 v3, s[24:27], s13 offen lds
    s_add_u32 s13, s47, 774176
    s_add_u32 m0, s48, 29696
    s_nop 0
    buffer_load_dwordx4 v3, s[24:27], s13 offen lds
    s_add_u32 s13, s47, 811040
    s_add_u32 m0, s48, 30720
    s_nop 0
    buffer_load_dwordx4 v3, s[24:27], s13 offen lds
    s_add_u32 s13, s47, 847904
    s_add_u32 m0, s48, 31744
    s_nop 0
    buffer_load_dwordx4 v3, s[24:27], s13 offen lds
    s_add_u32 s13, s47, 737344
    s_add_u32 m0, s48, 32768
    s_nop 0
    buffer_load_dwordx4 v3, s[24:27], s13 offen lds
    s_add_u32 s13, s47, 774208
    s_add_u32 m0, s48, 33792
    s_nop 0
    buffer_load_dwordx4 v3, s[24:27], s13 offen lds
    s_add_u32 s13, s47, 811072
    s_add_u32 m0, s48, 34816
    s_nop 0
    buffer_load_dwordx4 v3, s[24:27], s13 offen lds
    s_add_u32 s13, s47, 847936
    s_add_u32 m0, s48, 35840
    s_nop 0
    buffer_load_dwordx4 v3, s[24:27], s13 offen lds
    s_waitcnt vmcnt(24)
    ds_read_b64_tr_b16 a[144:145], v4 offset:0
    ds_read_b64_tr_b16 a[146:147], v4 offset:256
    ds_read_b64_tr_b16 a[148:149], v4 offset:4096
    ds_read_b64_tr_b16 a[150:151], v4 offset:4352
    ds_read_b64_tr_b16 a[152:153], v4 offset:8192
    ds_read_b64_tr_b16 a[154:155], v4 offset:8448
    s_waitcnt lgkmcnt(0)
    ds_read_b64_tr_b16 a[156:157], v4 offset:1024
    ds_read_b64_tr_b16 a[158:159], v4 offset:1280
    ds_read_b64_tr_b16 a[160:161], v4 offset:5120
    ds_read_b64_tr_b16 a[162:163], v4 offset:5376
    ds_read_b64_tr_b16 a[164:165], v4 offset:9216
    ds_read_b64_tr_b16 a[166:167], v4 offset:9472
    s_waitcnt lgkmcnt(0)
    ds_read_b64_tr_b16 a[168:169], v4 offset:2048
    ds_read_b64_tr_b16 a[170:171], v4 offset:2304
    ds_read_b64_tr_b16 a[172:173], v4 offset:6144
    ds_read_b64_tr_b16 a[174:175], v4 offset:6400
    ds_read_b64_tr_b16 a[176:177], v4 offset:10240
    ds_read_b64_tr_b16 a[178:179], v4 offset:10496
    s_waitcnt lgkmcnt(0)
    ds_read_b64_tr_b16 a[180:181], v4 offset:3072
    ds_read_b64_tr_b16 a[182:183], v4 offset:3328
    ds_read_b64_tr_b16 a[184:185], v4 offset:7168
    ds_read_b64_tr_b16 a[186:187], v4 offset:7424
    ds_read_b64_tr_b16 a[188:189], v4 offset:11264
    ds_read_b64_tr_b16 a[190:191], v4 offset:11520
    s_waitcnt lgkmcnt(0)
    s_add_u32 s13, s47, 884736
    s_add_u32 m0, s48, 0
    s_nop 0
    buffer_load_dwordx4 v3, s[24:27], s13 offen lds
    s_add_u32 s13, s47, 921600
    s_add_u32 m0, s48, 1024
    s_nop 0
    buffer_load_dwordx4 v3, s[24:27], s13 offen lds
    s_add_u32 s13, s47, 958464
    s_add_u32 m0, s48, 2048
    s_nop 0
    buffer_load_dwordx4 v3, s[24:27], s13 offen lds
    s_add_u32 s13, s47, 995328
    s_add_u32 m0, s48, 3072
    s_nop 0
    buffer_load_dwordx4 v3, s[24:27], s13 offen lds
    s_add_u32 s13, s47, 884768
    s_add_u32 m0, s48, 4096
    s_nop 0
    buffer_load_dwordx4 v3, s[24:27], s13 offen lds
    s_add_u32 s13, s47, 921632
    s_add_u32 m0, s48, 5120
    s_nop 0
    buffer_load_dwordx4 v3, s[24:27], s13 offen lds
    s_add_u32 s13, s47, 958496
    s_add_u32 m0, s48, 6144
    s_nop 0
    buffer_load_dwordx4 v3, s[24:27], s13 offen lds
    s_add_u32 s13, s47, 995360
    s_add_u32 m0, s48, 7168
    s_nop 0
    buffer_load_dwordx4 v3, s[24:27], s13 offen lds
    s_add_u32 s13, s47, 884800
    s_add_u32 m0, s48, 8192
    s_nop 0
    buffer_load_dwordx4 v3, s[24:27], s13 offen lds
    s_add_u32 s13, s47, 921664
    s_add_u32 m0, s48, 9216
    s_nop 0
    buffer_load_dwordx4 v3, s[24:27], s13 offen lds
    s_add_u32 s13, s47, 958528
    s_add_u32 m0, s48, 10240
    s_nop 0
    buffer_load_dwordx4 v3, s[24:27], s13 offen lds
    s_add_u32 s13, s47, 995392
    s_add_u32 m0, s48, 11264
    s_nop 0
    buffer_load_dwordx4 v3, s[24:27], s13 offen lds
    s_waitcnt vmcnt(24)
    ds_read_b64_tr_b16 a[192:193], v4 offset:12288
    ds_read_b64_tr_b16 a[194:195], v4 offset:12544
    ds_read_b64_tr_b16 a[196:197], v4 offset:16384
    ds_read_b64_tr_b16 a[198:199], v4 offset:16640
    ds_read_b64_tr_b16 a[200:201], v4 offset:20480
    ds_read_b64_tr_b16 a[202:203], v4 offset:20736
    s_waitcnt lgkmcnt(0)
    ds_read_b64_tr_b16 a[204:205], v4 offset:13312
    ds_read_b64_tr_b16 a[206:207], v4 offset:13568
    ds_read_b64_tr_b16 a[208:209], v4 offset:17408
    ds_read_b64_tr_b16 a[210:211], v4 offset:17664
    ds_read_b64_tr_b16 a[212:213], v4 offset:21504
    ds_read_b64_tr_b16 a[214:215], v4 offset:21760
    s_waitcnt lgkmcnt(0)
    ds_read_b64_tr_b16 a[216:217], v4 offset:14336
    ds_read_b64_tr_b16 a[218:219], v4 offset:14592
    ds_read_b64_tr_b16 a[220:221], v4 offset:18432
    ds_read_b64_tr_b16 a[222:223], v4 offset:18688
    ds_read_b64_tr_b16 a[224:225], v4 offset:22528
    ds_read_b64_tr_b16 a[226:227], v4 offset:22784
    s_waitcnt lgkmcnt(0)
    ds_read_b64_tr_b16 a[228:229], v4 offset:15360
    ds_read_b64_tr_b16 a[230:231], v4 offset:15616
    ds_read_b64_tr_b16 a[232:233], v4 offset:19456
    ds_read_b64_tr_b16 a[234:235], v4 offset:19712
    ds_read_b64_tr_b16 a[236:237], v4 offset:23552
    ds_read_b64_tr_b16 a[238:239], v4 offset:23808
    s_waitcnt lgkmcnt(0)
    s_add_u32 s13, s47, 1032192
    s_add_u32 m0, s48, 12288
    s_nop 0
    buffer_load_dwordx4 v3, s[24:27], s13 offen lds
    s_add_u32 s13, s47, 1069056
    s_add_u32 m0, s48, 13312
    s_nop 0
    buffer_load_dwordx4 v3, s[24:27], s13 offen lds
    s_add_u32 s13, s47, 1105920
    s_add_u32 m0, s48, 14336
    s_nop 0
    buffer_load_dwordx4 v3, s[24:27], s13 offen lds
    s_add_u32 s13, s47, 1142784
    s_add_u32 m0, s48, 15360
    s_nop 0
    buffer_load_dwordx4 v3, s[24:27], s13 offen lds
    s_add_u32 s13, s47, 1032224
    s_add_u32 m0, s48, 16384
    s_nop 0
    buffer_load_dwordx4 v3, s[24:27], s13 offen lds
    s_add_u32 s13, s47, 1069088
    s_add_u32 m0, s48, 17408
    s_nop 0
    buffer_load_dwordx4 v3, s[24:27], s13 offen lds
    s_add_u32 s13, s47, 1105952
    s_add_u32 m0, s48, 18432
    s_nop 0
    buffer_load_dwordx4 v3, s[24:27], s13 offen lds
    s_add_u32 s13, s47, 1142816
    s_add_u32 m0, s48, 19456
    s_nop 0
    buffer_load_dwordx4 v3, s[24:27], s13 offen lds
    s_add_u32 s13, s47, 1032256
    s_add_u32 m0, s48, 20480
    s_nop 0
    buffer_load_dwordx4 v3, s[24:27], s13 offen lds
    s_add_u32 s13, s47, 1069120
    s_add_u32 m0, s48, 21504
    s_nop 0
    buffer_load_dwordx4 v3, s[24:27], s13 offen lds
    s_add_u32 s13, s47, 1105984
    s_add_u32 m0, s48, 22528
    s_nop 0
    buffer_load_dwordx4 v3, s[24:27], s13 offen lds
    s_add_u32 s13, s47, 1142848
    s_add_u32 m0, s48, 23552
    s_nop 0
    buffer_load_dwordx4 v3, s[24:27], s13 offen lds
    s_waitcnt vmcnt(24)
    ds_read_b64_tr_b16 a[240:241], v4 offset:24576
    ds_read_b64_tr_b16 a[242:243], v4 offset:24832
    ds_read_b64_tr_b16 a[244:245], v4 offset:28672
    ds_read_b64_tr_b16 a[246:247], v4 offset:28928
    ds_read_b64_tr_b16 a[248:249], v4 offset:32768
    ds_read_b64_tr_b16 a[250:251], v4 offset:33024
    s_waitcnt lgkmcnt(0)
    ds_read_b64_tr_b16 a[252:253], v4 offset:25600
    ds_read_b64_tr_b16 a[254:255], v4 offset:25856
    ds_read_b64_tr_b16 v[128:129], v4 offset:29696
    ds_read_b64_tr_b16 v[130:131], v4 offset:29952
    ds_read_b64_tr_b16 v[132:133], v4 offset:33792
    ds_read_b64_tr_b16 v[134:135], v4 offset:34048
    s_waitcnt lgkmcnt(0)
    ds_read_b64_tr_b16 v[136:137], v4 offset:26624
    ds_read_b64_tr_b16 v[138:139], v4 offset:26880
    ds_read_b64_tr_b16 v[140:141], v4 offset:30720
    ds_read_b64_tr_b16 v[142:143], v4 offset:30976
    ds_read_b64_tr_b16 v[144:145], v4 offset:34816
    ds_read_b64_tr_b16 v[146:147], v4 offset:35072
    s_waitcnt lgkmcnt(0)
    ds_read_b64_tr_b16 v[148:149], v4 offset:27648
    ds_read_b64_tr_b16 v[150:151], v4 offset:27904
    ds_read_b64_tr_b16 v[152:153], v4 offset:31744
    ds_read_b64_tr_b16 v[154:155], v4 offset:32000
    ds_read_b64_tr_b16 v[156:157], v4 offset:35840
    ds_read_b64_tr_b16 v[158:159], v4 offset:36096
    s_waitcnt lgkmcnt(0)
    s_waitcnt vmcnt(12)
    ds_read_b64_tr_b16 v[160:161], v4 offset:0
    ds_read_b64_tr_b16 v[162:163], v4 offset:256
    ds_read_b64_tr_b16 v[164:165], v4 offset:4096
    ds_read_b64_tr_b16 v[166:167], v4 offset:4352
    ds_read_b64_tr_b16 v[168:169], v4 offset:8192
    ds_read_b64_tr_b16 v[170:171], v4 offset:8448
    s_waitcnt lgkmcnt(0)
    ds_read_b64_tr_b16 v[172:173], v4 offset:1024
    ds_read_b64_tr_b16 v[174:175], v4 offset:1280
    ds_read_b64_tr_b16 v[176:177], v4 offset:5120
    ds_read_b64_tr_b16 v[178:179], v4 offset:5376
    ds_read_b64_tr_b16 v[180:181], v4 offset:9216
    ds_read_b64_tr_b16 v[182:183], v4 offset:9472
    s_waitcnt lgkmcnt(0)
    ds_read_b64_tr_b16 v[184:185], v4 offset:2048
    ds_read_b64_tr_b16 v[186:187], v4 offset:2304
    ds_read_b64_tr_b16 v[188:189], v4 offset:6144
    ds_read_b64_tr_b16 v[190:191], v4 offset:6400
    ds_read_b64_tr_b16 v[192:193], v4 offset:10240
    ds_read_b64_tr_b16 v[194:195], v4 offset:10496
    s_waitcnt lgkmcnt(0)
    ds_read_b64_tr_b16 v[196:197], v4 offset:3072
    ds_read_b64_tr_b16 v[198:199], v4 offset:3328
    ds_read_b64_tr_b16 v[200:201], v4 offset:7168
    ds_read_b64_tr_b16 v[202:203], v4 offset:7424
    ds_read_b64_tr_b16 v[204:205], v4 offset:11264
    ds_read_b64_tr_b16 v[206:207], v4 offset:11520
    s_waitcnt lgkmcnt(0)
    s_waitcnt vmcnt(0)
    ds_read_b64_tr_b16 v[208:209], v4 offset:12288
    ds_read_b64_tr_b16 v[210:211], v4 offset:12544
    ds_read_b64_tr_b16 v[212:213], v4 offset:16384
    ds_read_b64_tr_b16 v[214:215], v4 offset:16640
    ds_read_b64_tr_b16 v[216:217], v4 offset:20480
    ds_read_b64_tr_b16 v[218:219], v4 offset:20736
    s_waitcnt lgkmcnt(0)
    ds_read_b64_tr_b16 v[220:221], v4 offset:13312
    ds_read_b64_tr_b16 v[222:223], v4 offset:13568
    ds_read_b64_tr_b16 v[224:225], v4 offset:17408
    ds_read_b64_tr_b16 v[226:227], v4 offset:17664
    ds_read_b64_tr_b16 v[228:229], v4 offset:21504
    ds_read_b64_tr_b16 v[230:231], v4 offset:21760
    s_waitcnt lgkmcnt(0)
    ds_read_b64_tr_b16 v[232:233], v4 offset:14336
    ds_read_b64_tr_b16 v[234:235], v4 offset:14592
    ds_read_b64_tr_b16 v[236:237], v4 offset:18432
    ds_read_b64_tr_b16 v[238:239], v4 offset:18688
    ds_read_b64_tr_b16 v[240:241], v4 offset:22528
    ds_read_b64_tr_b16 v[242:243], v4 offset:22784
    s_waitcnt lgkmcnt(0)
    ds_read_b64_tr_b16 v[244:245], v4 offset:15360
    ds_read_b64_tr_b16 v[246:247], v4 offset:15616
    ds_read_b64_tr_b16 v[248:249], v4 offset:19456
    ds_read_b64_tr_b16 v[250:251], v4 offset:19712
    ds_read_b64_tr_b16 v[252:253], v4 offset:23552
    ds_read_b64_tr_b16 v[254:255], v4 offset:23808
    s_waitcnt lgkmcnt(0)
    s_barrier
    s_mov_b32 s46, s53
    s_mov_b32 s52, 0
    s_mov_b32 s19, 0
O_loop:
    s_lshl_b32 s50, s46, 13
    s_add_u32 s50, s50, 7340032
    s_lshl_b32 s49, s46, 18
    s_lshr_b32 s13, s45, 1
    s_lshl_b32 s13, s13, 17
    s_add_u32 s49, s49, s13
    s_lshl_b32 s13, s6, 15
    s_add_u32 s49, s49, s13
    s_add_u32 s49, s49, 85983232
    s_lshl_b32 s51, s46, 2
    s_add_u32 s51, s51, s45
    s_mul_i32 s51, s51, 18432
    s_mul_i32 s13, s44, 96
    s_add_u32 s51, s51, s13
    s_lshl_b32 s13, s6, 5
    s_add_u32 s51, s51, s13
    s_add_u32 s51, s51, 1152
O_poll:
    s_mov_b32 exec_hi, 0
    buffer_load_dword v8, v5, s[8:11], s50 offen sc1
    s_waitcnt vmcnt(0)
    v_cmp_ne_u32 vcc, v7, v8
    s_mov_b64 exec, -1
    s_add_u32 s19, s19, 1
    s_cmp_gt_u32 s19, 0x80000
    s_cbranch_scc1 O_go
    s_cbranch_vccz O_go
    s_sleep 1
    s_branch O_poll
O_go:
    buffer_load_dwordx4 v[32:35], v12, s[8:11], s49 offen offset:0 sc1
    buffer_load_dwordx4 v[36:39], v12, s[8:11], s49 offen offset:1024 sc1
    buffer_load_dwordx4 v[40:43], v12, s[8:11], s49 offen offset:2048 sc1
    buffer_load_dwordx4 v[44:47], v12, s[8:11], s49 offen offset:3072 sc1
    s_add_u32 s49, s49, 4096
    buffer_load_dwordx4 v[48:51], v12, s[8:11], s49 offen offset:0 sc1
    buffer_load_dwordx4 v[52:55], v12, s[8:11], s49 offen offset:1024 sc1
    buffer_load_dwordx4 v[56:59], v12, s[8:11], s49 offen offset:2048 sc1
    buffer_load_dwordx4 v[60:63], v12, s[8:11], s49 offen offset:3072 sc1
    s_add_u32 s49, s49, 4096
    buffer_load_dwordx4 v[64:67], v12, s[8:11], s49 offen offset:0 sc1
    buffer_load_dwordx4 v[68:71], v12, s[8:11], s49 offen offset:1024 sc1
    buffer_load_dwordx4 v[72:75], v12, s[8:11], s49 offen offset:2048 sc1
    buffer_load_dwordx4 v[76:79], v12, s[8:11], s49 offen offset:3072 sc1
    s_add_u32 s49, s49, 4096
    buffer_load_dwordx4 v[80:83], v12, s[8:11], s49 offen offset:0 sc1
    buffer_load_dwordx4 v[84:87], v12, s[8:11], s49 offen offset:1024 sc1
    buffer_load_dwordx4 v[88:91], v12, s[8:11], s49 offen offset:2048 sc1
    buffer_load_dwordx4 v[92:95], v12, s[8:11], s49 offen offset:3072 sc1
    s_waitcnt vmcnt(15)
    v_mfma_f32_16x16x32_bf16 v[16:19], a[0:3], v[32:35], 0
    v_mfma_f32_16x16x32_bf16 v[20:23], a[4:7], v[32:35], 0
    v_mfma_f32_16x16x32_bf16 v[24:27], a[8:11], v[32:35], 0
    s_add_u32 s49, s49, 4096
    buffer_load_dwordx4 v[32:35], v12, s[8:11], s49 offen offset:0 sc1
    s_waitcnt vmcnt(15)
    v_mfma_f32_16x16x32_bf16 v[16:19], a[12:15], v[36:39], v[16:19]
    v_mfma_f32_16x16x32_bf16 v[20:23], a[16:19], v[36:39], v[20:23]
    v_mfma_f32_16x16x32_bf16 v[24:27], a[20:23], v[36:39], v[24:27]
    buffer_load_dwordx4 v[36:39], v12, s[8:11], s49 offen offset:1024 sc1
    s_waitcnt vmcnt(15)
    v_mfma_f32_16x16x32_bf16 v[16:19], a[24:27], v[40:43], v[16:19]
    v_mfma_f32_16x16x32_bf16 v[20:23], a[28:31], v[40:43], v[20:23]
    v_mfma_f32_16x16x32_bf16 v[24:27], a[32:35], v[40:43], v[24:27]
    buffer_load_dwordx4 v[40:43], v12, s[8:11], s49 offen offset:2048 sc1
    s_waitcnt vmcnt(15)
    v_mfma_f32_16x16x32_bf16 v[16:19], a[36:39], v[44:47], v[16:19]
    v_mfma_f32_16x16x32_bf16 v[20:23], a[40:43], v[44:47], v[20:23]
    v_mfma_f32_16x16x32_bf16 v[24:27], a[44:47], v[44:47], v[24:27]
    buffer_load_dwordx4 v[44:47], v12, s[8:11], s49 offen offset:3072 sc1
    s_waitcnt vmcnt(15)
    v_mfma_f32_16x16x32_bf16 v[16:19], a[48:51], v[48:51], v[16:19]
    v_mfma_f32_16x16x32_bf16 v[20:23], a[52:55], v[48:51], v[20:23]
    v_mfma_f32_16x16x32_bf16 v[24:27], a[56:59], v[48:51], v[24:27]
    s_add_u32 s49, s49, 4096
    buffer_load_dwordx4 v[48:51], v12, s[8:11], s49 offen offset:0 sc1
    s_waitcnt vmcnt(15)
    v_mfma_f32_16x16x32_bf16 v[16:19], a[60:63], v[52:55], v[16:19]
    v_mfma_f32_16x16x32_bf16 v[20:23], a[64:67], v[52:55], v[20:23]
    v_mfma_f32_16x16x32_bf16 v[24:27], a[68:71], v[52:55], v[24:27]
    buffer_load_dwordx4 v[52:55], v12, s[8:11], s49 offen offset:1024 sc1
    s_waitcnt vmcnt(15)
    v_mfma_f32_16x16x32_bf16 v[16:19], a[72:75], v[56:59], v[16:19]
    v_mfma_f32_16x16x32_bf16 v[20:23], a[76:79], v[56:59], v[20:23]
    v_mfma_f32_16x16x32_bf16 v[24:27], a[80:83], v[56:59], v[24:27]
    buffer_load_dwordx4 v[56:59], v12, s[8:11], s49 offen offset:2048 sc1
    s_waitcnt vmcnt(15)
    v_mfma_f32_16x16x32_bf16 v[16:19], a[84:87], v[60:63], v[16:19]
    v_mfma_f32_16x16x32_bf16 v[20:23], a[88:91], v[60:63], v[20:23]
    v_mfma_f32_16x16x32_bf16 v[24:27], a[92:95], v[60:63], v[24:27]
    buffer_load_dwordx4 v[60:63], v12, s[8:11], s49 offen offset:3072 sc1
    s_waitcnt vmcnt(15)
    v_mfma_f32_16x16x32_bf16 v[16:19], a[96:99], v[64:67], v[16:19]
    v_mfma_f32_16x16x32_bf16 v[20:23], a[100:103], v[64:67], v[20:23]
    v_mfma_f32_16x16x32_bf16 v[24:27], a[104:107], v[64:67], v[24:27]
    s_add_u32 s49, s49, 4096
    buffer_load_dwordx4 v[64:67], v12, s[8:11], s49 offen offset:0 sc1
    s_waitcnt vmcnt(15)
    v_mfma_f32_16x16x32_bf16 v[16:19], a[108:111], v[68:71], v[16:19]
    v_mfma_f32_16x16x32_bf16 v[20:23], a[112:115], v[68:71], v[20:23]
    v_mfma_f32_16x16x32_bf16 v[24:27], a[116:119], v[68:71], v[24:27]
    buffer_load_dwordx4 v[68:71], v12, s[8:11], s49 offen offset:1024 sc1
    s_waitcnt vmcnt(15)
    v_mfma_f32_16x16x32_bf16 v[16:19], a[120:123], v[72:75], v[16:19]
    v_mfma_f32_16x16x32_bf16 v[20:23], a[124:127], v[72:75], v[20:23]
    v_mfma_f32_16x16x32_bf16 v[24:27], a[128:131], v[72:75], v[24:27]
    buffer_load_dwordx4 v[72:75], v12, s[8:11], s49 offen offset:2048 sc1
    s_waitcnt vmcnt(15)
    v_mfma_f32_16x16x32_bf16 v[16:19], a[132:135], v[76:79], v[16:19]
    v_mfma_f32_16x16x32_bf16 v[20:23], a[136:139], v[76:79], v[20:23]
    v_mfma_f32_16x16x32_bf16 v[24:27], a[140:143], v[76:79], v[24:27]
    buffer_load_dwordx4 v[76:79], v12, s[8:11], s49 offen offset:3072 sc1
    s_waitcnt vmcnt(15)
    v_mfma_f32_16x16x32_bf16 v[16:19], a[144:147], v[80:83], v[16:19]
    v_mfma_f32_16x16x32_bf16 v[20:23], a[148:151], v[80:83], v[20:23]
    v_mfma_f32_16x16x32_bf16 v[24:27], a[152:155], v[80:83], v[24:27]
    s_add_u32 s49, s49, 4096
    buffer_load_dwordx4 v[80:83], v12, s[8:11], s49 offen offset:0 sc1
    s_waitcnt vmcnt(15)
    v_mfma_f32_16x16x32_bf16 v[16:19], a[156:159], v[84:87], v[16:19]
    v_mfma_f32_16x16x32_bf16 v[20:23], a[160:163], v[84:87], v[20:23]
    v_mfma_f32_16x16x32_bf16 v[24:27], a[164:167], v[84:87], v[24:27]
    buffer_load_dwordx4 v[84:87], v12, s[8:11], s49 offen offset:1024 sc1
    s_waitcnt vmcnt(15)
    v_mfma_f32_16x16x32_bf16 v[16:19], a[168:171], v[88:91], v[16:19]
    v_mfma_f32_16x16x32_bf16 v[20:23], a[172:175], v[88:91], v[20:23]
    v_mfma_f32_16x16x32_bf16 v[24:27], a[176:179], v[88:91], v[24:27]
    buffer_load_dwordx4 v[88:91], v12, s[8:11], s49 offen offset:2048 sc1
    s_waitcnt vmcnt(15)
    v_mfma_f32_16x16x32_bf16 v[16:19], a[180:183], v[92:95], v[16:19]
    v_mfma_f32_16x16x32_bf16 v[20:23], a[184:187], v[92:95], v[20:23]
    v_mfma_f32_16x16x32_bf16 v[24:27], a[188:191], v[92:95], v[24:27]
    buffer_load_dwordx4 v[92:95], v12, s[8:11], s49 offen offset:3072 sc1
    s_waitcnt vmcnt(15)
    v_mfma_f32_16x16x32_bf16 v[16:19], a[192:195], v[32:35], v[16:19]
    v_mfma_f32_16x16x32_bf16 v[20:23], a[196:199], v[32:35], v[20:23]
    v_mfma_f32_16x16x32_bf16 v[24:27], a[200:203], v[32:35], v[24:27]
    s_waitcnt vmcnt(14)
    v_mfma_f32_16x16x32_bf16 v[16:19], a[204:207], v[36:39], v[16:19]
    v_mfma_f32_16x16x32_bf16 v[20:23], a[208:211], v[36:39], v[20:23]
    v_mfma_f32_16x16x32_bf16 v[24:27], a[212:215], v[36:39], v[24:27]
    s_waitcnt vmcnt(13)
    v_mfma_f32_16x16x32_bf16 v[16:19], a[216:219], v[40:43], v[16:19]
    v_mfma_f32_16x16x32_bf16 v[20:23], a[220:223], v[40:43], v[20:23]
    v_mfma_f32_16x16x32_bf16 v[24:27], a[224:227], v[40:43], v[24:27]
    s_waitcnt vmcnt(12)
    v_mfma_f32_16x16x32_bf16 v[16:19], a[228:231], v[44:47], v[16:19]
    v_mfma_f32_16x16x32_bf16 v[20:23], a[232:235], v[44:47], v[20:23]
    v_mfma_f32_16x16x32_bf16 v[24:27], a[236:239], v[44:47], v[24:27]
    s_waitcnt vmcnt(11)
    v_mfma_f32_16x16x32_bf16 v[16:19], a[240:243], v[48:51], v[16:19]
    v_mfma_f32_16x16x32_bf16 v[20:23], a[244:247], v[48:51], v[20:23]
    v_mfma_f32_16x16x32_bf16 v[24:27], a[248:251], v[48:51], v[24:27]
    s_waitcnt vmcnt(10)
    v_mfma_f32_16x16x32_bf16 v[16:19], a[252:255], v[52:55], v[16:19]
    v_mfma_f32_16x16x32_bf16 v[20:23], v[128:131], v[52:55], v[20:23]
    v_mfma_f32_16x16x32_bf16 v[24:27], v[132:135], v[52:55], v[24:27]
    s_waitcnt vmcnt(9)
    v_mfma_f32_16x16x32_bf16 v[16:19], v[136:139], v[56:59], v[16:19]
    v_mfma_f32_16x16x32_bf16 v[20:23], v[140:143], v[56:59], v[20:23]
    v_mfma_f32_16x16x32_bf16 v[24:27], v[144:147], v[56:59], v[24:27]
    s_waitcnt vmcnt(8)
    v_mfma_f32_16x16x32_bf16 v[16:19], v[148:151], v[60:63], v[16:19]
    v_mfma_f32_16x16x32_bf16 v[20:23], v[152:155], v[60:63], v[20:23]
    v_mfma_f32_16x16x32_bf16 v[24:27], v[156:159], v[60:63], v[24:27]
    s_waitcnt vmcnt(7)
    v_mfma_f32_16x16x32_bf16 v[16:19], v[160:163], v[64:67], v[16:19]
    v_mfma_f32_16x16x32_bf16 v[20:23], v[164:167], v[64:67], v[20:23]
    v_mfma_f32_16x16x32_bf16 v[24:27], v[168:171], v[64:67], v[24:27]
    s_waitcnt vmcnt(6)
    v_mfma_f32_16x16x32_bf16 v[16:19], v[172:175], v[68:71], v[16:19]
    v_mfma_f32_16x16x32_bf16 v[20:23], v[176:179], v[68:71], v[20:23]
    v_mfma_f32_16x16x32_bf16 v[24:27], v[180:183], v[68:71], v[24:27]
    s_waitcnt vmcnt(5)
    v_mfma_f32_16x16x32_bf16 v[16:19], v[184:187], v[72:75], v[16:19]
    v_mfma_f32_16x16x32_bf16 v[20:23], v[188:191], v[72:75], v[20:23]
    v_mfma_f32_16x16x32_bf16 v[24:27], v[192:195], v[72:75], v[24:27]
    s_waitcnt vmcnt(4)
    v_mfma_f32_16x16x32_bf16 v[16:19], v[196:199], v[76:79], v[16:19]
    v_mfma_f32_16x16x32_bf16 v[20:23], v[200:203], v[76:79], v[20:23]
    v_mfma_f32_16x16x32_bf16 v[24:27], v[204:207], v[76:79], v[24:27]
    s_waitcnt vmcnt(3)
    v_mfma_f32_16x16x32_bf16 v[16:19], v[208:211], v[80:83], v[16:19]
    v_mfma_f32_16x16x32_bf16 v[20:23], v[212:215], v[80:83], v[20:23]
    v_mfma_f32_16x16x32_bf16 v[24:27], v[216:219], v[80:83], v[24:27]
    s_waitcnt vmcnt(2)
    v_mfma_f32_16x16x32_bf16 v[16:19], v[220:223], v[84:87], v[16:19]
    v_mfma_f32_16x16x32_bf16 v[20:23], v[224:227], v[84:87], v[20:23]
    v_mfma_f32_16x16x32_bf16 v[24:27], v[228:231], v[84:87], v[24:27]
    s_waitcnt vmcnt(1)
    v_mfma_f32_16x16x32_bf16 v[16:19], v[232:235], v[88:91], v[16:19]
    v_mfma_f32_16x16x32_bf16 v[20:23], v[236:239], v[88:91], v[20:23]
    v_mfma_f32_16x16x32_bf16 v[24:27], v[240:243], v[88:91], v[24:27]
    s_waitcnt vmcnt(0)
    v_mfma_f32_16x16x32_bf16 v[16:19], v[244:247], v[92:95], v[16:19]
    v_mfma_f32_16x16x32_bf16 v[20:23], v[248:251], v[92:95], v[20:23]
    v_mfma_f32_16x16x32_bf16 v[24:27], v[252:255], v[92:95], v[24:27]
    v_add_u32 v8, s52, v10
    v_add_u32 v9, s52, v11
    ds_write_b128 v8, v[16:19] offset:0
    s_nop 0
    ds_write_b128 v8, v[20:23] offset:1024
    s_nop 2
    ds_write_b128 v8, v[24:27] offset:2048
    s_waitcnt lgkmcnt(0)
    s_barrier
    s_cmp_eq_u32 s6, 3
    s_cbranch_scc1 O_next
    ds_read_b128 v[96:99], v9 offset:0
    ds_read_b128 v[100:103], v9 offset:3072
    ds_read_b128 v[104:107], v9 offset:6144
    ds_read_b128 v[108:111], v9 offset:9216
    s_waitcnt lgkmcnt(0)
    v_pk_add_f32 v[96:97], v[96:97], v[100:101]
    v_pk_add_f32 v[98:99], v[98:99], v[102:103]
    v_pk_add_f32 v[104:105], v[104:105], v[108:109]
    v_pk_add_f32 v[106:107], v[106:107], v[110:111]
    v_pk_add_f32 v[96:97], v[96:97], v[104:105]
    v_pk_add_f32 v[98:99], v[98:99], v[106:107]
    v_cvt_pk_bf16_f32 v96, v96, v97
    v_cvt_pk_bf16_f32 v97, v98, v99
    buffer_store_dwordx2 v[96:97], v6, s[36:39], s51 offen
O_next:
    s_xor_b32 s52, s52, 0x4000
    s_add_u32 s46, s46, 2
    s_cmp_lt_u32 s46, 64
    s_cbranch_scc1 O_loop
    s_cmp_lg_u32 s12, 0
    s_cbranch_scc1 L_exit
    s_cmp_lg_u32 s6, 0
    s_cbranch_scc1 L_exit
    s_mov_b64 exec, 1
    v_mov_b32 v8, 2031616
    buffer_store_dword v7, v8, s[8:11], 0 offen sc1
    s_endpgm
L_code_end:
.section .rodata,"a"
.p2align 6
.amdhsa_kernel concat_heads__spectral_gfnet__memory_aug_recurrent_mem_tr__prompt_kernel
  .amdhsa_next_free_vgpr 512
  .amdhsa_next_free_sgpr 102
  .amdhsa_accum_offset 256
  .amdhsa_group_segment_fixed_size 0
  .amdhsa_kernarg_size 104
  .amdhsa_user_sgpr_count 2
  .amdhsa_user_sgpr_kernarg_segment_ptr 1
  .amdhsa_system_sgpr_workgroup_id_x 1
.end_amdhsa_kernel
```
